```python
import torch

def _softmax(x, axis=-1):
    return torch.softmax(x, dim=axis)
def _gelu(x):
    return torch.nn.functional.gelu(x, approximate="tanh")
def _silu(x):
    return torch.nn.functional.silu(x)
def _sigmoid(x):
    return torch.sigmoid(x)
def _layernorm(x, axis=-1, eps=1e-5):
    m = x.mean(dim=axis, keepdim=True)
    v = x.var(dim=axis, keepdim=True, unbiased=False)
    return (x - m) / torch.sqrt(v + eps)
def _scatter_add(tgt, idx, src, axis=0):
    return tgt.clone().index_add_(axis, idx, src)
def _segment_sum(src, seg, n):
    out = torch.zeros((n,) + src.shape[1:], dtype=src.dtype)
    return out.index_add_(0, seg, src)
def _pad(x, pw):
    flat = tuple(v for pair in reversed(pw) for v in pair)
    return torch.nn.functional.pad(x, flat)

kernel_name = 'interleave_layers__linear_attn_block__glu_gated_reglu__prompt'

def setup_inputs():

    _w = (lambda a: (lambda t: t.to(torch.bfloat16) if t.is_floating_point() else t)(torch.as_tensor(a)))
    def _A_setup():
        B, S, D = 1, 2048, 512
        return {
            "x": _w((lambda *s: torch.randn(*s, dtype=torch.bfloat16) * 0.05)(B, S, D)),
            "wqkv": _w((lambda *s: torch.randn(*s, dtype=torch.bfloat16) * 0.05)(D, 3 * D)),
            "wo": _w((lambda *s: torch.randn(*s, dtype=torch.bfloat16) * 0.05)(D, D)),
        }
    _A_in = _A_setup()

    def _B_setup():
        B, S, D, F = 1, 2048, 512, 1376
        return {
            "x": _w((lambda *s: torch.randn(*s, dtype=torch.bfloat16) * 0.05)(B, S, D)),
            "W_gate": _w((lambda *s: torch.randn(*s, dtype=torch.bfloat16) * 0.4)(D, F) * (2.0 / D) ** 0.5),
            "W_up": _w((lambda *s: torch.randn(*s, dtype=torch.bfloat16) * 0.4)(D, F) * (2.0 / D) ** 0.5),
            "W_down": _w((lambda *s: torch.randn(*s, dtype=torch.bfloat16) * 0.4)(F, D) * (1.0 / F) ** 0.5),
        }
    _B_in = _B_setup()

    return {
        "A_x": _A_in["x"],
        "A_wqkv": _A_in["wqkv"],
        "A_wo": _A_in["wo"],
        "B_x": _B_in["x"],
        "B_W_gate": _B_in["W_gate"],
        "B_W_up": _B_in["W_up"],
        "B_W_down": _B_in["W_down"],
    }

def reference(A_x, A_wqkv, A_wo, B_x, B_W_gate, B_W_up, B_W_down):
    def _A_ref(x, wqkv, wo):
        B, S, D = x.shape
        H = 32; Dh = D // H
        qkv = (lambda x, *d: x.permute(*d))((x @ wqkv).reshape(B, S, 3, H, Dh), 2, 0, 3, 1, 4)
        q, k, v = qkv[0], qkv[1], qkv[2]
        phi = lambda t: torch.where(t > 0, t + 1, torch.exp(t)) + 1e-6
        pq, pk = phi(q), phi(k)
        kv = torch.einsum("bhsd,bhse->bhde", pk, v)
        z = torch.einsum("bhsd->bhd", pk)
        num = torch.einsum("bhqd,bhde->bhqe", pq, kv)
        den = torch.einsum("bhqd,bhd->bhq", pq, z)[..., None] + 1e-6
        o = num / den
        return (lambda x, *d: x.permute(*d))(o, 0, 2, 1, 3).reshape(B, S, D) @ wo

    def _B_ref(x, W_gate, W_up, W_down):
        gate = torch.einsum("bsd,df->bsf", x, W_gate)
        up = torch.einsum("bsd,df->bsf", x, W_up)
        gate = gate * (lambda x, dt: x.to(dt))(gate > 0, gate.dtype)
        h = gate * up
        return torch.einsum("bsf,fd->bsd", h, W_down)

    x = A_x
    x = x + _A_ref(_layernorm(x, axis=-1), A_wqkv, A_wo)
    x = x + _B_ref(_layernorm(x, axis=-1), B_W_gate, B_W_up, B_W_down)
    x = x + _A_ref(_layernorm(x, axis=-1), A_wqkv, A_wo)
    x = x + _B_ref(_layernorm(x, axis=-1), B_W_gate, B_W_up, B_W_down)
    return x
```

```asm
; @launch grid=(256,1,1) block=(512,1,1) lds=160768
.amdgcn_target "amdgcn-amd-amdhsa--gfx950"

.text
.globl interleave_layers__linear_attn_block__glu_gated_reglu__prompt_kernel
.p2align 8
.type interleave_layers__linear_attn_block__glu_gated_reglu__prompt_kernel,@function
interleave_layers__linear_attn_block__glu_gated_reglu__prompt_kernel:
    s_cmp_ge_u32 s2, 256
    s_cbranch_scc1 L_end
    v_and_b32 v1, 63, v0
    v_lshrrev_b32 v2, 6, v0
    s_load_dwordx16 s[16:31], s[0:1], 0
    s_load_dwordx4 s[32:35], s[0:1], 64
    s_getreg_b32 s62, hwreg(HW_REG_XCC_ID, 0, 4)
    s_and_b32 s62, s62, 7
    v_readfirstlane_b32 s3, v2
    v_lshrrev_b32 v2, 4, v1
    v_and_b32 v3, 15, v1
    s_mov_b32 s63, 0
    s_waitcnt lgkmcnt(0)
    s_mov_b32 s44, s34
    s_mov_b32 s45, s35
    s_mov_b32 s46, 268435456
    s_mov_b32 s47, 0x00020000
    s_mov_b32 s48, s32
    s_mov_b32 s49, s33
    s_mov_b32 s50, 256
    s_mov_b32 s51, 0x00020000
    s_mov_b32 s64, s18
    s_mov_b32 s65, s19
    s_mov_b32 s66, 1572864
    s_mov_b32 s67, 0x00020000
    s_mov_b32 s68, s20
    s_mov_b32 s69, s21
    s_mov_b32 s70, 524288
    s_mov_b32 s71, 0x00020000
    s_mov_b32 s72, s24
    s_mov_b32 s73, s25
    s_mov_b32 s74, 1409024
    s_mov_b32 s75, 0x00020000
    s_mov_b32 s76, s26
    s_mov_b32 s77, s27
    s_mov_b32 s78, 1409024
    s_mov_b32 s79, 0x00020000
    s_mov_b32 s80, s28
    s_mov_b32 s81, s29
    s_mov_b32 s82, 1409024
    s_mov_b32 s83, 0x00020000
    s_mov_b32 s36, s16
    s_mov_b32 s37, s17
    s_mov_b32 s38, 2097152
    s_mov_b32 s39, 0x00020000
    s_cmp_eq_u32 s3, 0
    s_cbranch_scc0 L_e1
    s_lshl_b32 s4, s62, 5
    v_mov_b32 v4, s4
    v_mov_b32 v5, 1
    s_mov_b64 exec, 1
    buffer_atomic_add v5, v4, s[48:51], 0 offen sc0
    s_mov_b64 exec, -1
    v_lshlrev_b32 v6, 7, v1
    s_lshr_b32 s7, s2, 3
    s_and_b32 s7, s7, 31
    s_mul_i32 s7, s7, 49152
    v_lshlrev_b32 v7, 10, v1
    s_mov_b32 exec_hi, 0xffff
    buffer_load_dword v31, v7, s[64:67], s7 offen offset:384
    s_mov_b64 exec, -1
    s_lshr_b32 s7, s2, 3
    s_and_b32 s7, s7, 31
    s_lshl_b32 s5, s62, 18
    s_lshl_b32 s6, s7, 13
    s_add_u32 s5, s5, s6
    buffer_load_dword v31, v6, s[36:39], s5 offen
    s_mul_i32 s7, s2, 6144
    s_mov_b32 exec_hi, 0xffff
    buffer_load_dword v31, v6, s[64:67], s7 offen
    s_mov_b64 exec, -1
    s_waitcnt vmcnt(3)
    v_readfirstlane_b32 s5, v5
    s_add_u32 s96, s4, s5
    s_cmp_lt_u32 s5, 32
    s_cbranch_scc1 L_tk_ok
    s_mov_b32 s84, 131072
    s_nop 0
L_tk_wait:
    v_lshlrev_b32 v4, 5, v1
    s_mov_b64 exec, 0xff
    buffer_load_dword v5, v4, s[48:51], 0 offen sc1
    s_waitcnt vmcnt(0)
    s_mov_b64 exec, -1
    v_readlane_b32 s86, v5, 0
    v_readlane_b32 s87, v5, 1
    v_readlane_b32 s88, v5, 2
    v_readlane_b32 s89, v5, 3
    v_readlane_b32 s90, v5, 4
    v_readlane_b32 s91, v5, 5
    v_readlane_b32 s92, v5, 6
    v_readlane_b32 s93, v5, 7
    s_add_u32 s85, s86, s87
    s_add_u32 s85, s85, s88
    s_add_u32 s85, s85, s89
    s_add_u32 s85, s85, s90
    s_add_u32 s85, s85, s91
    s_add_u32 s85, s85, s92
    s_add_u32 s85, s85, s93
    s_cmp_ge_u32 s85, 256
    s_cbranch_scc1 L_tk_all
    s_sub_u32 s84, s84, 1
    s_cbranch_scc1 L_tk_all
    s_sleep 2
    s_branch L_tk_wait
L_tk_all:
    s_sub_u32 s5, s5, 32
    s_max_u32 s6, s86, 32
    s_sub_u32 s6, s6, 32
    s_cmp_gt_u32 s62, 0
    s_cselect_b32 s6, s6, 0
    s_add_u32 s5, s5, s6
    s_max_u32 s6, s87, 32
    s_sub_u32 s6, s6, 32
    s_cmp_gt_u32 s62, 1
    s_cselect_b32 s6, s6, 0
    s_add_u32 s5, s5, s6
    s_max_u32 s6, s88, 32
    s_sub_u32 s6, s6, 32
    s_cmp_gt_u32 s62, 2
    s_cselect_b32 s6, s6, 0
    s_add_u32 s5, s5, s6
    s_max_u32 s6, s89, 32
    s_sub_u32 s6, s6, 32
    s_cmp_gt_u32 s62, 3
    s_cselect_b32 s6, s6, 0
    s_add_u32 s5, s5, s6
    s_max_u32 s6, s90, 32
    s_sub_u32 s6, s6, 32
    s_cmp_gt_u32 s62, 4
    s_cselect_b32 s6, s6, 0
    s_add_u32 s5, s5, s6
    s_max_u32 s6, s91, 32
    s_sub_u32 s6, s6, 32
    s_cmp_gt_u32 s62, 5
    s_cselect_b32 s6, s6, 0
    s_add_u32 s5, s5, s6
    s_max_u32 s6, s92, 32
    s_sub_u32 s6, s6, 32
    s_cmp_gt_u32 s62, 6
    s_cselect_b32 s6, s6, 0
    s_add_u32 s5, s5, s6
    s_mov_b32 s96, 0
    s_mov_b32 s7, 0
    s_min_u32 s6, s86, 32
    s_sub_u32 s8, 32, s6
    s_add_u32 s6, s6, 0
    s_add_u32 s6, s6, s5
    s_cmp_lt_u32 s5, s8
    s_cselect_b32 s10, 1, 0
    s_andn2_b32 s10, s10, s7
    s_or_b32 s7, s7, s10
    s_cmp_lg_u32 s10, 0
    s_cselect_b32 s96, s6, s96
    s_sub_u32 s5, s5, s8
    s_min_u32 s6, s87, 32
    s_sub_u32 s8, 32, s6
    s_add_u32 s6, s6, 32
    s_add_u32 s6, s6, s5
    s_cmp_lt_u32 s5, s8
    s_cselect_b32 s10, 1, 0
    s_andn2_b32 s10, s10, s7
    s_or_b32 s7, s7, s10
    s_cmp_lg_u32 s10, 0
    s_cselect_b32 s96, s6, s96
    s_sub_u32 s5, s5, s8
    s_min_u32 s6, s88, 32
    s_sub_u32 s8, 32, s6
    s_add_u32 s6, s6, 64
    s_add_u32 s6, s6, s5
    s_cmp_lt_u32 s5, s8
    s_cselect_b32 s10, 1, 0
    s_andn2_b32 s10, s10, s7
    s_or_b32 s7, s7, s10
    s_cmp_lg_u32 s10, 0
    s_cselect_b32 s96, s6, s96
    s_sub_u32 s5, s5, s8
    s_min_u32 s6, s89, 32
    s_sub_u32 s8, 32, s6
    s_add_u32 s6, s6, 96
    s_add_u32 s6, s6, s5
    s_cmp_lt_u32 s5, s8
    s_cselect_b32 s10, 1, 0
    s_andn2_b32 s10, s10, s7
    s_or_b32 s7, s7, s10
    s_cmp_lg_u32 s10, 0
    s_cselect_b32 s96, s6, s96
    s_sub_u32 s5, s5, s8
    s_min_u32 s6, s90, 32
    s_sub_u32 s8, 32, s6
    s_add_u32 s6, s6, 128
    s_add_u32 s6, s6, s5
    s_cmp_lt_u32 s5, s8
    s_cselect_b32 s10, 1, 0
    s_andn2_b32 s10, s10, s7
    s_or_b32 s7, s7, s10
    s_cmp_lg_u32 s10, 0
    s_cselect_b32 s96, s6, s96
    s_sub_u32 s5, s5, s8
    s_min_u32 s6, s91, 32
    s_sub_u32 s8, 32, s6
    s_add_u32 s6, s6, 160
    s_add_u32 s6, s6, s5
    s_cmp_lt_u32 s5, s8
    s_cselect_b32 s10, 1, 0
    s_andn2_b32 s10, s10, s7
    s_or_b32 s7, s7, s10
    s_cmp_lg_u32 s10, 0
    s_cselect_b32 s96, s6, s96
    s_sub_u32 s5, s5, s8
    s_min_u32 s6, s92, 32
    s_sub_u32 s8, 32, s6
    s_add_u32 s6, s6, 192
    s_add_u32 s6, s6, s5
    s_cmp_lt_u32 s5, s8
    s_cselect_b32 s10, 1, 0
    s_andn2_b32 s10, s10, s7
    s_or_b32 s7, s7, s10
    s_cmp_lg_u32 s10, 0
    s_cselect_b32 s96, s6, s96
    s_sub_u32 s5, s5, s8
    s_min_u32 s6, s93, 32
    s_sub_u32 s8, 32, s6
    s_add_u32 s6, s6, 224
    s_add_u32 s6, s6, s5
    s_cmp_lt_u32 s5, s8
    s_cselect_b32 s10, 1, 0
    s_andn2_b32 s10, s10, s7
    s_or_b32 s7, s7, s10
    s_cmp_lg_u32 s10, 0
    s_cselect_b32 s96, s6, s96
    s_sub_u32 s5, s5, s8
L_tk_ok:
    v_mov_b32 v4, 159744
    v_mov_b32 v5, s96
    ds_write_b32 v4, v5
    s_waitcnt lgkmcnt(0)
    s_branch L_eT
L_e1:
    s_cmp_eq_u32 s3, 1
    s_cbranch_scc0 L_eT
    s_cmp_lt_u32 s2, 16
    s_cbranch_scc0 L_eT
    v_mov_b32 v4, 0
    v_mov_b32 v5, 0
    v_mov_b32 v6, 0
    v_mov_b32 v7, 0
    v_lshlrev_b32 v8, 4, v1
    s_lshl_b32 s4, s2, 11
    s_add_u32 s5, s4, 23068672
    buffer_store_dwordx4 v[4:7], v8, s[44:47], s5 offen offset:0 sc1
    buffer_store_dwordx4 v[4:7], v8, s[44:47], s5 offen offset:1024 sc1
    s_add_u32 s5, s4, 23134208
    buffer_store_dwordx4 v[4:7], v8, s[44:47], s5 offen offset:0 sc1
    buffer_store_dwordx4 v[4:7], v8, s[44:47], s5 offen offset:1024 sc1
    s_lshl_b32 s4, s2, 7
    s_mov_b64 exec, 0xff
    s_add_u32 s5, s4, 23101440
    buffer_store_dwordx4 v[4:7], v8, s[44:47], s5 offen sc1
    s_add_u32 s5, s4, 23166976
    buffer_store_dwordx4 v[4:7], v8, s[44:47], s5 offen sc1
    s_mov_b64 exec, -1
    s_mul_i32 s4, s2, 2048
    s_add_u32 s4, s4, 23199744
    buffer_store_dwordx4 v[4:7], v8, s[44:47], s4 offen offset:1024 sc1
    s_mov_b64 exec, -1
    buffer_store_dwordx4 v[4:7], v8, s[44:47], s4 offen sc1
    s_mov_b64 exec, -1
L_eT:
    s_nop 4
    s_barrier
    v_mov_b32 v4, 159744
    ds_read_b32 v5, v4
    s_waitcnt lgkmcnt(0)
    v_readfirstlane_b32 s96, v5
    s_lshr_b32 s60, s96, 4
    s_and_b32 s61, s96, 15
    s_setprio 2
    s_cmp_lt_u32 s3, 4
    s_cbranch_scc1 L_comp
    s_setprio 3
    s_cmp_lt_u32 s3, 6
    s_cbranch_scc1 L_aload
    s_setprio 1
    s_and_b32 s4, s3, 1
    s_mov_b32 s36, s24
    s_mov_b32 s37, s25
    s_mov_b32 s38, 1409024
    s_mov_b32 s39, 0x00020000
    s_mov_b32 s40, s26
    s_mov_b32 s41, s27
    s_mov_b32 s42, 1409024
    s_mov_b32 s43, 0x00020000
    s_cmp_eq_u32 s61, 15
    s_cselect_b32 s74, 0, s74
    s_cselect_b32 s78, 0, s78
    v_bfe_u32 v4, v1, 2, 2
    v_bfe_u32 v5, v1, 1, 1
    v_and_b32 v6, 1, v2
    v_xor_b32 v5, v5, v6
    v_and_b32 v6, 1, v1
    v_lshlrev_b32 v5, 5, v5
    v_lshl_add_u32 v5, v6, 4, v5
    v_lshl_add_u32 v6, v2, 3, v4
    v_lshl_add_u32 v7, v2, 2, v4
    s_lshl_b32 s9, s61, 6
    s_mul_i32 s10, s4, 12288
    s_add_u32 s10, s10, s9
    v_mul_u32_u24 v8, 3072, v6
    v_add3_u32 v12, v8, v5, s10
    v_add_u32 v13, 1024, v12
    v_add_u32 v14, 2048, v12
    s_and_b32 s9, s61, 7
    s_lshl_b32 s9, s9, 7
    s_mul_i32 s10, s4, 16384
    s_add_u32 s10, s10, s9
    v_mul_u32_u24 v8, 1024, v7
    v_add3_u32 v18, v8, v5, s10
    v_add_u32 v19, 64, v18
    s_mul_i32 s9, s61, 192
    s_mul_i32 s10, s4, 44032
    s_add_u32 s10, s10, s9
    v_mul_u32_u24 v8, 2752, v7
    v_add3_u32 v20, v8, v5, s10
    v_add_u32 v21, 64, v20
    v_add_u32 v22, 128, v20
    s_lshl_b32 s9, s61, 6
    s_mul_i32 s10, s4, 49152
    s_add_u32 s10, s10, s9
    v_mul_u32_u24 v8, 3072, v7
    v_add3_u32 v15, v8, v5, s10
    v_add_u32 v16, 1024, v15
    v_add_u32 v17, 2048, v15
    s_lshl_b32 s11, s4, 10
    s_mov_b32 s12, s60
    s_mov_b32 s13, s61
    s_lshl_b32 s14, s61, 1
    s_and_b32 s14, s14, 15
    s_mul_i32 s7, s14, 98304
    s_add_u32 s5, s11, 0
    s_add_u32 m0, s5, 0
    s_nop 0
    buffer_load_dwordx4 v13, s[64:67], s7 offen  lds
    s_add_u32 m0, s5, 2048
    s_nop 0
    buffer_load_dwordx4 v14, s[64:67], s7 offen  lds
    s_add_u32 s7, s7, 98304
    s_cmp_eq_u32 s7, 1572864
    s_cselect_b32 s7, 0, s7
    s_add_u32 m0, s5, 4096
    s_nop 0
    buffer_load_dwordx4 v13, s[64:67], s7 offen  lds
    s_add_u32 m0, s5, 6144
    s_nop 0
    buffer_load_dwordx4 v14, s[64:67], s7 offen  lds
    s_add_u32 s7, s7, 98304
    s_cmp_eq_u32 s7, 1572864
    s_cselect_b32 s7, 0, s7
    s_add_u32 s5, s5, 8192
    s_cmp_ge_u32 s5, 98304
    s_cselect_b32 s5, s11, s5
    s_add_u32 m0, s5, 0
    s_nop 0
    buffer_load_dwordx4 v13, s[64:67], s7 offen  lds
    s_add_u32 m0, s5, 2048
    s_nop 0
    buffer_load_dwordx4 v14, s[64:67], s7 offen  lds
    s_add_u32 s7, s7, 98304
    s_cmp_eq_u32 s7, 1572864
    s_cselect_b32 s7, 0, s7
    s_add_u32 m0, s5, 4096
    s_nop 0
    buffer_load_dwordx4 v13, s[64:67], s7 offen  lds
    s_add_u32 m0, s5, 6144
    s_nop 0
    buffer_load_dwordx4 v14, s[64:67], s7 offen  lds
    s_add_u32 s7, s7, 98304
    s_cmp_eq_u32 s7, 1572864
    s_cselect_b32 s7, 0, s7
    s_add_u32 s5, s5, 8192
    s_cmp_ge_u32 s5, 98304
    s_cselect_b32 s5, s11, s5
    s_add_u32 m0, s5, 0
    s_nop 0
    buffer_load_dwordx4 v13, s[64:67], s7 offen  lds
    s_add_u32 m0, s5, 2048
    s_nop 0
    buffer_load_dwordx4 v14, s[64:67], s7 offen  lds
    s_add_u32 s7, s7, 98304
    s_cmp_eq_u32 s7, 1572864
    s_cselect_b32 s7, 0, s7
    s_add_u32 m0, s5, 4096
    s_nop 0
    buffer_load_dwordx4 v13, s[64:67], s7 offen  lds
    s_add_u32 m0, s5, 6144
    s_nop 0
    buffer_load_dwordx4 v14, s[64:67], s7 offen  lds
    s_add_u32 s7, s7, 98304
    s_cmp_eq_u32 s7, 1572864
    s_cselect_b32 s7, 0, s7
    s_add_u32 s5, s5, 8192
    s_cmp_ge_u32 s5, 98304
    s_cselect_b32 s5, s11, s5
    s_waitcnt vmcnt(8)
    s_barrier
    s_add_u32 m0, s5, 0
    s_nop 0
    buffer_load_dwordx4 v13, s[64:67], s7 offen  lds
    s_add_u32 m0, s5, 2048
    s_nop 0
    buffer_load_dwordx4 v14, s[64:67], s7 offen  lds
    s_add_u32 s7, s7, 98304
    s_cmp_eq_u32 s7, 1572864
    s_cselect_b32 s7, 0, s7
    s_add_u32 m0, s5, 4096
    s_nop 0
    buffer_load_dwordx4 v13, s[64:67], s7 offen  lds
    s_add_u32 m0, s5, 6144
    s_nop 0
    buffer_load_dwordx4 v14, s[64:67], s7 offen  lds
    s_add_u32 s7, s7, 98304
    s_cmp_eq_u32 s7, 1572864
    s_cselect_b32 s7, 0, s7
    s_add_u32 s5, s5, 8192
    s_cmp_ge_u32 s5, 98304
    s_cselect_b32 s5, s11, s5
    s_add_u32 m0, s5, 0
    s_nop 0
    buffer_load_dwordx4 v13, s[64:67], s7 offen  lds
    s_add_u32 m0, s5, 2048
    s_nop 0
    buffer_load_dwordx4 v14, s[64:67], s7 offen  lds
    s_add_u32 s7, s7, 98304
    s_cmp_eq_u32 s7, 1572864
    s_cselect_b32 s7, 0, s7
    s_add_u32 m0, s5, 4096
    s_nop 0
    buffer_load_dwordx4 v13, s[64:67], s7 offen  lds
    s_add_u32 m0, s5, 6144
    s_nop 0
    buffer_load_dwordx4 v14, s[64:67], s7 offen  lds
    s_add_u32 s7, s7, 98304
    s_cmp_eq_u32 s7, 1572864
    s_cselect_b32 s7, 0, s7
    s_add_u32 s5, s5, 8192
    s_cmp_ge_u32 s5, 98304
    s_cselect_b32 s5, s11, s5
    s_waitcnt vmcnt(12)
    s_barrier
    s_add_u32 m0, s5, 0
    s_nop 0
    buffer_load_dwordx4 v13, s[64:67], s7 offen  lds
    s_add_u32 m0, s5, 2048
    s_nop 0
    buffer_load_dwordx4 v14, s[64:67], s7 offen  lds
    s_add_u32 s7, s7, 98304
    s_cmp_eq_u32 s7, 1572864
    s_cselect_b32 s7, 0, s7
    s_add_u32 m0, s5, 4096
    s_nop 0
    buffer_load_dwordx4 v13, s[64:67], s7 offen  lds
    s_add_u32 m0, s5, 6144
    s_nop 0
    buffer_load_dwordx4 v14, s[64:67], s7 offen  lds
    s_add_u32 s7, s7, 98304
    s_cmp_eq_u32 s7, 1572864
    s_cselect_b32 s7, 0, s7
    s_add_u32 s5, s5, 8192
    s_cmp_ge_u32 s5, 98304
    s_cselect_b32 s5, s11, s5
    s_add_u32 m0, s5, 0
    s_nop 0
    buffer_load_dwordx4 v13, s[64:67], s7 offen  lds
    s_add_u32 m0, s5, 2048
    s_nop 0
    buffer_load_dwordx4 v14, s[64:67], s7 offen  lds
    s_add_u32 s7, s7, 98304
    s_cmp_eq_u32 s7, 1572864
    s_cselect_b32 s7, 0, s7
    s_add_u32 m0, s5, 4096
    s_nop 0
    buffer_load_dwordx4 v13, s[64:67], s7 offen  lds
    s_add_u32 m0, s5, 6144
    s_nop 0
    buffer_load_dwordx4 v14, s[64:67], s7 offen  lds
    s_add_u32 s7, s7, 98304
    s_cmp_eq_u32 s7, 1572864
    s_cselect_b32 s7, 0, s7
    s_add_u32 s5, s5, 8192
    s_cmp_ge_u32 s5, 98304
    s_cselect_b32 s5, s11, s5
    s_waitcnt vmcnt(16)
    s_barrier
    s_add_u32 m0, s5, 0
    s_nop 0
    buffer_load_dwordx4 v13, s[64:67], s7 offen  lds
    s_add_u32 m0, s5, 2048
    s_nop 0
    buffer_load_dwordx4 v14, s[64:67], s7 offen  lds
    s_add_u32 s7, s7, 98304
    s_cmp_eq_u32 s7, 1572864
    s_cselect_b32 s7, 0, s7
    s_add_u32 m0, s5, 4096
    s_nop 0
    buffer_load_dwordx4 v13, s[64:67], s7 offen  lds
    s_add_u32 m0, s5, 6144
    s_nop 0
    buffer_load_dwordx4 v14, s[64:67], s7 offen  lds
    s_add_u32 s7, s7, 98304
    s_cmp_eq_u32 s7, 1572864
    s_cselect_b32 s7, 0, s7
    s_add_u32 s5, s5, 8192
    s_cmp_ge_u32 s5, 98304
    s_cselect_b32 s5, s11, s5
    s_mov_b32 s12, s60
    s_mov_b32 s13, s61
    s_lshl_b32 s14, s61, 1
    s_and_b32 s14, s14, 15
    s_mul_i32 s7, s14, 98304
    s_add_u32 s5, s11, 65536
    s_add_u32 m0, s5, 0
    s_nop 0
    buffer_load_dwordx4 v12, s[64:67], s7 offen  lds
    s_add_u32 s7, s7, 98304
    s_cmp_eq_u32 s7, 1572864
    s_cselect_b32 s7, 0, s7
    s_add_u32 m0, s5, 2048
    s_nop 0
    buffer_load_dwordx4 v12, s[64:67], s7 offen  lds
    s_add_u32 s7, s7, 98304
    s_cmp_eq_u32 s7, 1572864
    s_cselect_b32 s7, 0, s7
    s_add_u32 m0, s5, 4096
    s_nop 0
    buffer_load_dwordx4 v12, s[64:67], s7 offen  lds
    s_add_u32 s7, s7, 98304
    s_cmp_eq_u32 s7, 1572864
    s_cselect_b32 s7, 0, s7
    s_add_u32 m0, s5, 6144
    s_nop 0
    buffer_load_dwordx4 v12, s[64:67], s7 offen  lds
    s_add_u32 s7, s7, 98304
    s_cmp_eq_u32 s7, 1572864
    s_cselect_b32 s7, 0, s7
    s_add_u32 s5, s5, 8192
    s_cmp_ge_u32 s5, 98304
    s_cselect_b32 s5, s11, s5
    s_waitcnt vmcnt(20)
    s_barrier
    s_add_u32 m0, s5, 0
    s_nop 0
    buffer_load_dwordx4 v12, s[64:67], s7 offen  lds
    s_add_u32 s7, s7, 98304
    s_cmp_eq_u32 s7, 1572864
    s_cselect_b32 s7, 0, s7
    s_add_u32 m0, s5, 2048
    s_nop 0
    buffer_load_dwordx4 v12, s[64:67], s7 offen  lds
    s_add_u32 s7, s7, 98304
    s_cmp_eq_u32 s7, 1572864
    s_cselect_b32 s7, 0, s7
    s_add_u32 m0, s5, 4096
    s_nop 0
    buffer_load_dwordx4 v12, s[64:67], s7 offen  lds
    s_add_u32 s7, s7, 98304
    s_cmp_eq_u32 s7, 1572864
    s_cselect_b32 s7, 0, s7
    s_add_u32 m0, s5, 6144
    s_nop 0
    buffer_load_dwordx4 v12, s[64:67], s7 offen  lds
    s_add_u32 s7, s7, 98304
    s_cmp_eq_u32 s7, 1572864
    s_cselect_b32 s7, 0, s7
    s_add_u32 s5, s5, 8192
    s_cmp_ge_u32 s5, 98304
    s_cselect_b32 s5, s11, s5
    s_add_u32 m0, s5, 0
    s_nop 0
    buffer_load_dwordx4 v12, s[64:67], s7 offen  lds
    s_add_u32 s7, s7, 98304
    s_cmp_eq_u32 s7, 1572864
    s_cselect_b32 s7, 0, s7
    s_add_u32 m0, s5, 2048
    s_nop 0
    buffer_load_dwordx4 v12, s[64:67], s7 offen  lds
    s_add_u32 s7, s7, 98304
    s_cmp_eq_u32 s7, 1572864
    s_cselect_b32 s7, 0, s7
    s_add_u32 m0, s5, 4096
    s_nop 0
    buffer_load_dwordx4 v12, s[64:67], s7 offen  lds
    s_add_u32 s7, s7, 98304
    s_cmp_eq_u32 s7, 1572864
    s_cselect_b32 s7, 0, s7
    s_add_u32 m0, s5, 6144
    s_nop 0
    buffer_load_dwordx4 v12, s[64:67], s7 offen  lds
    s_add_u32 s7, s7, 98304
    s_cmp_eq_u32 s7, 1572864
    s_cselect_b32 s7, 0, s7
    s_add_u32 s5, s5, 8192
    s_cmp_ge_u32 s5, 98304
    s_cselect_b32 s5, s11, s5
    s_lshl_b32 s53, s96, 1
    s_add_u32 s53, s53, s4
    s_lshl_b32 s53, s53, 10
    v_lshlrev_b32 v32, 7, v1
    s_mov_b64 exec, 0xff
    buffer_load_dword v31, v32, s[68:71], s53 offen
    s_mov_b64 exec, -1
    s_waitcnt vmcnt(25)
    s_barrier
    s_add_u32 m0, s5, 0
    s_nop 0
    buffer_load_dwordx4 v12, s[64:67], s7 offen  lds
    s_add_u32 s7, s7, 98304
    s_cmp_eq_u32 s7, 1572864
    s_cselect_b32 s7, 0, s7
    s_add_u32 m0, s5, 2048
    s_nop 0
    buffer_load_dwordx4 v12, s[64:67], s7 offen  lds
    s_add_u32 s7, s7, 98304
    s_cmp_eq_u32 s7, 1572864
    s_cselect_b32 s7, 0, s7
    s_add_u32 m0, s5, 4096
    s_nop 0
    buffer_load_dwordx4 v12, s[64:67], s7 offen  lds
    s_add_u32 s7, s7, 98304
    s_cmp_eq_u32 s7, 1572864
    s_cselect_b32 s7, 0, s7
    s_add_u32 m0, s5, 6144
    s_nop 0
    buffer_load_dwordx4 v12, s[64:67], s7 offen  lds
    s_add_u32 s7, s7, 98304
    s_cmp_eq_u32 s7, 1572864
    s_cselect_b32 s7, 0, s7
    s_add_u32 s5, s5, 8192
    s_cmp_ge_u32 s5, 98304
    s_cselect_b32 s5, s11, s5
    s_waitcnt vmcnt(25)
    s_barrier
    s_waitcnt vmcnt(21)
    s_barrier
    s_waitcnt vmcnt(17)
    s_barrier
    s_lshr_b32 s13, s61, 3
    s_lshl_b32 s12, s60, 1
    s_add_u32 s12, s12, s13
    s_and_b32 s13, s61, 7
    s_lshl_b32 s14, s13, 1
    s_mul_i32 s7, s14, 32768
    s_add_u32 s5, s11, 0
    s_add_u32 m0, s5, 0
    s_nop 0
    buffer_load_dwordx4 v18, s[68:71], s7 offen  lds
    s_add_u32 m0, s5, 2048
    s_nop 0
    buffer_load_dwordx4 v19, s[68:71], s7 offen  lds
    s_add_u32 s7, s7, 32768
    s_cmp_eq_u32 s7, 524288
    s_cselect_b32 s7, 0, s7
    s_add_u32 m0, s5, 4096
    s_nop 0
    buffer_load_dwordx4 v18, s[68:71], s7 offen  lds
    s_add_u32 m0, s5, 6144
    s_nop 0
    buffer_load_dwordx4 v19, s[68:71], s7 offen  lds
    s_add_u32 s7, s7, 32768
    s_cmp_eq_u32 s7, 524288
    s_cselect_b32 s7, 0, s7
    s_add_u32 s5, s5, 8192
    s_cmp_ge_u32 s5, 98304
    s_cselect_b32 s5, s11, s5
    s_add_u32 m0, s5, 0
    s_nop 0
    buffer_load_dwordx4 v18, s[68:71], s7 offen  lds
    s_add_u32 m0, s5, 2048
    s_nop 0
    buffer_load_dwordx4 v19, s[68:71], s7 offen  lds
    s_add_u32 s7, s7, 32768
    s_cmp_eq_u32 s7, 524288
    s_cselect_b32 s7, 0, s7
    s_add_u32 m0, s5, 4096
    s_nop 0
    buffer_load_dwordx4 v18, s[68:71], s7 offen  lds
    s_add_u32 m0, s5, 6144
    s_nop 0
    buffer_load_dwordx4 v19, s[68:71], s7 offen  lds
    s_add_u32 s7, s7, 32768
    s_cmp_eq_u32 s7, 524288
    s_cselect_b32 s7, 0, s7
    s_add_u32 s5, s5, 8192
    s_cmp_ge_u32 s5, 98304
    s_cselect_b32 s5, s11, s5
    s_barrier
    s_add_u32 m0, s5, 0
    s_nop 0
    buffer_load_dwordx4 v18, s[68:71], s7 offen  lds
    s_add_u32 m0, s5, 2048
    s_nop 0
    buffer_load_dwordx4 v19, s[68:71], s7 offen  lds
    s_add_u32 s7, s7, 32768
    s_cmp_eq_u32 s7, 524288
    s_cselect_b32 s7, 0, s7
    s_add_u32 m0, s5, 4096
    s_nop 0
    buffer_load_dwordx4 v18, s[68:71], s7 offen  lds
    s_add_u32 m0, s5, 6144
    s_nop 0
    buffer_load_dwordx4 v19, s[68:71], s7 offen  lds
    s_add_u32 s7, s7, 32768
    s_cmp_eq_u32 s7, 524288
    s_cselect_b32 s7, 0, s7
    s_add_u32 s5, s5, 8192
    s_cmp_ge_u32 s5, 98304
    s_cselect_b32 s5, s11, s5
    s_add_u32 m0, s5, 0
    s_nop 0
    buffer_load_dwordx4 v18, s[68:71], s7 offen  lds
    s_add_u32 m0, s5, 2048
    s_nop 0
    buffer_load_dwordx4 v19, s[68:71], s7 offen  lds
    s_add_u32 s7, s7, 32768
    s_cmp_eq_u32 s7, 524288
    s_cselect_b32 s7, 0, s7
    s_add_u32 m0, s5, 4096
    s_nop 0
    buffer_load_dwordx4 v18, s[68:71], s7 offen  lds
    s_add_u32 m0, s5, 6144
    s_nop 0
    buffer_load_dwordx4 v19, s[68:71], s7 offen  lds
    s_add_u32 s7, s7, 32768
    s_cmp_eq_u32 s7, 524288
    s_cselect_b32 s7, 0, s7
    s_add_u32 s5, s5, 8192
    s_cmp_ge_u32 s5, 98304
    s_cselect_b32 s5, s11, s5
    s_barrier
    s_and_b32 s53, s96, 31
    s_lshl_b32 s53, s53, 1
    s_add_u32 s53, s53, s4
    s_mul_i32 s53, s53, 8192
    v_lshlrev_b32 v32, 10, v1
    s_mov_b64 exec, 0xff
    buffer_load_dword v31, v32, s[68:71], s53 offen offset:384
    s_mov_b64 exec, -1
    s_waitcnt vmcnt(17)
    s_barrier
    s_mov_b32 s8, 4
L_bi_11_0:
    s_add_u32 m0, s5, 0
    s_nop 0
    buffer_load_dwordx4 v18, s[68:71], s7 offen  lds
    s_add_u32 m0, s5, 2048
    s_nop 0
    buffer_load_dwordx4 v19, s[68:71], s7 offen  lds
    s_add_u32 s7, s7, 32768
    s_cmp_eq_u32 s7, 524288
    s_cselect_b32 s7, 0, s7
    s_add_u32 m0, s5, 4096
    s_nop 0
    buffer_load_dwordx4 v18, s[68:71], s7 offen  lds
    s_add_u32 m0, s5, 6144
    s_nop 0
    buffer_load_dwordx4 v19, s[68:71], s7 offen  lds
    s_add_u32 s7, s7, 32768
    s_cmp_eq_u32 s7, 524288
    s_cselect_b32 s7, 0, s7
    s_add_u32 s5, s5, 8192
    s_cmp_ge_u32 s5, 98304
    s_cselect_b32 s5, s11, s5
    s_sub_u32 s8, s8, 1
    s_cmp_lg_u32 s8, 0
    s_cbranch_scc1 L_bi_11_0
    v_lshlrev_b32 v32, 8, v1
    s_lshl_b32 s55, s4, 7
    s_mul_i32 s53, s2, 5504
    s_add_u32 s53, s53, s55
    s_mov_b64 exec, 0x3fffff
    buffer_load_dword v31, v32, s[36:39], s53 offen
    buffer_load_dword v31, v32, s[40:43], s53 offen
    buffer_load_dword v31, v32, s[80:83], s53 offen
    s_mov_b64 exec, -1
    s_barrier
    s_mov_b32 s12, s60
    s_mov_b32 s13, s61
    s_mov_b32 s14, s61
    s_mul_i32 s7, s14, 88064
    s_add_u32 s5, s11, 73728
    s_add_u32 m0, s5, 0
    s_nop 0
    buffer_load_dwordx4 v20, s[72:75], s7 offen  lds
    s_add_u32 m0, s5, 2048
    s_nop 0
    buffer_load_dwordx4 v20, s[76:79], s7 offen  lds
    s_add_u32 m0, s5, 4096
    s_nop 0
    buffer_load_dwordx4 v21, s[72:75], s7 offen  lds
    s_add_u32 m0, s5, 6144
    s_nop 0
    buffer_load_dwordx4 v21, s[76:79], s7 offen  lds
    s_add_u32 m0, s5, 8192
    s_nop 0
    buffer_load_dwordx4 v22, s[72:75], s7 offen  lds
    s_add_u32 m0, s5, 10240
    s_nop 0
    buffer_load_dwordx4 v22, s[76:79], s7 offen  lds
    s_add_u32 s7, s7, 88064
    s_cmp_eq_u32 s7, 1409024
    s_cselect_b32 s7, 0, s7
    s_add_u32 m0, s5, 12288
    s_nop 0
    buffer_load_dwordx4 v20, s[72:75], s7 offen  lds
    s_add_u32 m0, s5, 14336
    s_nop 0
    buffer_load_dwordx4 v20, s[76:79], s7 offen  lds
    s_add_u32 m0, s5, 16384
    s_nop 0
    buffer_load_dwordx4 v21, s[72:75], s7 offen  lds
    s_add_u32 m0, s5, 18432
    s_nop 0
    buffer_load_dwordx4 v21, s[76:79], s7 offen  lds
    s_add_u32 m0, s5, 20480
    s_nop 0
    buffer_load_dwordx4 v22, s[72:75], s7 offen  lds
    s_add_u32 m0, s5, 22528
    s_nop 0
    buffer_load_dwordx4 v22, s[76:79], s7 offen  lds
    s_add_u32 s7, s7, 88064
    s_cmp_eq_u32 s7, 1409024
    s_cselect_b32 s7, 0, s7
    s_add_u32 s5, s5, 24576
    s_cmp_ge_u32 s5, 98304
    s_cselect_b32 s5, s11, s5
    s_barrier
    s_waitcnt vmcnt(44)
    s_barrier
    s_waitcnt vmcnt(40)
    s_barrier
    s_waitcnt vmcnt(36)
    s_barrier
    s_waitcnt vmcnt(32)
    s_barrier
    s_waitcnt vmcnt(27)
    s_barrier
    s_add_u32 m0, s5, 0
    s_nop 0
    buffer_load_dwordx4 v20, s[72:75], s7 offen  lds
    s_add_u32 m0, s5, 2048
    s_nop 0
    buffer_load_dwordx4 v20, s[76:79], s7 offen  lds
    s_add_u32 m0, s5, 4096
    s_nop 0
    buffer_load_dwordx4 v21, s[72:75], s7 offen  lds
    s_add_u32 m0, s5, 6144
    s_nop 0
    buffer_load_dwordx4 v21, s[76:79], s7 offen  lds
    s_add_u32 m0, s5, 8192
    s_nop 0
    buffer_load_dwordx4 v22, s[72:75], s7 offen  lds
    s_add_u32 m0, s5, 10240
    s_nop 0
    buffer_load_dwordx4 v22, s[76:79], s7 offen  lds
    s_add_u32 s7, s7, 88064
    s_cmp_eq_u32 s7, 1409024
    s_cselect_b32 s7, 0, s7
    s_add_u32 m0, s5, 12288
    s_nop 0
    buffer_load_dwordx4 v20, s[72:75], s7 offen  lds
    s_add_u32 m0, s5, 14336
    s_nop 0
    buffer_load_dwordx4 v20, s[76:79], s7 offen  lds
    s_add_u32 m0, s5, 16384
    s_nop 0
    buffer_load_dwordx4 v21, s[72:75], s7 offen  lds
    s_add_u32 m0, s5, 18432
    s_nop 0
    buffer_load_dwordx4 v21, s[76:79], s7 offen  lds
    s_add_u32 m0, s5, 20480
    s_nop 0
    buffer_load_dwordx4 v22, s[72:75], s7 offen  lds
    s_add_u32 m0, s5, 22528
    s_nop 0
    buffer_load_dwordx4 v22, s[76:79], s7 offen  lds
    s_add_u32 s7, s7, 88064
    s_cmp_eq_u32 s7, 1409024
    s_cselect_b32 s7, 0, s7
    s_add_u32 s5, s5, 24576
    s_cmp_ge_u32 s5, 98304
    s_cselect_b32 s5, s11, s5
    s_waitcnt vmcnt(35)
    s_barrier
    s_waitcnt vmcnt(31)
    s_barrier
    s_waitcnt vmcnt(27)
    s_barrier
    s_add_u32 m0, s5, 0
    s_nop 0
    buffer_load_dwordx4 v20, s[72:75], s7 offen  lds
    s_add_u32 m0, s5, 2048
    s_nop 0
    buffer_load_dwordx4 v20, s[76:79], s7 offen  lds
    s_add_u32 m0, s5, 4096
    s_nop 0
    buffer_load_dwordx4 v21, s[72:75], s7 offen  lds
    s_add_u32 m0, s5, 6144
    s_nop 0
    buffer_load_dwordx4 v21, s[76:79], s7 offen  lds
    s_add_u32 m0, s5, 8192
    s_nop 0
    buffer_load_dwordx4 v22, s[72:75], s7 offen  lds
    s_add_u32 m0, s5, 10240
    s_nop 0
    buffer_load_dwordx4 v22, s[76:79], s7 offen  lds
    s_add_u32 s7, s7, 88064
    s_cmp_eq_u32 s7, 1409024
    s_cselect_b32 s7, 0, s7
    s_add_u32 m0, s5, 12288
    s_nop 0
    buffer_load_dwordx4 v20, s[72:75], s7 offen  lds
    s_add_u32 m0, s5, 14336
    s_nop 0
    buffer_load_dwordx4 v20, s[76:79], s7 offen  lds
    s_add_u32 m0, s5, 16384
    s_nop 0
    buffer_load_dwordx4 v21, s[72:75], s7 offen  lds
    s_add_u32 m0, s5, 18432
    s_nop 0
    buffer_load_dwordx4 v21, s[76:79], s7 offen  lds
    s_add_u32 m0, s5, 20480
    s_nop 0
    buffer_load_dwordx4 v22, s[72:75], s7 offen  lds
    s_add_u32 m0, s5, 22528
    s_nop 0
    buffer_load_dwordx4 v22, s[76:79], s7 offen  lds
    s_add_u32 s7, s7, 88064
    s_cmp_eq_u32 s7, 1409024
    s_cselect_b32 s7, 0, s7
    s_add_u32 s5, s5, 24576
    s_cmp_ge_u32 s5, 98304
    s_cselect_b32 s5, s11, s5
    s_barrier
    s_barrier
    s_add_u32 m0, s5, 0
    s_nop 0
    buffer_load_dwordx4 v20, s[72:75], s7 offen  lds
    s_add_u32 m0, s5, 2048
    s_nop 0
    buffer_load_dwordx4 v20, s[76:79], s7 offen  lds
    s_add_u32 m0, s5, 4096
    s_nop 0
    buffer_load_dwordx4 v21, s[72:75], s7 offen  lds
    s_add_u32 m0, s5, 6144
    s_nop 0
    buffer_load_dwordx4 v21, s[76:79], s7 offen  lds
    s_add_u32 m0, s5, 8192
    s_nop 0
    buffer_load_dwordx4 v22, s[72:75], s7 offen  lds
    s_add_u32 m0, s5, 10240
    s_nop 0
    buffer_load_dwordx4 v22, s[76:79], s7 offen  lds
    s_add_u32 s7, s7, 88064
    s_cmp_eq_u32 s7, 1409024
    s_cselect_b32 s7, 0, s7
    s_add_u32 m0, s5, 12288
    s_nop 0
    buffer_load_dwordx4 v20, s[72:75], s7 offen  lds
    s_add_u32 m0, s5, 14336
    s_nop 0
    buffer_load_dwordx4 v20, s[76:79], s7 offen  lds
    s_add_u32 m0, s5, 16384
    s_nop 0
    buffer_load_dwordx4 v21, s[72:75], s7 offen  lds
    s_add_u32 m0, s5, 18432
    s_nop 0
    buffer_load_dwordx4 v21, s[76:79], s7 offen  lds
    s_add_u32 m0, s5, 20480
    s_nop 0
    buffer_load_dwordx4 v22, s[72:75], s7 offen  lds
    s_add_u32 m0, s5, 22528
    s_nop 0
    buffer_load_dwordx4 v22, s[76:79], s7 offen  lds
    s_add_u32 s7, s7, 88064
    s_cmp_eq_u32 s7, 1409024
    s_cselect_b32 s7, 0, s7
    s_add_u32 s5, s5, 24576
    s_cmp_ge_u32 s5, 98304
    s_cselect_b32 s5, s11, s5
    s_waitcnt vmcnt(36)
    s_barrier
    s_waitcnt vmcnt(24)
    s_barrier
    s_add_u32 m0, s5, 0
    s_nop 0
    buffer_load_dwordx4 v20, s[72:75], s7 offen  lds
    s_add_u32 m0, s5, 2048
    s_nop 0
    buffer_load_dwordx4 v20, s[76:79], s7 offen  lds
    s_add_u32 m0, s5, 4096
    s_nop 0
    buffer_load_dwordx4 v21, s[72:75], s7 offen  lds
    s_add_u32 m0, s5, 6144
    s_nop 0
    buffer_load_dwordx4 v21, s[76:79], s7 offen  lds
    s_add_u32 m0, s5, 8192
    s_nop 0
    buffer_load_dwordx4 v22, s[72:75], s7 offen  lds
    s_add_u32 m0, s5, 10240
    s_nop 0
    buffer_load_dwordx4 v22, s[76:79], s7 offen  lds
    s_add_u32 s7, s7, 88064
    s_cmp_eq_u32 s7, 1409024
    s_cselect_b32 s7, 0, s7
    s_add_u32 m0, s5, 12288
    s_nop 0
    buffer_load_dwordx4 v20, s[72:75], s7 offen  lds
    s_add_u32 m0, s5, 14336
    s_nop 0
    buffer_load_dwordx4 v20, s[76:79], s7 offen  lds
    s_add_u32 m0, s5, 16384
    s_nop 0
    buffer_load_dwordx4 v21, s[72:75], s7 offen  lds
    s_add_u32 m0, s5, 18432
    s_nop 0
    buffer_load_dwordx4 v21, s[76:79], s7 offen  lds
    s_add_u32 m0, s5, 20480
    s_nop 0
    buffer_load_dwordx4 v22, s[72:75], s7 offen  lds
    s_add_u32 m0, s5, 22528
    s_nop 0
    buffer_load_dwordx4 v22, s[76:79], s7 offen  lds
    s_add_u32 s7, s7, 88064
    s_cmp_eq_u32 s7, 1409024
    s_cselect_b32 s7, 0, s7
    s_add_u32 s5, s5, 24576
    s_cmp_ge_u32 s5, 98304
    s_cselect_b32 s5, s11, s5
    s_and_b32 s53, s96, 31
    s_lshl_b32 s53, s53, 1
    s_add_u32 s53, s53, s4
    s_mul_i32 s53, s53, 22528
    v_lshlrev_b32 v32, 10, v1
    s_mov_b64 exec, 0x3fffff
    buffer_load_dword v31, v32, s[80:83], s53 offen offset:384
    s_mov_b64 exec, -1
    s_waitcnt vmcnt(25)
    s_barrier
    s_mov_b32 s9, 2
L_bs_26:
    s_add_u32 m0, s5, 0
    s_nop 0
    buffer_load_dwordx4 v20, s[72:75], s7 offen  lds
    s_add_u32 m0, s5, 2048
    s_nop 0
    buffer_load_dwordx4 v20, s[76:79], s7 offen  lds
    s_add_u32 m0, s5, 4096
    s_nop 0
    buffer_load_dwordx4 v21, s[72:75], s7 offen  lds
    s_add_u32 m0, s5, 6144
    s_nop 0
    buffer_load_dwordx4 v21, s[76:79], s7 offen  lds
    s_add_u32 m0, s5, 8192
    s_nop 0
    buffer_load_dwordx4 v22, s[72:75], s7 offen  lds
    s_add_u32 m0, s5, 10240
    s_nop 0
    buffer_load_dwordx4 v22, s[76:79], s7 offen  lds
    s_add_u32 s7, s7, 88064
    s_cmp_eq_u32 s7, 1409024
    s_cselect_b32 s7, 0, s7
    s_add_u32 m0, s5, 12288
    s_nop 0
    buffer_load_dwordx4 v20, s[72:75], s7 offen  lds
    s_add_u32 m0, s5, 14336
    s_nop 0
    buffer_load_dwordx4 v20, s[76:79], s7 offen  lds
    s_add_u32 m0, s5, 16384
    s_nop 0
    buffer_load_dwordx4 v21, s[72:75], s7 offen  lds
    s_add_u32 m0, s5, 18432
    s_nop 0
    buffer_load_dwordx4 v21, s[76:79], s7 offen  lds
    s_add_u32 m0, s5, 20480
    s_nop 0
    buffer_load_dwordx4 v22, s[72:75], s7 offen  lds
    s_add_u32 m0, s5, 22528
    s_nop 0
    buffer_load_dwordx4 v22, s[76:79], s7 offen  lds
    s_add_u32 s7, s7, 88064
    s_cmp_eq_u32 s7, 1409024
    s_cselect_b32 s7, 0, s7
    s_add_u32 s5, s5, 24576
    s_cmp_ge_u32 s5, 98304
    s_cselect_b32 s5, s11, s5
    s_waitcnt vmcnt(25)
    s_barrier
    s_sub_u32 s9, s9, 1
    s_cmp_lg_u32 s9, 0
    s_cbranch_scc1 L_bs_26
    s_add_u32 m0, s5, 0
    s_nop 0
    buffer_load_dwordx4 v20, s[72:75], s7 offen  lds
    s_add_u32 m0, s5, 2048
    s_nop 0
    buffer_load_dwordx4 v20, s[76:79], s7 offen  lds
    s_add_u32 m0, s5, 4096
    s_nop 0
    buffer_load_dwordx4 v21, s[72:75], s7 offen  lds
    s_add_u32 m0, s5, 6144
    s_nop 0
    buffer_load_dwordx4 v21, s[76:79], s7 offen  lds
    s_add_u32 m0, s5, 8192
    s_nop 0
    buffer_load_dwordx4 v22, s[72:75], s7 offen  lds
    s_add_u32 m0, s5, 10240
    s_nop 0
    buffer_load_dwordx4 v22, s[76:79], s7 offen  lds
    s_add_u32 s7, s7, 88064
    s_cmp_eq_u32 s7, 1409024
    s_cselect_b32 s7, 0, s7
    s_add_u32 m0, s5, 12288
    s_nop 0
    buffer_load_dwordx4 v20, s[72:75], s7 offen  lds
    s_add_u32 m0, s5, 14336
    s_nop 0
    buffer_load_dwordx4 v20, s[76:79], s7 offen  lds
    s_add_u32 m0, s5, 16384
    s_nop 0
    buffer_load_dwordx4 v21, s[72:75], s7 offen  lds
    s_add_u32 m0, s5, 18432
    s_nop 0
    buffer_load_dwordx4 v21, s[76:79], s7 offen  lds
    s_add_u32 m0, s5, 20480
    s_nop 0
    buffer_load_dwordx4 v22, s[72:75], s7 offen  lds
    s_add_u32 m0, s5, 22528
    s_nop 0
    buffer_load_dwordx4 v22, s[76:79], s7 offen  lds
    s_add_u32 s7, s7, 88064
    s_cmp_eq_u32 s7, 1409024
    s_cselect_b32 s7, 0, s7
    s_add_u32 s5, s5, 24576
    s_cmp_ge_u32 s5, 98304
    s_cselect_b32 s5, s11, s5
    s_waitcnt vmcnt(24)
    s_barrier
    s_lshr_b32 s13, s61, 3
    s_lshl_b32 s12, s60, 1
    s_add_u32 s12, s12, s13
    s_and_b32 s13, s61, 7
    s_mul_i32 s14, s13, 5
    s_mul_i32 s7, s14, 32768
    s_add_u32 s5, s11, 81920
    s_add_u32 m0, s5, 0
    s_nop 0
    buffer_load_dwordx4 v18, s[80:83], s7 offen  lds
    s_add_u32 m0, s5, 2048
    s_nop 0
    buffer_load_dwordx4 v19, s[80:83], s7 offen  lds
    s_add_u32 s7, s7, 32768
    s_cmp_eq_u32 s7, 1441792
    s_cselect_b32 s7, 0, s7
    s_add_u32 s5, s5, 4096
    s_cmp_ge_u32 s5, 98304
    s_cselect_b32 s5, s11, s5
    s_mov_b32 s8, 3
L_bi_29_1:
    s_add_u32 m0, s5, 0
    s_nop 0
    buffer_load_dwordx4 v18, s[80:83], s7 offen  lds
    s_add_u32 m0, s5, 2048
    s_nop 0
    buffer_load_dwordx4 v19, s[80:83], s7 offen  lds
    s_add_u32 s7, s7, 32768
    s_cmp_eq_u32 s7, 1441792
    s_cselect_b32 s7, 0, s7
    s_add_u32 s5, s5, 4096
    s_cmp_ge_u32 s5, 98304
    s_cselect_b32 s5, s11, s5
    s_sub_u32 s8, s8, 1
    s_cmp_lg_u32 s8, 0
    s_cbranch_scc1 L_bi_29_1
    s_waitcnt vmcnt(20)
    s_barrier
    s_mov_b32 s8, 4
L_bi_30_0:
    s_add_u32 m0, s5, 0
    s_nop 0
    buffer_load_dwordx4 v18, s[80:83], s7 offen  lds
    s_add_u32 m0, s5, 2048
    s_nop 0
    buffer_load_dwordx4 v19, s[80:83], s7 offen  lds
    s_add_u32 s7, s7, 32768
    s_cmp_eq_u32 s7, 1441792
    s_cselect_b32 s7, 0, s7
    s_add_u32 s5, s5, 4096
    s_cmp_ge_u32 s5, 98304
    s_cselect_b32 s5, s11, s5
    s_sub_u32 s8, s8, 1
    s_cmp_lg_u32 s8, 0
    s_cbranch_scc1 L_bi_30_0
    s_waitcnt vmcnt(16)
    s_barrier
    s_mov_b32 s8, 4
L_bi_31_0:
    s_add_u32 m0, s5, 0
    s_nop 0
    buffer_load_dwordx4 v18, s[80:83], s7 offen  lds
    s_add_u32 m0, s5, 2048
    s_nop 0
    buffer_load_dwordx4 v19, s[80:83], s7 offen  lds
    s_add_u32 s7, s7, 32768
    s_cmp_eq_u32 s7, 1441792
    s_cselect_b32 s7, 0, s7
    s_add_u32 s5, s5, 4096
    s_cmp_ge_u32 s5, 98304
    s_cselect_b32 s5, s11, s5
    s_sub_u32 s8, s8, 1
    s_cmp_lg_u32 s8, 0
    s_cbranch_scc1 L_bi_31_0
    s_barrier
    s_mov_b32 s8, 4
L_bi_32_0:
    s_add_u32 m0, s5, 0
    s_nop 0
    buffer_load_dwordx4 v18, s[80:83], s7 offen  lds
    s_add_u32 m0, s5, 2048
    s_nop 0
    buffer_load_dwordx4 v19, s[80:83], s7 offen  lds
    s_add_u32 s7, s7, 32768
    s_cmp_eq_u32 s7, 1441792
    s_cselect_b32 s7, 0, s7
    s_add_u32 s5, s5, 4096
    s_cmp_ge_u32 s5, 98304
    s_cselect_b32 s5, s11, s5
    s_sub_u32 s8, s8, 1
    s_cmp_lg_u32 s8, 0
    s_cbranch_scc1 L_bi_32_0
    s_barrier
    s_mov_b32 s8, 4
L_bi_33_0:
    s_add_u32 m0, s5, 0
    s_nop 0
    buffer_load_dwordx4 v18, s[80:83], s7 offen  lds
    s_add_u32 m0, s5, 2048
    s_nop 0
    buffer_load_dwordx4 v19, s[80:83], s7 offen  lds
    s_add_u32 s7, s7, 32768
    s_cmp_eq_u32 s7, 1441792
    s_cselect_b32 s7, 0, s7
    s_add_u32 s5, s5, 4096
    s_cmp_ge_u32 s5, 98304
    s_cselect_b32 s5, s11, s5
    s_sub_u32 s8, s8, 1
    s_cmp_lg_u32 s8, 0
    s_cbranch_scc1 L_bi_33_0
    s_waitcnt vmcnt(36)
    s_barrier
    s_mov_b32 s8, 4
L_bi_34_0:
    s_add_u32 m0, s5, 0
    s_nop 0
    buffer_load_dwordx4 v18, s[80:83], s7 offen  lds
    s_add_u32 m0, s5, 2048
    s_nop 0
    buffer_load_dwordx4 v19, s[80:83], s7 offen  lds
    s_add_u32 s7, s7, 32768
    s_cmp_eq_u32 s7, 1441792
    s_cselect_b32 s7, 0, s7
    s_add_u32 s5, s5, 4096
    s_cmp_ge_u32 s5, 98304
    s_cselect_b32 s5, s11, s5
    s_sub_u32 s8, s8, 1
    s_cmp_lg_u32 s8, 0
    s_cbranch_scc1 L_bi_34_0
    s_waitcnt vmcnt(40)
    s_barrier
    s_waitcnt vmcnt(36)
    s_barrier
    s_add_u32 m0, s5, 0
    s_nop 0
    buffer_load_dwordx4 v18, s[80:83], s7 offen  lds
    s_add_u32 m0, s5, 2048
    s_nop 0
    buffer_load_dwordx4 v19, s[80:83], s7 offen  lds
    s_add_u32 s7, s7, 32768
    s_cmp_eq_u32 s7, 1441792
    s_cselect_b32 s7, 0, s7
    s_add_u32 s5, s5, 4096
    s_cmp_ge_u32 s5, 98304
    s_cselect_b32 s5, s11, s5
    s_waitcnt vmcnt(34)
    s_barrier
    s_add_u32 m0, s5, 0
    s_nop 0
    buffer_load_dwordx4 v18, s[80:83], s7 offen  lds
    s_add_u32 m0, s5, 2048
    s_nop 0
    buffer_load_dwordx4 v19, s[80:83], s7 offen  lds
    s_add_u32 s7, s7, 32768
    s_cmp_eq_u32 s7, 1441792
    s_cselect_b32 s7, 0, s7
    s_add_u32 s5, s5, 4096
    s_cmp_ge_u32 s5, 98304
    s_cselect_b32 s5, s11, s5
    s_and_b32 s53, s96, 31
    s_lshl_b32 s53, s53, 1
    s_add_u32 s53, s53, s4
    s_mul_i32 s53, s53, 24576
    v_lshlrev_b32 v32, 10, v1
    s_mov_b64 exec, 0xffffff
    buffer_load_dword v31, v32, s[64:67], s53 offen offset:384
    s_mov_b64 exec, -1
    s_waitcnt vmcnt(33)
    s_barrier
    s_add_u32 m0, s5, 0
    s_nop 0
    buffer_load_dwordx4 v18, s[80:83], s7 offen  lds
    s_add_u32 m0, s5, 2048
    s_nop 0
    buffer_load_dwordx4 v19, s[80:83], s7 offen  lds
    s_add_u32 s7, s7, 32768
    s_cmp_eq_u32 s7, 1441792
    s_cselect_b32 s7, 0, s7
    s_add_u32 s5, s5, 4096
    s_cmp_ge_u32 s5, 98304
    s_cselect_b32 s5, s11, s5
    s_waitcnt vmcnt(31)
    s_barrier
    s_add_u32 m0, s5, 0
    s_nop 0
    buffer_load_dwordx4 v18, s[80:83], s7 offen  lds
    s_add_u32 m0, s5, 2048
    s_nop 0
    buffer_load_dwordx4 v19, s[80:83], s7 offen  lds
    s_add_u32 s7, s7, 32768
    s_cmp_eq_u32 s7, 1441792
    s_cselect_b32 s7, 0, s7
    s_add_u32 s5, s5, 4096
    s_cmp_ge_u32 s5, 98304
    s_cselect_b32 s5, s11, s5
    s_waitcnt vmcnt(29)
    s_barrier
    s_add_u32 m0, s5, 0
    s_nop 0
    buffer_load_dwordx4 v18, s[80:83], s7 offen  lds
    s_add_u32 m0, s5, 2048
    s_nop 0
    buffer_load_dwordx4 v19, s[80:83], s7 offen  lds
    s_add_u32 s7, s7, 32768
    s_cmp_eq_u32 s7, 1441792
    s_cselect_b32 s7, 0, s7
    s_add_u32 s5, s5, 4096
    s_cmp_ge_u32 s5, 98304
    s_cselect_b32 s5, s11, s5
    s_waitcnt vmcnt(27)
    s_barrier
    s_add_u32 m0, s5, 0
    s_nop 0
    buffer_load_dwordx4 v18, s[80:83], s7 offen  lds
    s_add_u32 m0, s5, 2048
    s_nop 0
    buffer_load_dwordx4 v19, s[80:83], s7 offen  lds
    s_add_u32 s7, s7, 32768
    s_cmp_eq_u32 s7, 1441792
    s_cselect_b32 s7, 0, s7
    s_add_u32 s5, s5, 4096
    s_cmp_ge_u32 s5, 98304
    s_cselect_b32 s5, s11, s5
    s_waitcnt vmcnt(25)
    s_barrier
    s_add_u32 m0, s5, 0
    s_nop 0
    buffer_load_dwordx4 v18, s[80:83], s7 offen  lds
    s_add_u32 m0, s5, 2048
    s_nop 0
    buffer_load_dwordx4 v19, s[80:83], s7 offen  lds
    s_add_u32 s7, s7, 32768
    s_cmp_eq_u32 s7, 1441792
    s_cselect_b32 s7, 0, s7
    s_add_u32 s5, s5, 4096
    s_cmp_ge_u32 s5, 98304
    s_cselect_b32 s5, s11, s5
    s_waitcnt vmcnt(23)
    s_barrier
    s_add_u32 m0, s5, 0
    s_nop 0
    buffer_load_dwordx4 v18, s[80:83], s7 offen  lds
    s_add_u32 m0, s5, 2048
    s_nop 0
    buffer_load_dwordx4 v19, s[80:83], s7 offen  lds
    s_add_u32 s7, s7, 32768
    s_cmp_eq_u32 s7, 1441792
    s_cselect_b32 s7, 0, s7
    s_add_u32 s5, s5, 4096
    s_cmp_ge_u32 s5, 98304
    s_cselect_b32 s5, s11, s5
    s_waitcnt vmcnt(21)
    s_barrier
    s_add_u32 m0, s5, 0
    s_nop 0
    buffer_load_dwordx4 v18, s[80:83], s7 offen  lds
    s_add_u32 m0, s5, 2048
    s_nop 0
    buffer_load_dwordx4 v19, s[80:83], s7 offen  lds
    s_add_u32 s7, s7, 32768
    s_cmp_eq_u32 s7, 1441792
    s_cselect_b32 s7, 0, s7
    s_add_u32 s5, s5, 4096
    s_cmp_ge_u32 s5, 98304
    s_cselect_b32 s5, s11, s5
    s_waitcnt vmcnt(19)
    s_barrier
    s_add_u32 m0, s5, 0
    s_nop 0
    buffer_load_dwordx4 v18, s[80:83], s7 offen  lds
    s_add_u32 m0, s5, 2048
    s_nop 0
    buffer_load_dwordx4 v19, s[80:83], s7 offen  lds
    s_add_u32 s7, s7, 32768
    s_cmp_eq_u32 s7, 1441792
    s_cselect_b32 s7, 0, s7
    s_add_u32 s5, s5, 4096
    s_cmp_ge_u32 s5, 98304
    s_cselect_b32 s5, s11, s5
    s_waitcnt vmcnt(17)
    s_barrier
    s_add_u32 m0, s5, 0
    s_nop 0
    buffer_load_dwordx4 v18, s[80:83], s7 offen  lds
    s_add_u32 m0, s5, 2048
    s_nop 0
    buffer_load_dwordx4 v19, s[80:83], s7 offen  lds
    s_add_u32 s7, s7, 32768
    s_cmp_eq_u32 s7, 1441792
    s_cselect_b32 s7, 0, s7
    s_add_u32 s5, s5, 4096
    s_cmp_ge_u32 s5, 98304
    s_cselect_b32 s5, s11, s5
    s_waitcnt vmcnt(14)
    s_barrier
    s_add_u32 m0, s5, 0
    s_nop 0
    buffer_load_dwordx4 v18, s[80:83], s7 offen  lds
    s_add_u32 m0, s5, 2048
    s_nop 0
    buffer_load_dwordx4 v19, s[80:83], s7 offen  lds
    s_add_u32 s7, s7, 32768
    s_cmp_eq_u32 s7, 1441792
    s_cselect_b32 s7, 0, s7
    s_add_u32 s5, s5, 4096
    s_cmp_ge_u32 s5, 98304
    s_cselect_b32 s5, s11, s5
    s_waitcnt vmcnt(12)
    s_barrier
    s_mov_b32 s9, 4
L_bs_48:
    s_add_u32 m0, s5, 0
    s_nop 0
    buffer_load_dwordx4 v18, s[80:83], s7 offen  lds
    s_add_u32 m0, s5, 2048
    s_nop 0
    buffer_load_dwordx4 v19, s[80:83], s7 offen  lds
    s_add_u32 s7, s7, 32768
    s_cmp_eq_u32 s7, 1441792
    s_cselect_b32 s7, 0, s7
    s_add_u32 s5, s5, 4096
    s_cmp_ge_u32 s5, 98304
    s_cselect_b32 s5, s11, s5
    s_add_u32 m0, s5, 0
    s_nop 0
    buffer_load_dwordx4 v18, s[80:83], s7 offen  lds
    s_add_u32 m0, s5, 2048
    s_nop 0
    buffer_load_dwordx4 v19, s[80:83], s7 offen  lds
    s_add_u32 s7, s7, 32768
    s_cmp_eq_u32 s7, 1441792
    s_cselect_b32 s7, 0, s7
    s_add_u32 s5, s5, 4096
    s_cmp_ge_u32 s5, 98304
    s_cselect_b32 s5, s11, s5
    s_waitcnt vmcnt(12)
    s_barrier
    s_sub_u32 s9, s9, 1
    s_cmp_lg_u32 s9, 0
    s_cbranch_scc1 L_bs_48
    s_mov_b32 s12, s60
    s_mov_b32 s13, s61
    s_mov_b32 s14, s61
    s_mul_i32 s7, s14, 98304
    s_add_u32 s5, s11, 65536
    s_add_u32 m0, s5, 0
    s_nop 0
    buffer_load_dwordx4 v16, s[64:67], s7 offen  lds
    s_add_u32 m0, s5, 2048
    s_nop 0
    buffer_load_dwordx4 v17, s[64:67], s7 offen  lds
    s_add_u32 s7, s7, 98304
    s_cmp_eq_u32 s7, 1572864
    s_cselect_b32 s7, 0, s7
    s_add_u32 m0, s5, 4096
    s_nop 0
    buffer_load_dwordx4 v16, s[64:67], s7 offen  lds
    s_add_u32 m0, s5, 6144
    s_nop 0
    buffer_load_dwordx4 v17, s[64:67], s7 offen  lds
    s_add_u32 s7, s7, 98304
    s_cmp_eq_u32 s7, 1572864
    s_cselect_b32 s7, 0, s7
    s_add_u32 s5, s5, 8192
    s_cmp_ge_u32 s5, 98304
    s_cselect_b32 s5, s11, s5
    s_add_u32 m0, s5, 0
    s_nop 0
    buffer_load_dwordx4 v16, s[64:67], s7 offen  lds
    s_add_u32 m0, s5, 2048
    s_nop 0
    buffer_load_dwordx4 v17, s[64:67], s7 offen  lds
    s_add_u32 s7, s7, 98304
    s_cmp_eq_u32 s7, 1572864
    s_cselect_b32 s7, 0, s7
    s_add_u32 m0, s5, 4096
    s_nop 0
    buffer_load_dwordx4 v16, s[64:67], s7 offen  lds
    s_add_u32 m0, s5, 6144
    s_nop 0
    buffer_load_dwordx4 v17, s[64:67], s7 offen  lds
    s_add_u32 s7, s7, 98304
    s_cmp_eq_u32 s7, 1572864
    s_cselect_b32 s7, 0, s7
    s_add_u32 s5, s5, 8192
    s_cmp_ge_u32 s5, 98304
    s_cselect_b32 s5, s11, s5
    s_waitcnt vmcnt(16)
    s_barrier
    s_add_u32 m0, s5, 0
    s_nop 0
    buffer_load_dwordx4 v16, s[64:67], s7 offen  lds
    s_add_u32 m0, s5, 2048
    s_nop 0
    buffer_load_dwordx4 v17, s[64:67], s7 offen  lds
    s_add_u32 s7, s7, 98304
    s_cmp_eq_u32 s7, 1572864
    s_cselect_b32 s7, 0, s7
    s_add_u32 m0, s5, 4096
    s_nop 0
    buffer_load_dwordx4 v16, s[64:67], s7 offen  lds
    s_add_u32 m0, s5, 6144
    s_nop 0
    buffer_load_dwordx4 v17, s[64:67], s7 offen  lds
    s_add_u32 s7, s7, 98304
    s_cmp_eq_u32 s7, 1572864
    s_cselect_b32 s7, 0, s7
    s_add_u32 s5, s5, 8192
    s_cmp_ge_u32 s5, 98304
    s_cselect_b32 s5, s11, s5
    s_add_u32 m0, s5, 0
    s_nop 0
    buffer_load_dwordx4 v16, s[64:67], s7 offen  lds
    s_add_u32 m0, s5, 2048
    s_nop 0
    buffer_load_dwordx4 v17, s[64:67], s7 offen  lds
    s_add_u32 s7, s7, 98304
    s_cmp_eq_u32 s7, 1572864
    s_cselect_b32 s7, 0, s7
    s_add_u32 m0, s5, 4096
    s_nop 0
    buffer_load_dwordx4 v16, s[64:67], s7 offen  lds
    s_add_u32 m0, s5, 6144
    s_nop 0
    buffer_load_dwordx4 v17, s[64:67], s7 offen  lds
    s_add_u32 s7, s7, 98304
    s_cmp_eq_u32 s7, 1572864
    s_cselect_b32 s7, 0, s7
    s_add_u32 s5, s5, 8192
    s_cmp_ge_u32 s5, 98304
    s_cselect_b32 s5, s11, s5
    s_waitcnt vmcnt(20)
    s_barrier
    s_add_u32 m0, s5, 0
    s_nop 0
    buffer_load_dwordx4 v16, s[64:67], s7 offen  lds
    s_add_u32 m0, s5, 2048
    s_nop 0
    buffer_load_dwordx4 v17, s[64:67], s7 offen  lds
    s_add_u32 s7, s7, 98304
    s_cmp_eq_u32 s7, 1572864
    s_cselect_b32 s7, 0, s7
    s_add_u32 m0, s5, 4096
    s_nop 0
    buffer_load_dwordx4 v16, s[64:67], s7 offen  lds
    s_add_u32 m0, s5, 6144
    s_nop 0
    buffer_load_dwordx4 v17, s[64:67], s7 offen  lds
    s_add_u32 s7, s7, 98304
    s_cmp_eq_u32 s7, 1572864
    s_cselect_b32 s7, 0, s7
    s_add_u32 s5, s5, 8192
    s_cmp_ge_u32 s5, 98304
    s_cselect_b32 s5, s11, s5
    s_add_u32 m0, s5, 0
    s_nop 0
    buffer_load_dwordx4 v16, s[64:67], s7 offen  lds
    s_add_u32 m0, s5, 2048
    s_nop 0
    buffer_load_dwordx4 v17, s[64:67], s7 offen  lds
    s_add_u32 s7, s7, 98304
    s_cmp_eq_u32 s7, 1572864
    s_cselect_b32 s7, 0, s7
    s_add_u32 m0, s5, 4096
    s_nop 0
    buffer_load_dwordx4 v16, s[64:67], s7 offen  lds
    s_add_u32 m0, s5, 6144
    s_nop 0
    buffer_load_dwordx4 v17, s[64:67], s7 offen  lds
    s_add_u32 s7, s7, 98304
    s_cmp_eq_u32 s7, 1572864
    s_cselect_b32 s7, 0, s7
    s_add_u32 s5, s5, 8192
    s_cmp_ge_u32 s5, 98304
    s_cselect_b32 s5, s11, s5
    s_waitcnt vmcnt(24)
    s_barrier
    s_add_u32 m0, s5, 0
    s_nop 0
    buffer_load_dwordx4 v16, s[64:67], s7 offen  lds
    s_add_u32 m0, s5, 2048
    s_nop 0
    buffer_load_dwordx4 v17, s[64:67], s7 offen  lds
    s_add_u32 s7, s7, 98304
    s_cmp_eq_u32 s7, 1572864
    s_cselect_b32 s7, 0, s7
    s_add_u32 m0, s5, 4096
    s_nop 0
    buffer_load_dwordx4 v16, s[64:67], s7 offen  lds
    s_add_u32 m0, s5, 6144
    s_nop 0
    buffer_load_dwordx4 v17, s[64:67], s7 offen  lds
    s_add_u32 s7, s7, 98304
    s_cmp_eq_u32 s7, 1572864
    s_cselect_b32 s7, 0, s7
    s_add_u32 s5, s5, 8192
    s_cmp_ge_u32 s5, 98304
    s_cselect_b32 s5, s11, s5
    s_add_u32 m0, s5, 0
    s_nop 0
    buffer_load_dwordx4 v16, s[64:67], s7 offen  lds
    s_add_u32 m0, s5, 2048
    s_nop 0
    buffer_load_dwordx4 v17, s[64:67], s7 offen  lds
    s_add_u32 s7, s7, 98304
    s_cmp_eq_u32 s7, 1572864
    s_cselect_b32 s7, 0, s7
    s_add_u32 m0, s5, 4096
    s_nop 0
    buffer_load_dwordx4 v16, s[64:67], s7 offen  lds
    s_add_u32 m0, s5, 6144
    s_nop 0
    buffer_load_dwordx4 v17, s[64:67], s7 offen  lds
    s_add_u32 s7, s7, 98304
    s_cmp_eq_u32 s7, 1572864
    s_cselect_b32 s7, 0, s7
    s_add_u32 s5, s5, 8192
    s_cmp_ge_u32 s5, 98304
    s_cselect_b32 s5, s11, s5
    s_barrier
    s_mov_b32 s12, s60
    s_mov_b32 s13, s61
    s_mov_b32 s14, s61
    s_mul_i32 s7, s14, 98304
    s_add_u32 s5, s11, 32768
    s_add_u32 m0, s5, 0
    s_nop 0
    buffer_load_dwordx4 v15, s[64:67], s7 offen  lds
    s_add_u32 s7, s7, 98304
    s_cmp_eq_u32 s7, 1572864
    s_cselect_b32 s7, 0, s7
    s_add_u32 m0, s5, 2048
    s_nop 0
    buffer_load_dwordx4 v15, s[64:67], s7 offen  lds
    s_add_u32 s7, s7, 98304
    s_cmp_eq_u32 s7, 1572864
    s_cselect_b32 s7, 0, s7
    s_add_u32 m0, s5, 4096
    s_nop 0
    buffer_load_dwordx4 v15, s[64:67], s7 offen  lds
    s_add_u32 s7, s7, 98304
    s_cmp_eq_u32 s7, 1572864
    s_cselect_b32 s7, 0, s7
    s_add_u32 m0, s5, 6144
    s_nop 0
    buffer_load_dwordx4 v15, s[64:67], s7 offen  lds
    s_add_u32 s7, s7, 98304
    s_cmp_eq_u32 s7, 1572864
    s_cselect_b32 s7, 0, s7
    s_add_u32 s5, s5, 8192
    s_cmp_ge_u32 s5, 98304
    s_cselect_b32 s5, s11, s5
    s_add_u32 m0, s5, 0
    s_nop 0
    buffer_load_dwordx4 v15, s[64:67], s7 offen  lds
    s_add_u32 s7, s7, 98304
    s_cmp_eq_u32 s7, 1572864
    s_cselect_b32 s7, 0, s7
    s_add_u32 m0, s5, 2048
    s_nop 0
    buffer_load_dwordx4 v15, s[64:67], s7 offen  lds
    s_add_u32 s7, s7, 98304
    s_cmp_eq_u32 s7, 1572864
    s_cselect_b32 s7, 0, s7
    s_add_u32 m0, s5, 4096
    s_nop 0
    buffer_load_dwordx4 v15, s[64:67], s7 offen  lds
    s_add_u32 s7, s7, 98304
    s_cmp_eq_u32 s7, 1572864
    s_cselect_b32 s7, 0, s7
    s_add_u32 m0, s5, 6144
    s_nop 0
    buffer_load_dwordx4 v15, s[64:67], s7 offen  lds
    s_add_u32 s7, s7, 98304
    s_cmp_eq_u32 s7, 1572864
    s_cselect_b32 s7, 0, s7
    s_add_u32 s5, s5, 8192
    s_cmp_ge_u32 s5, 98304
    s_cselect_b32 s5, s11, s5
    s_barrier
    s_add_u32 m0, s5, 0
    s_nop 0
    buffer_load_dwordx4 v15, s[64:67], s7 offen  lds
    s_add_u32 s7, s7, 98304
    s_cmp_eq_u32 s7, 1572864
    s_cselect_b32 s7, 0, s7
    s_add_u32 m0, s5, 2048
    s_nop 0
    buffer_load_dwordx4 v15, s[64:67], s7 offen  lds
    s_add_u32 s7, s7, 98304
    s_cmp_eq_u32 s7, 1572864
    s_cselect_b32 s7, 0, s7
    s_add_u32 m0, s5, 4096
    s_nop 0
    buffer_load_dwordx4 v15, s[64:67], s7 offen  lds
    s_add_u32 s7, s7, 98304
    s_cmp_eq_u32 s7, 1572864
    s_cselect_b32 s7, 0, s7
    s_add_u32 m0, s5, 6144
    s_nop 0
    buffer_load_dwordx4 v15, s[64:67], s7 offen  lds
    s_add_u32 s7, s7, 98304
    s_cmp_eq_u32 s7, 1572864
    s_cselect_b32 s7, 0, s7
    s_add_u32 s5, s5, 8192
    s_cmp_ge_u32 s5, 98304
    s_cselect_b32 s5, s11, s5
    s_add_u32 m0, s5, 0
    s_nop 0
    buffer_load_dwordx4 v15, s[64:67], s7 offen  lds
    s_add_u32 s7, s7, 98304
    s_cmp_eq_u32 s7, 1572864
    s_cselect_b32 s7, 0, s7
    s_add_u32 m0, s5, 2048
    s_nop 0
    buffer_load_dwordx4 v15, s[64:67], s7 offen  lds
    s_add_u32 s7, s7, 98304
    s_cmp_eq_u32 s7, 1572864
    s_cselect_b32 s7, 0, s7
    s_add_u32 m0, s5, 4096
    s_nop 0
    buffer_load_dwordx4 v15, s[64:67], s7 offen  lds
    s_add_u32 s7, s7, 98304
    s_cmp_eq_u32 s7, 1572864
    s_cselect_b32 s7, 0, s7
    s_add_u32 m0, s5, 6144
    s_nop 0
    buffer_load_dwordx4 v15, s[64:67], s7 offen  lds
    s_add_u32 s7, s7, 98304
    s_cmp_eq_u32 s7, 1572864
    s_cselect_b32 s7, 0, s7
    s_add_u32 s5, s5, 8192
    s_cmp_ge_u32 s5, 98304
    s_cselect_b32 s5, s11, s5
    s_waitcnt vmcnt(44)
    s_barrier
    s_waitcnt vmcnt(40)
    s_barrier
    s_waitcnt vmcnt(36)
    s_barrier
    s_waitcnt vmcnt(32)
    s_barrier
    s_waitcnt vmcnt(28)
    s_barrier
    s_waitcnt vmcnt(24)
    s_barrier
    s_waitcnt vmcnt(20)
    s_barrier
    s_waitcnt vmcnt(16)
    s_barrier
    s_mov_b32 s9, 2
L_bs_65:
    s_barrier
    s_sub_u32 s9, s9, 1
    s_cmp_lg_u32 s9, 0
    s_cbranch_scc1 L_bs_65
    s_and_b32 s53, s96, 31
    s_lshl_b32 s53, s53, 1
    s_add_u32 s53, s53, s4
    s_mul_i32 s53, s53, 8192
    v_lshlrev_b32 v32, 10, v1
    s_mov_b64 exec, 0xff
    buffer_load_dword v31, v32, s[68:71], s53 offen offset:384
    s_mov_b64 exec, -1
    s_waitcnt vmcnt(1)
    s_barrier
    s_lshr_b32 s13, s61, 3
    s_lshl_b32 s12, s60, 1
    s_add_u32 s12, s12, s13
    s_and_b32 s13, s61, 7
    s_lshl_b32 s14, s13, 1
    s_mul_i32 s7, s14, 32768
    s_add_u32 s5, s11, 65536
    s_add_u32 m0, s5, 0
    s_nop 0
    buffer_load_dwordx4 v18, s[68:71], s7 offen  lds
    s_add_u32 m0, s5, 2048
    s_nop 0
    buffer_load_dwordx4 v19, s[68:71], s7 offen  lds
    s_add_u32 s7, s7, 32768
    s_cmp_eq_u32 s7, 524288
    s_cselect_b32 s7, 0, s7
    s_add_u32 m0, s5, 4096
    s_nop 0
    buffer_load_dwordx4 v18, s[68:71], s7 offen  lds
    s_add_u32 m0, s5, 6144
    s_nop 0
    buffer_load_dwordx4 v19, s[68:71], s7 offen  lds
    s_add_u32 s7, s7, 32768
    s_cmp_eq_u32 s7, 524288
    s_cselect_b32 s7, 0, s7
    s_add_u32 s5, s5, 8192
    s_cmp_ge_u32 s5, 98304
    s_cselect_b32 s5, s11, s5
    s_mov_b32 s8, 7
L_bi_68_1:
    s_add_u32 m0, s5, 0
    s_nop 0
    buffer_load_dwordx4 v18, s[68:71], s7 offen  lds
    s_add_u32 m0, s5, 2048
    s_nop 0
    buffer_load_dwordx4 v19, s[68:71], s7 offen  lds
    s_add_u32 s7, s7, 32768
    s_cmp_eq_u32 s7, 524288
    s_cselect_b32 s7, 0, s7
    s_add_u32 m0, s5, 4096
    s_nop 0
    buffer_load_dwordx4 v18, s[68:71], s7 offen  lds
    s_add_u32 m0, s5, 6144
    s_nop 0
    buffer_load_dwordx4 v19, s[68:71], s7 offen  lds
    s_add_u32 s7, s7, 32768
    s_cmp_eq_u32 s7, 524288
    s_cselect_b32 s7, 0, s7
    s_add_u32 s5, s5, 8192
    s_cmp_ge_u32 s5, 98304
    s_cselect_b32 s5, s11, s5
    s_sub_u32 s8, s8, 1
    s_cmp_lg_u32 s8, 0
    s_cbranch_scc1 L_bi_68_1
    s_barrier
    s_barrier
    s_waitcnt vmcnt(28)
    s_barrier
    s_waitcnt vmcnt(24)
    s_barrier
    s_waitcnt vmcnt(20)
    s_barrier
    s_mov_b32 s12, s60
    s_mov_b32 s13, s61
    s_mov_b32 s14, s61
    s_mul_i32 s7, s14, 88064
    s_add_u32 s5, s11, 49152
    s_add_u32 m0, s5, 0
    s_nop 0
    buffer_load_dwordx4 v20, s[72:75], s7 offen  lds
    s_add_u32 m0, s5, 2048
    s_nop 0
    buffer_load_dwordx4 v20, s[76:79], s7 offen  lds
    s_add_u32 m0, s5, 4096
    s_nop 0
    buffer_load_dwordx4 v21, s[72:75], s7 offen  lds
    s_add_u32 m0, s5, 6144
    s_nop 0
    buffer_load_dwordx4 v21, s[76:79], s7 offen  lds
    s_add_u32 m0, s5, 8192
    s_nop 0
    buffer_load_dwordx4 v22, s[72:75], s7 offen  lds
    s_add_u32 m0, s5, 10240
    s_nop 0
    buffer_load_dwordx4 v22, s[76:79], s7 offen  lds
    s_add_u32 s7, s7, 88064
    s_cmp_eq_u32 s7, 1409024
    s_cselect_b32 s7, 0, s7
    s_add_u32 m0, s5, 12288
    s_nop 0
    buffer_load_dwordx4 v20, s[72:75], s7 offen  lds
    s_add_u32 m0, s5, 14336
    s_nop 0
    buffer_load_dwordx4 v20, s[76:79], s7 offen  lds
    s_add_u32 m0, s5, 16384
    s_nop 0
    buffer_load_dwordx4 v21, s[72:75], s7 offen  lds
    s_add_u32 m0, s5, 18432
    s_nop 0
    buffer_load_dwordx4 v21, s[76:79], s7 offen  lds
    s_add_u32 m0, s5, 20480
    s_nop 0
    buffer_load_dwordx4 v22, s[72:75], s7 offen  lds
    s_add_u32 m0, s5, 22528
    s_nop 0
    buffer_load_dwordx4 v22, s[76:79], s7 offen  lds
    s_add_u32 s7, s7, 88064
    s_cmp_eq_u32 s7, 1409024
    s_cselect_b32 s7, 0, s7
    s_add_u32 s5, s5, 24576
    s_cmp_ge_u32 s5, 98304
    s_cselect_b32 s5, s11, s5
    s_waitcnt vmcnt(28)
    s_barrier
    s_waitcnt vmcnt(24)
    s_barrier
    s_waitcnt vmcnt(20)
    s_barrier
    s_add_u32 m0, s5, 0
    s_nop 0
    buffer_load_dwordx4 v20, s[72:75], s7 offen  lds
    s_add_u32 m0, s5, 2048
    s_nop 0
    buffer_load_dwordx4 v20, s[76:79], s7 offen  lds
    s_add_u32 m0, s5, 4096
    s_nop 0
    buffer_load_dwordx4 v21, s[72:75], s7 offen  lds
    s_add_u32 m0, s5, 6144
    s_nop 0
    buffer_load_dwordx4 v21, s[76:79], s7 offen  lds
    s_add_u32 m0, s5, 8192
    s_nop 0
    buffer_load_dwordx4 v22, s[72:75], s7 offen  lds
    s_add_u32 m0, s5, 10240
    s_nop 0
    buffer_load_dwordx4 v22, s[76:79], s7 offen  lds
    s_add_u32 s7, s7, 88064
    s_cmp_eq_u32 s7, 1409024
    s_cselect_b32 s7, 0, s7
    s_add_u32 m0, s5, 12288
    s_nop 0
    buffer_load_dwordx4 v20, s[72:75], s7 offen  lds
    s_add_u32 m0, s5, 14336
    s_nop 0
    buffer_load_dwordx4 v20, s[76:79], s7 offen  lds
    s_add_u32 m0, s5, 16384
    s_nop 0
    buffer_load_dwordx4 v21, s[72:75], s7 offen  lds
    s_add_u32 m0, s5, 18432
    s_nop 0
    buffer_load_dwordx4 v21, s[76:79], s7 offen  lds
    s_add_u32 m0, s5, 20480
    s_nop 0
    buffer_load_dwordx4 v22, s[72:75], s7 offen  lds
    s_add_u32 m0, s5, 22528
    s_nop 0
    buffer_load_dwordx4 v22, s[76:79], s7 offen  lds
    s_add_u32 s7, s7, 88064
    s_cmp_eq_u32 s7, 1409024
    s_cselect_b32 s7, 0, s7
    s_add_u32 s5, s5, 24576
    s_cmp_ge_u32 s5, 98304
    s_cselect_b32 s5, s11, s5
    s_waitcnt vmcnt(28)
    s_barrier
    s_waitcnt vmcnt(24)
    s_barrier
    s_barrier
    s_add_u32 m0, s5, 0
    s_nop 0
    buffer_load_dwordx4 v20, s[72:75], s7 offen  lds
    s_add_u32 m0, s5, 2048
    s_nop 0
    buffer_load_dwordx4 v20, s[76:79], s7 offen  lds
    s_add_u32 m0, s5, 4096
    s_nop 0
    buffer_load_dwordx4 v21, s[72:75], s7 offen  lds
    s_add_u32 m0, s5, 6144
    s_nop 0
    buffer_load_dwordx4 v21, s[76:79], s7 offen  lds
    s_add_u32 m0, s5, 8192
    s_nop 0
    buffer_load_dwordx4 v22, s[72:75], s7 offen  lds
    s_add_u32 m0, s5, 10240
    s_nop 0
    buffer_load_dwordx4 v22, s[76:79], s7 offen  lds
    s_add_u32 s7, s7, 88064
    s_cmp_eq_u32 s7, 1409024
    s_cselect_b32 s7, 0, s7
    s_add_u32 m0, s5, 12288
    s_nop 0
    buffer_load_dwordx4 v20, s[72:75], s7 offen  lds
    s_add_u32 m0, s5, 14336
    s_nop 0
    buffer_load_dwordx4 v20, s[76:79], s7 offen  lds
    s_add_u32 m0, s5, 16384
    s_nop 0
    buffer_load_dwordx4 v21, s[72:75], s7 offen  lds
    s_add_u32 m0, s5, 18432
    s_nop 0
    buffer_load_dwordx4 v21, s[76:79], s7 offen  lds
    s_add_u32 m0, s5, 20480
    s_nop 0
    buffer_load_dwordx4 v22, s[72:75], s7 offen  lds
    s_add_u32 m0, s5, 22528
    s_nop 0
    buffer_load_dwordx4 v22, s[76:79], s7 offen  lds
    s_add_u32 s7, s7, 88064
    s_cmp_eq_u32 s7, 1409024
    s_cselect_b32 s7, 0, s7
    s_add_u32 s5, s5, 24576
    s_cmp_ge_u32 s5, 98304
    s_cselect_b32 s5, s11, s5
    s_barrier
    s_add_u32 m0, s5, 0
    s_nop 0
    buffer_load_dwordx4 v20, s[72:75], s7 offen  lds
    s_add_u32 m0, s5, 2048
    s_nop 0
    buffer_load_dwordx4 v20, s[76:79], s7 offen  lds
    s_add_u32 m0, s5, 4096
    s_nop 0
    buffer_load_dwordx4 v21, s[72:75], s7 offen  lds
    s_add_u32 m0, s5, 6144
    s_nop 0
    buffer_load_dwordx4 v21, s[76:79], s7 offen  lds
    s_add_u32 m0, s5, 8192
    s_nop 0
    buffer_load_dwordx4 v22, s[72:75], s7 offen  lds
    s_add_u32 m0, s5, 10240
    s_nop 0
    buffer_load_dwordx4 v22, s[76:79], s7 offen  lds
    s_add_u32 s7, s7, 88064
    s_cmp_eq_u32 s7, 1409024
    s_cselect_b32 s7, 0, s7
    s_add_u32 m0, s5, 12288
    s_nop 0
    buffer_load_dwordx4 v20, s[72:75], s7 offen  lds
    s_add_u32 m0, s5, 14336
    s_nop 0
    buffer_load_dwordx4 v20, s[76:79], s7 offen  lds
    s_add_u32 m0, s5, 16384
    s_nop 0
    buffer_load_dwordx4 v21, s[72:75], s7 offen  lds
    s_add_u32 m0, s5, 18432
    s_nop 0
    buffer_load_dwordx4 v21, s[76:79], s7 offen  lds
    s_add_u32 m0, s5, 20480
    s_nop 0
    buffer_load_dwordx4 v22, s[72:75], s7 offen  lds
    s_add_u32 m0, s5, 22528
    s_nop 0
    buffer_load_dwordx4 v22, s[76:79], s7 offen  lds
    s_add_u32 s7, s7, 88064
    s_cmp_eq_u32 s7, 1409024
    s_cselect_b32 s7, 0, s7
    s_add_u32 s5, s5, 24576
    s_cmp_ge_u32 s5, 98304
    s_cselect_b32 s5, s11, s5
    s_waitcnt vmcnt(36)
    s_barrier
    s_waitcnt vmcnt(24)
    s_barrier
    s_add_u32 m0, s5, 0
    s_nop 0
    buffer_load_dwordx4 v20, s[72:75], s7 offen  lds
    s_add_u32 m0, s5, 2048
    s_nop 0
    buffer_load_dwordx4 v20, s[76:79], s7 offen  lds
    s_add_u32 m0, s5, 4096
    s_nop 0
    buffer_load_dwordx4 v21, s[72:75], s7 offen  lds
    s_add_u32 m0, s5, 6144
    s_nop 0
    buffer_load_dwordx4 v21, s[76:79], s7 offen  lds
    s_add_u32 m0, s5, 8192
    s_nop 0
    buffer_load_dwordx4 v22, s[72:75], s7 offen  lds
    s_add_u32 m0, s5, 10240
    s_nop 0
    buffer_load_dwordx4 v22, s[76:79], s7 offen  lds
    s_add_u32 s7, s7, 88064
    s_cmp_eq_u32 s7, 1409024
    s_cselect_b32 s7, 0, s7
    s_add_u32 m0, s5, 12288
    s_nop 0
    buffer_load_dwordx4 v20, s[72:75], s7 offen  lds
    s_add_u32 m0, s5, 14336
    s_nop 0
    buffer_load_dwordx4 v20, s[76:79], s7 offen  lds
    s_add_u32 m0, s5, 16384
    s_nop 0
    buffer_load_dwordx4 v21, s[72:75], s7 offen  lds
    s_add_u32 m0, s5, 18432
    s_nop 0
    buffer_load_dwordx4 v21, s[76:79], s7 offen  lds
    s_add_u32 m0, s5, 20480
    s_nop 0
    buffer_load_dwordx4 v22, s[72:75], s7 offen  lds
    s_add_u32 m0, s5, 22528
    s_nop 0
    buffer_load_dwordx4 v22, s[76:79], s7 offen  lds
    s_add_u32 s7, s7, 88064
    s_cmp_eq_u32 s7, 1409024
    s_cselect_b32 s7, 0, s7
    s_add_u32 s5, s5, 24576
    s_cmp_ge_u32 s5, 98304
    s_cselect_b32 s5, s11, s5
    s_and_b32 s53, s96, 31
    s_lshl_b32 s53, s53, 1
    s_add_u32 s53, s53, s4
    s_mul_i32 s53, s53, 22528
    v_lshlrev_b32 v32, 10, v1
    s_mov_b64 exec, 0x3fffff
    buffer_load_dword v31, v32, s[80:83], s53 offen offset:384
    s_mov_b64 exec, -1
    s_waitcnt vmcnt(25)
    s_barrier
    s_mov_b32 s9, 2
L_bs_83:
    s_add_u32 m0, s5, 0
    s_nop 0
    buffer_load_dwordx4 v20, s[72:75], s7 offen  lds
    s_add_u32 m0, s5, 2048
    s_nop 0
    buffer_load_dwordx4 v20, s[76:79], s7 offen  lds
    s_add_u32 m0, s5, 4096
    s_nop 0
    buffer_load_dwordx4 v21, s[72:75], s7 offen  lds
    s_add_u32 m0, s5, 6144
    s_nop 0
    buffer_load_dwordx4 v21, s[76:79], s7 offen  lds
    s_add_u32 m0, s5, 8192
    s_nop 0
    buffer_load_dwordx4 v22, s[72:75], s7 offen  lds
    s_add_u32 m0, s5, 10240
    s_nop 0
    buffer_load_dwordx4 v22, s[76:79], s7 offen  lds
    s_add_u32 s7, s7, 88064
    s_cmp_eq_u32 s7, 1409024
    s_cselect_b32 s7, 0, s7
    s_add_u32 m0, s5, 12288
    s_nop 0
    buffer_load_dwordx4 v20, s[72:75], s7 offen  lds
    s_add_u32 m0, s5, 14336
    s_nop 0
    buffer_load_dwordx4 v20, s[76:79], s7 offen  lds
    s_add_u32 m0, s5, 16384
    s_nop 0
    buffer_load_dwordx4 v21, s[72:75], s7 offen  lds
    s_add_u32 m0, s5, 18432
    s_nop 0
    buffer_load_dwordx4 v21, s[76:79], s7 offen  lds
    s_add_u32 m0, s5, 20480
    s_nop 0
    buffer_load_dwordx4 v22, s[72:75], s7 offen  lds
    s_add_u32 m0, s5, 22528
    s_nop 0
    buffer_load_dwordx4 v22, s[76:79], s7 offen  lds
    s_add_u32 s7, s7, 88064
    s_cmp_eq_u32 s7, 1409024
    s_cselect_b32 s7, 0, s7
    s_add_u32 s5, s5, 24576
    s_cmp_ge_u32 s5, 98304
    s_cselect_b32 s5, s11, s5
    s_waitcnt vmcnt(25)
    s_barrier
    s_sub_u32 s9, s9, 1
    s_cmp_lg_u32 s9, 0
    s_cbranch_scc1 L_bs_83
    s_add_u32 m0, s5, 0
    s_nop 0
    buffer_load_dwordx4 v20, s[72:75], s7 offen  lds
    s_add_u32 m0, s5, 2048
    s_nop 0
    buffer_load_dwordx4 v20, s[76:79], s7 offen  lds
    s_add_u32 m0, s5, 4096
    s_nop 0
    buffer_load_dwordx4 v21, s[72:75], s7 offen  lds
    s_add_u32 m0, s5, 6144
    s_nop 0
    buffer_load_dwordx4 v21, s[76:79], s7 offen  lds
    s_add_u32 m0, s5, 8192
    s_nop 0
    buffer_load_dwordx4 v22, s[72:75], s7 offen  lds
    s_add_u32 m0, s5, 10240
    s_nop 0
    buffer_load_dwordx4 v22, s[76:79], s7 offen  lds
    s_add_u32 s7, s7, 88064
    s_cmp_eq_u32 s7, 1409024
    s_cselect_b32 s7, 0, s7
    s_add_u32 m0, s5, 12288
    s_nop 0
    buffer_load_dwordx4 v20, s[72:75], s7 offen  lds
    s_add_u32 m0, s5, 14336
    s_nop 0
    buffer_load_dwordx4 v20, s[76:79], s7 offen  lds
    s_add_u32 m0, s5, 16384
    s_nop 0
    buffer_load_dwordx4 v21, s[72:75], s7 offen  lds
    s_add_u32 m0, s5, 18432
    s_nop 0
    buffer_load_dwordx4 v21, s[76:79], s7 offen  lds
    s_add_u32 m0, s5, 20480
    s_nop 0
    buffer_load_dwordx4 v22, s[72:75], s7 offen  lds
    s_add_u32 m0, s5, 22528
    s_nop 0
    buffer_load_dwordx4 v22, s[76:79], s7 offen  lds
    s_add_u32 s7, s7, 88064
    s_cmp_eq_u32 s7, 1409024
    s_cselect_b32 s7, 0, s7
    s_add_u32 s5, s5, 24576
    s_cmp_ge_u32 s5, 98304
    s_cselect_b32 s5, s11, s5
    s_waitcnt vmcnt(24)
    s_barrier
    s_lshr_b32 s13, s61, 3
    s_lshl_b32 s12, s60, 1
    s_add_u32 s12, s12, s13
    s_and_b32 s13, s61, 7
    s_mul_i32 s14, s13, 5
    s_mul_i32 s7, s14, 32768
    s_add_u32 s5, s11, 49152
    s_add_u32 m0, s5, 0
    s_nop 0
    buffer_load_dwordx4 v18, s[80:83], s7 offen  lds
    s_add_u32 m0, s5, 2048
    s_nop 0
    buffer_load_dwordx4 v19, s[80:83], s7 offen  lds
    s_add_u32 s7, s7, 32768
    s_cmp_eq_u32 s7, 1441792
    s_cselect_b32 s7, 0, s7
    s_add_u32 s5, s5, 4096
    s_cmp_ge_u32 s5, 98304
    s_cselect_b32 s5, s11, s5
    s_mov_b32 s8, 3
L_bi_86_1:
    s_add_u32 m0, s5, 0
    s_nop 0
    buffer_load_dwordx4 v18, s[80:83], s7 offen  lds
    s_add_u32 m0, s5, 2048
    s_nop 0
    buffer_load_dwordx4 v19, s[80:83], s7 offen  lds
    s_add_u32 s7, s7, 32768
    s_cmp_eq_u32 s7, 1441792
    s_cselect_b32 s7, 0, s7
    s_add_u32 s5, s5, 4096
    s_cmp_ge_u32 s5, 98304
    s_cselect_b32 s5, s11, s5
    s_sub_u32 s8, s8, 1
    s_cmp_lg_u32 s8, 0
    s_cbranch_scc1 L_bi_86_1
    s_waitcnt vmcnt(20)
    s_barrier
    s_mov_b32 s8, 4
L_bi_87_0:
    s_add_u32 m0, s5, 0
    s_nop 0
    buffer_load_dwordx4 v18, s[80:83], s7 offen  lds
    s_add_u32 m0, s5, 2048
    s_nop 0
    buffer_load_dwordx4 v19, s[80:83], s7 offen  lds
    s_add_u32 s7, s7, 32768
    s_cmp_eq_u32 s7, 1441792
    s_cselect_b32 s7, 0, s7
    s_add_u32 s5, s5, 4096
    s_cmp_ge_u32 s5, 98304
    s_cselect_b32 s5, s11, s5
    s_sub_u32 s8, s8, 1
    s_cmp_lg_u32 s8, 0
    s_cbranch_scc1 L_bi_87_0
    s_waitcnt vmcnt(16)
    s_barrier
    s_mov_b32 s8, 4
L_bi_88_0:
    s_add_u32 m0, s5, 0
    s_nop 0
    buffer_load_dwordx4 v18, s[80:83], s7 offen  lds
    s_add_u32 m0, s5, 2048
    s_nop 0
    buffer_load_dwordx4 v19, s[80:83], s7 offen  lds
    s_add_u32 s7, s7, 32768
    s_cmp_eq_u32 s7, 1441792
    s_cselect_b32 s7, 0, s7
    s_add_u32 s5, s5, 4096
    s_cmp_ge_u32 s5, 98304
    s_cselect_b32 s5, s11, s5
    s_sub_u32 s8, s8, 1
    s_cmp_lg_u32 s8, 0
    s_cbranch_scc1 L_bi_88_0
    s_barrier
    s_mov_b32 s8, 4
L_bi_89_0:
    s_add_u32 m0, s5, 0
    s_nop 0
    buffer_load_dwordx4 v18, s[80:83], s7 offen  lds
    s_add_u32 m0, s5, 2048
    s_nop 0
    buffer_load_dwordx4 v19, s[80:83], s7 offen  lds
    s_add_u32 s7, s7, 32768
    s_cmp_eq_u32 s7, 1441792
    s_cselect_b32 s7, 0, s7
    s_add_u32 s5, s5, 4096
    s_cmp_ge_u32 s5, 98304
    s_cselect_b32 s5, s11, s5
    s_sub_u32 s8, s8, 1
    s_cmp_lg_u32 s8, 0
    s_cbranch_scc1 L_bi_89_0
    s_barrier
    s_mov_b32 s8, 4
L_bi_90_0:
    s_add_u32 m0, s5, 0
    s_nop 0
    buffer_load_dwordx4 v18, s[80:83], s7 offen  lds
    s_add_u32 m0, s5, 2048
    s_nop 0
    buffer_load_dwordx4 v19, s[80:83], s7 offen  lds
    s_add_u32 s7, s7, 32768
    s_cmp_eq_u32 s7, 1441792
    s_cselect_b32 s7, 0, s7
    s_add_u32 s5, s5, 4096
    s_cmp_ge_u32 s5, 98304
    s_cselect_b32 s5, s11, s5
    s_sub_u32 s8, s8, 1
    s_cmp_lg_u32 s8, 0
    s_cbranch_scc1 L_bi_90_0
    s_waitcnt vmcnt(36)
    s_barrier
    s_mov_b32 s8, 4
L_bi_91_0:
    s_add_u32 m0, s5, 0
    s_nop 0
    buffer_load_dwordx4 v18, s[80:83], s7 offen  lds
    s_add_u32 m0, s5, 2048
    s_nop 0
    buffer_load_dwordx4 v19, s[80:83], s7 offen  lds
    s_add_u32 s7, s7, 32768
    s_cmp_eq_u32 s7, 1441792
    s_cselect_b32 s7, 0, s7
    s_add_u32 s5, s5, 4096
    s_cmp_ge_u32 s5, 98304
    s_cselect_b32 s5, s11, s5
    s_sub_u32 s8, s8, 1
    s_cmp_lg_u32 s8, 0
    s_cbranch_scc1 L_bi_91_0
    s_waitcnt vmcnt(40)
    s_barrier
    s_waitcnt vmcnt(36)
    s_barrier
    s_add_u32 m0, s5, 0
    s_nop 0
    buffer_load_dwordx4 v18, s[80:83], s7 offen  lds
    s_add_u32 m0, s5, 2048
    s_nop 0
    buffer_load_dwordx4 v19, s[80:83], s7 offen  lds
    s_add_u32 s7, s7, 32768
    s_cmp_eq_u32 s7, 1441792
    s_cselect_b32 s7, 0, s7
    s_add_u32 s5, s5, 4096
    s_cmp_ge_u32 s5, 98304
    s_cselect_b32 s5, s11, s5
    s_waitcnt vmcnt(34)
    s_barrier
    s_add_u32 m0, s5, 0
    s_nop 0
    buffer_load_dwordx4 v18, s[80:83], s7 offen  lds
    s_add_u32 m0, s5, 2048
    s_nop 0
    buffer_load_dwordx4 v19, s[80:83], s7 offen  lds
    s_add_u32 s7, s7, 32768
    s_cmp_eq_u32 s7, 1441792
    s_cselect_b32 s7, 0, s7
    s_add_u32 s5, s5, 4096
    s_cmp_ge_u32 s5, 98304
    s_cselect_b32 s5, s11, s5
    s_waitcnt vmcnt(32)
    s_barrier
    s_add_u32 m0, s5, 0
    s_nop 0
    buffer_load_dwordx4 v18, s[80:83], s7 offen  lds
    s_add_u32 m0, s5, 2048
    s_nop 0
    buffer_load_dwordx4 v19, s[80:83], s7 offen  lds
    s_add_u32 s7, s7, 32768
    s_cmp_eq_u32 s7, 1441792
    s_cselect_b32 s7, 0, s7
    s_add_u32 s5, s5, 4096
    s_cmp_ge_u32 s5, 98304
    s_cselect_b32 s5, s11, s5
    s_waitcnt vmcnt(30)
    s_barrier
    s_add_u32 m0, s5, 0
    s_nop 0
    buffer_load_dwordx4 v18, s[80:83], s7 offen  lds
    s_add_u32 m0, s5, 2048
    s_nop 0
    buffer_load_dwordx4 v19, s[80:83], s7 offen  lds
    s_add_u32 s7, s7, 32768
    s_cmp_eq_u32 s7, 1441792
    s_cselect_b32 s7, 0, s7
    s_add_u32 s5, s5, 4096
    s_cmp_ge_u32 s5, 98304
    s_cselect_b32 s5, s11, s5
    s_waitcnt vmcnt(28)
    s_barrier
    s_add_u32 m0, s5, 0
    s_nop 0
    buffer_load_dwordx4 v18, s[80:83], s7 offen  lds
    s_add_u32 m0, s5, 2048
    s_nop 0
    buffer_load_dwordx4 v19, s[80:83], s7 offen  lds
    s_add_u32 s7, s7, 32768
    s_cmp_eq_u32 s7, 1441792
    s_cselect_b32 s7, 0, s7
    s_add_u32 s5, s5, 4096
    s_cmp_ge_u32 s5, 98304
    s_cselect_b32 s5, s11, s5
    s_waitcnt vmcnt(26)
    s_barrier
    s_add_u32 m0, s5, 0
    s_nop 0
    buffer_load_dwordx4 v18, s[80:83], s7 offen  lds
    s_add_u32 m0, s5, 2048
    s_nop 0
    buffer_load_dwordx4 v19, s[80:83], s7 offen  lds
    s_add_u32 s7, s7, 32768
    s_cmp_eq_u32 s7, 1441792
    s_cselect_b32 s7, 0, s7
    s_add_u32 s5, s5, 4096
    s_cmp_ge_u32 s5, 98304
    s_cselect_b32 s5, s11, s5
    s_waitcnt vmcnt(24)
    s_barrier
    s_add_u32 m0, s5, 0
    s_nop 0
    buffer_load_dwordx4 v18, s[80:83], s7 offen  lds
    s_add_u32 m0, s5, 2048
    s_nop 0
    buffer_load_dwordx4 v19, s[80:83], s7 offen  lds
    s_add_u32 s7, s7, 32768
    s_cmp_eq_u32 s7, 1441792
    s_cselect_b32 s7, 0, s7
    s_add_u32 s5, s5, 4096
    s_cmp_ge_u32 s5, 98304
    s_cselect_b32 s5, s11, s5
    s_waitcnt vmcnt(22)
    s_barrier
    s_add_u32 m0, s5, 0
    s_nop 0
    buffer_load_dwordx4 v18, s[80:83], s7 offen  lds
    s_add_u32 m0, s5, 2048
    s_nop 0
    buffer_load_dwordx4 v19, s[80:83], s7 offen  lds
    s_add_u32 s7, s7, 32768
    s_cmp_eq_u32 s7, 1441792
    s_cselect_b32 s7, 0, s7
    s_add_u32 s5, s5, 4096
    s_cmp_ge_u32 s5, 98304
    s_cselect_b32 s5, s11, s5
    s_waitcnt vmcnt(20)
    s_barrier
    s_add_u32 m0, s5, 0
    s_nop 0
    buffer_load_dwordx4 v18, s[80:83], s7 offen  lds
    s_add_u32 m0, s5, 2048
    s_nop 0
    buffer_load_dwordx4 v19, s[80:83], s7 offen  lds
    s_add_u32 s7, s7, 32768
    s_cmp_eq_u32 s7, 1441792
    s_cselect_b32 s7, 0, s7
    s_add_u32 s5, s5, 4096
    s_cmp_ge_u32 s5, 98304
    s_cselect_b32 s5, s11, s5
    s_waitcnt vmcnt(18)
    s_barrier
    s_add_u32 m0, s5, 0
    s_nop 0
    buffer_load_dwordx4 v18, s[80:83], s7 offen  lds
    s_add_u32 m0, s5, 2048
    s_nop 0
    buffer_load_dwordx4 v19, s[80:83], s7 offen  lds
    s_add_u32 s7, s7, 32768
    s_cmp_eq_u32 s7, 1441792
    s_cselect_b32 s7, 0, s7
    s_add_u32 s5, s5, 4096
    s_cmp_ge_u32 s5, 98304
    s_cselect_b32 s5, s11, s5
    s_waitcnt vmcnt(16)
    s_barrier
    s_add_u32 m0, s5, 0
    s_nop 0
    buffer_load_dwordx4 v18, s[80:83], s7 offen  lds
    s_add_u32 m0, s5, 2048
    s_nop 0
    buffer_load_dwordx4 v19, s[80:83], s7 offen  lds
    s_add_u32 s7, s7, 32768
    s_cmp_eq_u32 s7, 1441792
    s_cselect_b32 s7, 0, s7
    s_add_u32 s5, s5, 4096
    s_cmp_ge_u32 s5, 98304
    s_cselect_b32 s5, s11, s5
    s_waitcnt vmcnt(14)
    s_barrier
    s_add_u32 m0, s5, 0
    s_nop 0
    buffer_load_dwordx4 v18, s[80:83], s7 offen  lds
    s_add_u32 m0, s5, 2048
    s_nop 0
    buffer_load_dwordx4 v19, s[80:83], s7 offen  lds
    s_add_u32 s7, s7, 32768
    s_cmp_eq_u32 s7, 1441792
    s_cselect_b32 s7, 0, s7
    s_add_u32 s5, s5, 4096
    s_cmp_ge_u32 s5, 98304
    s_cselect_b32 s5, s11, s5
    s_waitcnt vmcnt(12)
    s_barrier
    s_mov_b32 s9, 4
L_bs_105:
    s_add_u32 m0, s5, 0
    s_nop 0
    buffer_load_dwordx4 v18, s[80:83], s7 offen  lds
    s_add_u32 m0, s5, 2048
    s_nop 0
    buffer_load_dwordx4 v19, s[80:83], s7 offen  lds
    s_add_u32 s7, s7, 32768
    s_cmp_eq_u32 s7, 1441792
    s_cselect_b32 s7, 0, s7
    s_add_u32 s5, s5, 4096
    s_cmp_ge_u32 s5, 98304
    s_cselect_b32 s5, s11, s5
    s_add_u32 m0, s5, 0
    s_nop 0
    buffer_load_dwordx4 v18, s[80:83], s7 offen  lds
    s_add_u32 m0, s5, 2048
    s_nop 0
    buffer_load_dwordx4 v19, s[80:83], s7 offen  lds
    s_add_u32 s7, s7, 32768
    s_cmp_eq_u32 s7, 1441792
    s_cselect_b32 s7, 0, s7
    s_add_u32 s5, s5, 4096
    s_cmp_ge_u32 s5, 98304
    s_cselect_b32 s5, s11, s5
    s_waitcnt vmcnt(12)
    s_barrier
    s_sub_u32 s9, s9, 1
    s_cmp_lg_u32 s9, 0
    s_cbranch_scc1 L_bs_105
    s_waitcnt vmcnt(8)
    s_barrier
    s_waitcnt vmcnt(4)
    s_barrier
    s_waitcnt vmcnt(0)
    s_barrier
    s_endpgm
L_aload:
    s_and_b32 s4, s3, 1
    v_mov_b32 v40, 1
    s_lshl_b32 s5, s61, 2
    v_mov_b32 v41, s5
    v_lshlrev_b32 v42, 2, v1
    s_and_b32 s5, s96, 31
    s_lshl_b32 s5, s5, 2
    v_mov_b32 v43, s5
    s_lshr_b32 s5, s96, 5
    s_lshl_b32 s5, s5, 2
    v_lshl_add_u32 v48, v1, 8, s5
    v_lshl_add_u32 v47, v1, 8, s96
    v_lshlrev_b32 v16, 4, v1
    v_lshrrev_b32 v4, 3, v1
    v_and_b32 v5, 7, v1
    v_mul_u32_u24 v4, 44032, v4
    v_lshl_add_u32 v49, v5, 7, v4
    v_lshlrev_b32 v50, 7, v1
    v_and_b32 v4, 3, v1
    v_lshlrev_b32 v4, 6, v4
    v_and_b32 v5, 60, v1
    v_add_u32 v55, v4, v5
    s_mov_b32 s12, s60
    s_mov_b32 s13, s61
    s_lshl_b32 s14, s61, 1
    s_and_b32 s14, s14, 15
    s_lshl_b32 s8, s12, 17
    v_lshrrev_b32 v4, 2, v1
    v_and_b32 v5, 3, v1
    v_sub_u32 v6, 4, v2
    v_and_b32 v6, 3, v6
    v_xor_b32 v5, v5, v6
    v_lshlrev_b32 v4, 10, v4
    v_lshl_add_u32 v8, v5, 4, v4
    s_lshl_b32 s10, s4, 14
    s_add_u32 s10, s10, s8
    v_add_u32 v8, s10, v8
    v_add_u32 v9, 32768, v8
    v_add_u32 v10, 65536, v8
    v_add_u32 v11, 98304, v8
    s_mul_i32 s6, s14, 64
    s_lshl_b32 s10, s4, 10
    s_add_u32 s10, s10, 98304
    s_mov_b32 s5, s10
    s_add_u32 s11, s10, 49152
    s_mov_b32 s9, 0
L_li_s1l0:
    s_add_u32 m0, s5, 0
    s_nop 0
    buffer_load_dwordx4 v8, s[36:39], s6 offen offset:0 lds
    s_add_u32 m0, s5, 8128
    s_nop 0
    buffer_load_dwordx4 v8, s[36:39], s6 offen offset:64 lds
    s_add_u32 m0, s5, 2048
    s_nop 0
    buffer_load_dwordx4 v9, s[36:39], s6 offen offset:0 lds
    s_add_u32 m0, s5, 10176
    s_nop 0
    buffer_load_dwordx4 v9, s[36:39], s6 offen offset:64 lds
    s_add_u32 m0, s5, 4096
    s_nop 0
    buffer_load_dwordx4 v10, s[36:39], s6 offen offset:0 lds
    s_add_u32 m0, s5, 12224
    s_nop 0
    buffer_load_dwordx4 v10, s[36:39], s6 offen offset:64 lds
    s_add_u32 m0, s5, 6144
    s_nop 0
    buffer_load_dwordx4 v11, s[36:39], s6 offen offset:0 lds
    s_add_u32 m0, s5, 14272
    s_nop 0
    buffer_load_dwordx4 v11, s[36:39], s6 offen offset:64 lds
    s_add_u32 s6, s6, 128
    s_cmp_eq_u32 s6, 1024
    s_cselect_b32 s6, 0, s6
    s_add_u32 s5, s5, 16384
    s_cmp_eq_u32 s5, s11
    s_cselect_b32 s5, s10, s5
    s_add_u32 s9, s9, 1
    s_cmp_lt_u32 s9, 2
    s_cbranch_scc1 L_li_s1l0
    s_waitcnt vmcnt(8)
    s_barrier
    s_cmp_lt_u32 s9, 8
    s_cbranch_scc1 L_li_s1l0
    s_mul_i32 s53, s12, 352256
    s_lshl_b32 s54, s13, 10
    s_add_u32 s53, s53, s54
    s_add_u32 s53, s53, 8388608
    s_lshl_b32 s54, s96, 13
    s_add_u32 s54, s54, 4194304
    s_cmp_eq_u32 s4, 0
    s_cselect_b32 s53, s53, s54
    s_cselect_b64 vcc, -1, 0
    v_cndmask_b32 v51, v50, v49, vcc
    buffer_load_dword v52, v51, s[44:47], s53 offen sc1
    s_lshl_b32 s54, s96, 9
    s_add_u32 s54, s54, 23592960
    s_lshl_b32 s53, s4, 17
    s_add_u32 s54, s54, s53
    s_mov_b64 exec, 15
    buffer_load_dword v53, v50, s[44:47], s54 offen sc1
    s_mov_b64 exec, -1
    buffer_load_dword v54, v42, s[48:51], 0 offen sc1
    s_waitcnt vmcnt(3)
    s_barrier
    s_barrier
    s_mov_b32 s84, 131072
    s_mov_b32 s52, 0x06060606
    s_mov_b32 s53, 0x06060606
    s_lshr_b32 s94, s60, 1
    s_lshl_b32 s94, s94, 3
    s_waitcnt vmcnt(0)
    s_branch L_het1
L_het:
    s_sleep 2
    buffer_load_dword v54, v42, s[48:51], 0 offen sc1
    s_waitcnt vmcnt(0)
L_het1:
    s_sub_u32 s84, s84, 1
    s_mov_b32 s63, 1
    s_cbranch_scc1 L_het_done
    v_cmp_eq_u32 vcc, 0, v54
    v_readlane_b32 s95, v54, s94
    s_nop 0
    s_and_b64 s[54:55], vcc, s[52:53]
    s_cbranch_scc1 L_het
    s_mov_b32 s63, 0
    s_cmp_ge_u32 s95, 32
    s_cbranch_scc1 L_het_done
    s_mov_b32 s63, 1
    v_readlane_b32 s86, v54, 0
    v_readlane_b32 s87, v54, 8
    v_readlane_b32 s88, v54, 16
    v_readlane_b32 s89, v54, 24
    v_readlane_b32 s90, v54, 32
    v_readlane_b32 s91, v54, 40
    v_readlane_b32 s92, v54, 48
    v_readlane_b32 s93, v54, 56
    s_add_u32 s85, s86, s87
    s_add_u32 s85, s85, s88
    s_add_u32 s85, s85, s89
    s_add_u32 s85, s85, s90
    s_add_u32 s85, s85, s91
    s_add_u32 s85, s85, s92
    s_add_u32 s85, s85, s93
    s_cmp_ge_u32 s85, 256
    s_cbranch_scc0 L_het
L_het_done:
    s_barrier
    s_lshr_b32 s13, s61, 3
    s_lshl_b32 s12, s60, 1
    s_add_u32 s12, s12, s13
    s_and_b32 s13, s61, 7
    s_lshl_b32 s14, s13, 1
    s_mul_i32 s8, s12, 176128
    s_add_u32 s8, s8, 8388608
    s_mul_i32 s10, s4, 44032
    s_add_u32 s10, s10, s8
    v_lshl_add_u32 v8, v1, 4, s10
    v_add_u32 v9, 88064, v8
    s_mul_i32 s6, s14, 1024
    s_lshl_b32 s10, s4, 10
    s_add_u32 s10, s10, 98304
    s_mov_b32 s5, s10
    s_add_u32 s11, s10, 49152
    s_mov_b32 s9, 0
    s_mov_b32 s36, s34
    s_mov_b32 s37, s35
    s_mov_b32 s38, 268435456
    s_mov_b32 s39, 0x00020000
    s_lshr_b32 s15, s96, 5
    s_lshl_b32 s15, s15, 7
    s_add_u32 s15, s15, 23214080
    s_add_u32 s97, s15, 1024
    s_lshr_b32 s97, s96, 4
    s_lshl_b32 s97, s97, 8
    s_add_u32 s97, s97, 23218176
    s_barrier
    s_cmp_eq_u32 s3, 4
    s_cbranch_scc0 L_ns_s2l0g
    s_mov_b64 exec, 1
    s_cmp_eq_u32 s63, 0
    s_cbranch_scc1 L_hom_s2l0g
    buffer_wbl2 sc1
    s_waitcnt vmcnt(0)
    buffer_store_dword v40, v43, s[44:47], s15 offen sc1
    s_branch L_sg_s2l0g
L_hom_s2l0g:
    buffer_store_dword v40, v43, s[44:47], s15 offen
L_sg_s2l0g:
    s_mov_b64 exec, -1
    s_and_b32 s85, s96, 31
    s_cmp_eq_u32 s85, 0
    s_cbranch_scc0 L_nl_s2l0g
    s_mov_b32 s84, 131072
    s_mov_b32 exec_hi, 0
L_poll_gs2l0g:
    buffer_load_dword v44, v42, s[44:47], s15 offen sc1
    s_waitcnt vmcnt(0)
    v_cmp_eq_u32 vcc, 0, v44
    s_nop 1
    s_cbranch_vccz L_pok_gs2l0g
    s_sub_u32 s84, s84, 1
    s_cbranch_scc1 L_pok_gs2l0g
    s_sleep 0
    s_branch L_poll_gs2l0g
L_pok_gs2l0g:
    s_mov_b64 exec, -1
    s_mov_b32 s85, 23218176
    s_mov_b64 exec, 0xffff
    buffer_store_dword v40, v48, s[44:47], s85 offen sc1
    s_mov_b64 exec, -1
    s_branch L_nl2_s2l0g
L_nl_s2l0g:
    s_sleep 16
L_nl2_s2l0g:
    s_mov_b32 s84, 131072
    s_mov_b64 exec, 255
L_poll_s2l0g:
    buffer_load_dword v44, v42, s[44:47], s97 offen sc1
    s_waitcnt vmcnt(0)
    v_cmp_eq_u32 vcc, 0, v44
    s_nop 1
    s_cbranch_vccz L_pok_s2l0g
    s_sub_u32 s84, s84, 1
    s_cbranch_scc1 L_pok_s2l0g
    s_sleep 0
    s_branch L_poll_s2l0g
L_pok_s2l0g:
    s_mov_b64 exec, -1
L_ns_s2l0g:
    s_barrier
    s_lshl_b32 s15, s60, 7
    s_add_u32 s15, s15, 23199744
    s_barrier
    s_cmp_eq_u32 s3, 4
    s_cbranch_scc0 L_ns_s2l0t
    s_mov_b64 exec, 1
    s_cmp_eq_u32 s63, 0
    s_cbranch_scc1 L_hom_s2l0t
    buffer_wbl2 sc1
    s_waitcnt vmcnt(0)
    buffer_store_dword v40, v41, s[44:47], s15 offen sc1
    s_branch L_sg_s2l0t
L_hom_s2l0t:
    buffer_store_dword v40, v41, s[44:47], s15 offen
L_sg_s2l0t:
    s_mov_b64 exec, -1
L_ns_s2l0t:
    s_mov_b32 s84, 131072
    s_mov_b64 exec, 65535
L_poll_s2l0t:
    buffer_load_dword v44, v42, s[44:47], s15 offen sc1
    s_waitcnt vmcnt(0)
    v_cmp_eq_u32 vcc, 0, v44
    s_nop 1
    s_cbranch_vccz L_pok_s2l0t
    s_sub_u32 s84, s84, 1
    s_cbranch_scc1 L_pok_s2l0t
    s_sleep 0
    s_branch L_poll_s2l0t
L_pok_s2l0t:
    s_mov_b64 exec, -1
L_li_s2l0:
    s_add_u32 m0, s5, 0
    s_nop 0
    buffer_load_dwordx4 v8, s[36:39], s6 offen sc1 lds
    s_add_u32 m0, s5, 2048
    s_nop 0
    buffer_load_dwordx4 v9, s[36:39], s6 offen sc1 lds
    s_add_u32 s6, s6, 1024
    s_cmp_eq_u32 s6, 16384
    s_cselect_b32 s6, 0, s6
    s_add_u32 m0, s5, 4096
    s_nop 0
    buffer_load_dwordx4 v8, s[36:39], s6 offen sc1 lds
    s_add_u32 m0, s5, 6144
    s_nop 0
    buffer_load_dwordx4 v9, s[36:39], s6 offen sc1 lds
    s_add_u32 s6, s6, 1024
    s_cmp_eq_u32 s6, 16384
    s_cselect_b32 s6, 0, s6
    s_add_u32 s5, s5, 8192
    s_cmp_eq_u32 s5, s11
    s_cselect_b32 s5, s10, s5
    s_add_u32 s9, s9, 1
    s_cmp_lt_u32 s9, 4
    s_cbranch_scc1 L_li_s2l0
    s_waitcnt vmcnt(12)
    s_barrier
    s_cmp_lt_u32 s9, 8
    s_cbranch_scc1 L_li_s2l0
    s_waitcnt vmcnt(8)
    s_barrier
    s_waitcnt vmcnt(4)
    s_barrier
    s_waitcnt vmcnt(0)
    s_barrier
    s_barrier
    s_mov_b32 s12, s60
    s_mov_b32 s13, s61
    s_mov_b32 s14, s61
    s_lshl_b32 s8, s12, 17
    s_add_u32 s8, s8, 4194304
    s_mul_i32 s10, s4, 16384
    s_add_u32 s10, s10, s8
    v_lshl_add_u32 v8, v1, 4, s10
    v_add_u32 v9, 32768, v8
    v_add_u32 v10, 65536, v8
    v_add_u32 v11, 98304, v8
    s_mul_i32 s6, s14, 1024
    s_lshl_b32 s10, s4, 10
    s_add_u32 s10, s10, 98304
    s_mov_b32 s5, s10
    s_add_u32 s11, s10, 49152
    s_mov_b32 s9, 0
    s_cmp_eq_u32 s61, 15
    s_cselect_b32 s38, 0, s38
    s_lshl_b32 s7, s12, 1
    s_add_u32 s7, s7, s4
    s_lshl_b32 s7, s7, 12
    s_add_u32 s7, s7, 23592960
    s_lshl_b32 s15, s60, 7
    s_add_u32 s15, s15, 23201792
    s_barrier
    s_cmp_eq_u32 s3, 4
    s_cbranch_scc0 L_ns_s3l0t
    s_mov_b64 exec, 1
    s_cmp_eq_u32 s63, 0
    s_cbranch_scc1 L_hom_s3l0t
    buffer_wbl2 sc1
    s_waitcnt vmcnt(0)
    buffer_store_dword v40, v41, s[44:47], s15 offen sc1
    s_branch L_sg_s3l0t
L_hom_s3l0t:
    buffer_store_dword v40, v41, s[44:47], s15 offen
L_sg_s3l0t:
    s_mov_b64 exec, -1
L_ns_s3l0t:
    s_mov_b32 s84, 131072
    s_mov_b64 exec, 65535
L_poll_s3l0t:
    buffer_load_dword v44, v42, s[44:47], s15 offen sc1
    s_waitcnt vmcnt(0)
    v_cmp_eq_u32 vcc, 0, v44
    s_nop 1
    s_cbranch_vccz L_pok_s3l0t
    s_sub_u32 s84, s84, 1
    s_cbranch_scc1 L_pok_s3l0t
    s_sleep 0
    s_branch L_poll_s3l0t
L_pok_s3l0t:
    s_mov_b64 exec, -1
    buffer_load_dwordx4 v[20:23], v16, s[44:47], s7 offen offset:0 sc1
    buffer_load_dwordx4 v[24:27], v16, s[44:47], s7 offen offset:1024 sc1
    buffer_load_dwordx4 v[28:31], v16, s[44:47], s7 offen offset:2048 sc1
    buffer_load_dwordx4 v[32:35], v16, s[44:47], s7 offen offset:3072 sc1
    s_add_u32 s7, s7, 131072
    buffer_load_dwordx4 v[56:59], v16, s[44:47], s7 offen offset:0 sc1
    buffer_load_dwordx4 v[60:63], v16, s[44:47], s7 offen offset:1024 sc1
    buffer_load_dwordx4 v[64:67], v16, s[44:47], s7 offen offset:2048 sc1
    buffer_load_dwordx4 v[68:71], v16, s[44:47], s7 offen offset:3072 sc1
L_li_s3l0:
    s_add_u32 m0, s5, 0
    s_nop 0
    buffer_load_dwordx4 v8, s[36:39], s6 offen sc1 lds
    s_add_u32 m0, s5, 2048
    s_nop 0
    buffer_load_dwordx4 v9, s[36:39], s6 offen sc1 lds
    s_add_u32 m0, s5, 4096
    s_nop 0
    buffer_load_dwordx4 v10, s[36:39], s6 offen sc1 lds
    s_add_u32 m0, s5, 6144
    s_nop 0
    buffer_load_dwordx4 v11, s[36:39], s6 offen sc1 lds
    s_add_u32 s6, s6, 1024
    s_cmp_eq_u32 s6, 16384
    s_cselect_b32 s6, 0, s6
    s_add_u32 m0, s5, 8192
    s_nop 0
    buffer_load_dwordx4 v8, s[36:39], s6 offen sc1 lds
    s_add_u32 m0, s5, 10240
    s_nop 0
    buffer_load_dwordx4 v9, s[36:39], s6 offen sc1 lds
    s_add_u32 m0, s5, 12288
    s_nop 0
    buffer_load_dwordx4 v10, s[36:39], s6 offen sc1 lds
    s_add_u32 m0, s5, 14336
    s_nop 0
    buffer_load_dwordx4 v11, s[36:39], s6 offen sc1 lds
    s_add_u32 s6, s6, 1024
    s_cmp_eq_u32 s6, 16384
    s_cselect_b32 s6, 0, s6
    s_add_u32 s5, s5, 16384
    s_cmp_eq_u32 s5, s11
    s_cselect_b32 s5, s10, s5
    s_add_u32 s9, s9, 1
    s_cmp_lt_u32 s9, 2
    s_cbranch_scc1 L_li_s3l0
    s_waitcnt vmcnt(8)
    s_barrier
    s_cmp_lt_u32 s9, 8
    s_cbranch_scc1 L_li_s3l0
    s_mul_i32 s53, s12, 352256
    s_mul_i32 s54, s13, 3072
    s_add_u32 s53, s53, s54
    s_add_u32 s53, s53, 8388608
    s_lshl_b32 s54, s4, 10
    s_add_u32 s54, s54, s53
    buffer_load_dword v52, v49, s[44:47], s54 offen sc1
    s_cmp_eq_u32 s4, 0
    s_cselect_b32 exec_lo, -1, 0
    s_cselect_b32 exec_hi, 0, -1
    buffer_load_dword v53, v49, s[44:47], s53 offen offset:2048 sc1
    s_mov_b64 exec, -1
    v_pk_add_f32 v[20:21], v[20:21], v[56:57] op_sel:[0,0] op_sel_hi:[1,1]
    v_pk_add_f32 v[22:23], v[22:23], v[58:59] op_sel:[0,0] op_sel_hi:[1,1]
    v_pk_add_f32 v[24:25], v[24:25], v[60:61] op_sel:[0,0] op_sel_hi:[1,1]
    v_pk_add_f32 v[26:27], v[26:27], v[62:63] op_sel:[0,0] op_sel_hi:[1,1]
    v_pk_add_f32 v[28:29], v[28:29], v[64:65] op_sel:[0,0] op_sel_hi:[1,1]
    v_pk_add_f32 v[30:31], v[30:31], v[66:67] op_sel:[0,0] op_sel_hi:[1,1]
    v_pk_add_f32 v[32:33], v[32:33], v[68:69] op_sel:[0,0] op_sel_hi:[1,1]
    v_pk_add_f32 v[34:35], v[34:35], v[70:71] op_sel:[0,0] op_sel_hi:[1,1]
    v_pk_add_f32 v[20:21], v[20:21], v[22:23] op_sel:[0,0] op_sel_hi:[1,1]
    v_pk_add_f32 v[24:25], v[24:25], v[26:27] op_sel:[0,0] op_sel_hi:[1,1]
    v_pk_add_f32 v[28:29], v[28:29], v[30:31] op_sel:[0,0] op_sel_hi:[1,1]
    v_pk_add_f32 v[32:33], v[32:33], v[34:35] op_sel:[0,0] op_sel_hi:[1,1]
    v_and_b32 v17, 1, v1
    v_cmp_eq_u32 vcc, 1, v17
    v_add_f32_dpp v20, v20, v20 quad_perm:[1,0,3,2] row_mask:0xf bank_mask:0xf
    v_add_f32_dpp v21, v21, v21 quad_perm:[1,0,3,2] row_mask:0xf bank_mask:0xf
    v_add_f32_dpp v24, v24, v24 quad_perm:[1,0,3,2] row_mask:0xf bank_mask:0xf
    v_add_f32_dpp v25, v25, v25 quad_perm:[1,0,3,2] row_mask:0xf bank_mask:0xf
    v_add_f32_dpp v28, v28, v28 quad_perm:[1,0,3,2] row_mask:0xf bank_mask:0xf
    v_add_f32_dpp v29, v29, v29 quad_perm:[1,0,3,2] row_mask:0xf bank_mask:0xf
    v_add_f32_dpp v32, v32, v32 quad_perm:[1,0,3,2] row_mask:0xf bank_mask:0xf
    v_add_f32_dpp v33, v33, v33 quad_perm:[1,0,3,2] row_mask:0xf bank_mask:0xf
    v_cndmask_b32 v20, v20, v24, vcc
    v_cndmask_b32 v21, v21, v25, vcc
    v_cndmask_b32 v28, v28, v32, vcc
    v_cndmask_b32 v29, v29, v33, vcc
    s_waitcnt vmcnt(2)
    s_barrier
    v_and_b32 v17, 2, v1
    v_cmp_eq_u32 vcc, 2, v17
    v_add_f32_dpp v20, v20, v20 quad_perm:[2,3,0,1] row_mask:0xf bank_mask:0xf
    v_add_f32_dpp v21, v21, v21 quad_perm:[2,3,0,1] row_mask:0xf bank_mask:0xf
    v_add_f32_dpp v28, v28, v28 quad_perm:[2,3,0,1] row_mask:0xf bank_mask:0xf
    v_add_f32_dpp v29, v29, v29 quad_perm:[2,3,0,1] row_mask:0xf bank_mask:0xf
    v_cndmask_b32 v20, v20, v28, vcc
    v_cndmask_b32 v21, v21, v29, vcc
    v_mul_f32 v22, 0x3b000000, v20
    v_mul_f32 v17, 0x3b000000, v21
    v_fma_f32 v17, -v22, v22, v17
    v_max_f32 v17, 0, v17
    v_add_f32 v17, 0x3727c5ac, v17
    v_rsq_f32 v23, v17
    s_lshl_b32 s8, s4, 8
    s_add_u32 s8, s8, 147456
    v_add_u32 v18, s8, v55
    ds_write_b32 v18, v22
    ds_write_b32 v18, v23 offset:512
    s_waitcnt lgkmcnt(0)
    s_barrier
    s_lshr_b32 s13, s61, 3
    s_lshl_b32 s12, s60, 1
    s_add_u32 s12, s12, s13
    s_and_b32 s13, s61, 7
    s_mul_i32 s14, s13, 5
    s_mul_i32 s8, s12, 176128
    s_add_u32 s8, s8, 8388608
    s_mul_i32 s10, s4, 44032
    s_add_u32 s10, s10, s8
    v_lshl_add_u32 v8, v1, 4, s10
    v_add_u32 v9, 88064, v8
    s_mul_i32 s6, s14, 1024
    s_lshl_b32 s10, s4, 10
    s_add_u32 s10, s10, 98304
    s_mov_b32 s5, s10
    s_add_u32 s11, s10, 49152
    s_mov_b32 s9, 0
    s_mov_b32 s38, 268435456
    s_lshl_b32 s15, s60, 7
    s_add_u32 s15, s15, 23203840
    s_barrier
    s_cmp_eq_u32 s3, 4
    s_cbranch_scc0 L_ns_s4l0t
    s_mov_b64 exec, 1
    s_cmp_eq_u32 s63, 0
    s_cbranch_scc1 L_hom_s4l0t
    buffer_wbl2 sc1
    s_waitcnt vmcnt(0)
    buffer_store_dword v40, v41, s[44:47], s15 offen sc1
    s_branch L_sg_s4l0t
L_hom_s4l0t:
    buffer_store_dword v40, v41, s[44:47], s15 offen
L_sg_s4l0t:
    s_mov_b64 exec, -1
L_ns_s4l0t:
    s_mov_b32 s84, 131072
    s_mov_b64 exec, 65535
L_poll_s4l0t:
    buffer_load_dword v44, v42, s[44:47], s15 offen sc1
    s_waitcnt vmcnt(0)
    v_cmp_eq_u32 vcc, 0, v44
    s_nop 1
    s_cbranch_vccz L_pok_s4l0t
    s_sub_u32 s84, s84, 1
    s_cbranch_scc1 L_pok_s4l0t
    s_sleep 0
    s_branch L_poll_s4l0t
L_pok_s4l0t:
    s_mov_b64 exec, -1
L_li_s4l0:
    s_cmp_eq_u32 s6, 44032
    s_cselect_b32 s8, 0x10000000, s6
    s_add_u32 m0, s5, 0
    s_nop 0
    buffer_load_dwordx4 v8, s[36:39], s8 offen sc1 lds
    s_add_u32 m0, s5, 2048
    s_nop 0
    buffer_load_dwordx4 v9, s[36:39], s8 offen sc1 lds
    s_add_u32 s6, s6, 1024
    s_cmp_eq_u32 s6, 45056
    s_cselect_b32 s6, 0, s6
    s_cmp_eq_u32 s6, 44032
    s_cselect_b32 s8, 0x10000000, s6
    s_add_u32 m0, s5, 4096
    s_nop 0
    buffer_load_dwordx4 v8, s[36:39], s8 offen sc1 lds
    s_add_u32 m0, s5, 6144
    s_nop 0
    buffer_load_dwordx4 v9, s[36:39], s8 offen sc1 lds
    s_add_u32 s6, s6, 1024
    s_cmp_eq_u32 s6, 45056
    s_cselect_b32 s6, 0, s6
    s_add_u32 s5, s5, 8192
    s_cmp_eq_u32 s5, s11
    s_cselect_b32 s5, s10, s5
    s_add_u32 s9, s9, 1
    s_cmp_lt_u32 s9, 4
    s_cbranch_scc1 L_li_s4l0
    s_waitcnt vmcnt(12)
    s_barrier
    s_cmp_lt_u32 s9, 22
    s_cbranch_scc1 L_li_s4l0
    s_waitcnt vmcnt(8)
    s_barrier
    s_waitcnt vmcnt(4)
    s_barrier
    s_waitcnt vmcnt(0)
    s_barrier
    s_barrier
    s_mov_b32 s12, s60
    s_mov_b32 s13, s61
    s_mov_b32 s14, s61
    s_lshl_b32 s8, s12, 17
    s_add_u32 s8, s8, 4194304
    s_mul_i32 s10, s4, 16384
    s_add_u32 s10, s10, s8
    v_lshl_add_u32 v8, v1, 4, s10
    v_add_u32 v9, 32768, v8
    v_add_u32 v10, 65536, v8
    v_add_u32 v11, 98304, v8
    s_mul_i32 s6, s14, 1024
    s_lshl_b32 s10, s4, 10
    s_add_u32 s10, s10, 98304
    s_mov_b32 s5, s10
    s_add_u32 s11, s10, 49152
    s_mov_b32 s9, 0
    s_lshl_b32 s7, s12, 1
    s_add_u32 s7, s7, s4
    s_lshl_b32 s7, s7, 12
    s_add_u32 s7, s7, 23592960
    s_lshl_b32 s15, s60, 7
    s_add_u32 s15, s15, 23205888
    s_barrier
    s_cmp_eq_u32 s3, 4
    s_cbranch_scc0 L_ns_s1l1t
    s_mov_b64 exec, 1
    s_cmp_eq_u32 s63, 0
    s_cbranch_scc1 L_hom_s1l1t
    buffer_wbl2 sc1
    s_waitcnt vmcnt(0)
    buffer_store_dword v40, v41, s[44:47], s15 offen sc1
    s_branch L_sg_s1l1t
L_hom_s1l1t:
    buffer_store_dword v40, v41, s[44:47], s15 offen
L_sg_s1l1t:
    s_mov_b64 exec, -1
L_ns_s1l1t:
    s_mov_b32 s84, 131072
    s_mov_b64 exec, 65535
L_poll_s1l1t:
    buffer_load_dword v44, v42, s[44:47], s15 offen sc1
    s_waitcnt vmcnt(0)
    v_cmp_eq_u32 vcc, 0, v44
    s_nop 1
    s_cbranch_vccz L_pok_s1l1t
    s_sub_u32 s84, s84, 1
    s_cbranch_scc1 L_pok_s1l1t
    s_sleep 0
    s_branch L_poll_s1l1t
L_pok_s1l1t:
    s_mov_b64 exec, -1
    buffer_load_dwordx4 v[20:23], v16, s[44:47], s7 offen offset:0 sc1
    buffer_load_dwordx4 v[24:27], v16, s[44:47], s7 offen offset:1024 sc1
    buffer_load_dwordx4 v[28:31], v16, s[44:47], s7 offen offset:2048 sc1
    buffer_load_dwordx4 v[32:35], v16, s[44:47], s7 offen offset:3072 sc1
    s_add_u32 s7, s7, 131072
    buffer_load_dwordx4 v[56:59], v16, s[44:47], s7 offen offset:0 sc1
    buffer_load_dwordx4 v[60:63], v16, s[44:47], s7 offen offset:1024 sc1
    buffer_load_dwordx4 v[64:67], v16, s[44:47], s7 offen offset:2048 sc1
    buffer_load_dwordx4 v[68:71], v16, s[44:47], s7 offen offset:3072 sc1
L_li_s1l1:
    s_add_u32 m0, s5, 0
    s_nop 0
    buffer_load_dwordx4 v8, s[36:39], s6 offen sc1 lds
    s_add_u32 m0, s5, 2048
    s_nop 0
    buffer_load_dwordx4 v9, s[36:39], s6 offen sc1 lds
    s_add_u32 m0, s5, 4096
    s_nop 0
    buffer_load_dwordx4 v10, s[36:39], s6 offen sc1 lds
    s_add_u32 m0, s5, 6144
    s_nop 0
    buffer_load_dwordx4 v11, s[36:39], s6 offen sc1 lds
    s_add_u32 s6, s6, 1024
    s_cmp_eq_u32 s6, 16384
    s_cselect_b32 s6, 0, s6
    s_add_u32 m0, s5, 8192
    s_nop 0
    buffer_load_dwordx4 v8, s[36:39], s6 offen sc1 lds
    s_add_u32 m0, s5, 10240
    s_nop 0
    buffer_load_dwordx4 v9, s[36:39], s6 offen sc1 lds
    s_add_u32 m0, s5, 12288
    s_nop 0
    buffer_load_dwordx4 v10, s[36:39], s6 offen sc1 lds
    s_add_u32 m0, s5, 14336
    s_nop 0
    buffer_load_dwordx4 v11, s[36:39], s6 offen sc1 lds
    s_add_u32 s6, s6, 1024
    s_cmp_eq_u32 s6, 16384
    s_cselect_b32 s6, 0, s6
    s_add_u32 s5, s5, 16384
    s_cmp_eq_u32 s5, s11
    s_cselect_b32 s5, s10, s5
    s_add_u32 s9, s9, 1
    s_cmp_lt_u32 s9, 2
    s_cbranch_scc1 L_li_s1l1
    s_waitcnt vmcnt(8)
    s_barrier
    s_cmp_lt_u32 s9, 8
    s_cbranch_scc1 L_li_s1l1
    v_pk_add_f32 v[20:21], v[20:21], v[56:57] op_sel:[0,0] op_sel_hi:[1,1]
    v_pk_add_f32 v[22:23], v[22:23], v[58:59] op_sel:[0,0] op_sel_hi:[1,1]
    v_pk_add_f32 v[24:25], v[24:25], v[60:61] op_sel:[0,0] op_sel_hi:[1,1]
    v_pk_add_f32 v[26:27], v[26:27], v[62:63] op_sel:[0,0] op_sel_hi:[1,1]
    v_pk_add_f32 v[28:29], v[28:29], v[64:65] op_sel:[0,0] op_sel_hi:[1,1]
    v_pk_add_f32 v[30:31], v[30:31], v[66:67] op_sel:[0,0] op_sel_hi:[1,1]
    v_pk_add_f32 v[32:33], v[32:33], v[68:69] op_sel:[0,0] op_sel_hi:[1,1]
    v_pk_add_f32 v[34:35], v[34:35], v[70:71] op_sel:[0,0] op_sel_hi:[1,1]
    v_pk_add_f32 v[20:21], v[20:21], v[22:23] op_sel:[0,0] op_sel_hi:[1,1]
    v_pk_add_f32 v[24:25], v[24:25], v[26:27] op_sel:[0,0] op_sel_hi:[1,1]
    v_pk_add_f32 v[28:29], v[28:29], v[30:31] op_sel:[0,0] op_sel_hi:[1,1]
    v_pk_add_f32 v[32:33], v[32:33], v[34:35] op_sel:[0,0] op_sel_hi:[1,1]
    v_and_b32 v17, 1, v1
    v_cmp_eq_u32 vcc, 1, v17
    v_add_f32_dpp v20, v20, v20 quad_perm:[1,0,3,2] row_mask:0xf bank_mask:0xf
    v_add_f32_dpp v21, v21, v21 quad_perm:[1,0,3,2] row_mask:0xf bank_mask:0xf
    v_add_f32_dpp v24, v24, v24 quad_perm:[1,0,3,2] row_mask:0xf bank_mask:0xf
    v_add_f32_dpp v25, v25, v25 quad_perm:[1,0,3,2] row_mask:0xf bank_mask:0xf
    v_add_f32_dpp v28, v28, v28 quad_perm:[1,0,3,2] row_mask:0xf bank_mask:0xf
    v_add_f32_dpp v29, v29, v29 quad_perm:[1,0,3,2] row_mask:0xf bank_mask:0xf
    v_add_f32_dpp v32, v32, v32 quad_perm:[1,0,3,2] row_mask:0xf bank_mask:0xf
    v_add_f32_dpp v33, v33, v33 quad_perm:[1,0,3,2] row_mask:0xf bank_mask:0xf
    v_cndmask_b32 v20, v20, v24, vcc
    v_cndmask_b32 v21, v21, v25, vcc
    v_cndmask_b32 v28, v28, v32, vcc
    v_cndmask_b32 v29, v29, v33, vcc
    s_waitcnt vmcnt(0)
    s_barrier
    v_and_b32 v17, 2, v1
    v_cmp_eq_u32 vcc, 2, v17
    v_add_f32_dpp v20, v20, v20 quad_perm:[2,3,0,1] row_mask:0xf bank_mask:0xf
    v_add_f32_dpp v21, v21, v21 quad_perm:[2,3,0,1] row_mask:0xf bank_mask:0xf
    v_add_f32_dpp v28, v28, v28 quad_perm:[2,3,0,1] row_mask:0xf bank_mask:0xf
    v_add_f32_dpp v29, v29, v29 quad_perm:[2,3,0,1] row_mask:0xf bank_mask:0xf
    v_cndmask_b32 v20, v20, v28, vcc
    v_cndmask_b32 v21, v21, v29, vcc
    v_mul_f32 v22, 0x3b000000, v20
    v_mul_f32 v17, 0x3b000000, v21
    v_fma_f32 v17, -v22, v22, v17
    v_max_f32 v17, 0, v17
    v_add_f32 v17, 0x3727c5ac, v17
    v_rsq_f32 v23, v17
    s_lshl_b32 s8, s4, 8
    s_add_u32 s8, s8, 156672
    v_add_u32 v18, s8, v55
    ds_write_b32 v18, v22
    ds_write_b32 v18, v23 offset:512
    s_waitcnt lgkmcnt(0)
    s_barrier
    s_barrier
    s_lshr_b32 s13, s61, 3
    s_lshl_b32 s12, s60, 1
    s_add_u32 s12, s12, s13
    s_and_b32 s13, s61, 7
    s_lshl_b32 s14, s13, 1
    s_mul_i32 s8, s12, 176128
    s_add_u32 s8, s8, 8388608
    s_mul_i32 s10, s4, 44032
    s_add_u32 s10, s10, s8
    v_lshl_add_u32 v8, v1, 4, s10
    v_add_u32 v9, 88064, v8
    s_mul_i32 s6, s14, 1024
    s_lshl_b32 s10, s4, 10
    s_add_u32 s10, s10, 98304
    s_mov_b32 s5, s10
    s_add_u32 s11, s10, 49152
    s_mov_b32 s9, 0
    s_lshr_b32 s15, s96, 5
    s_lshl_b32 s15, s15, 7
    s_add_u32 s15, s15, 23216128
    s_add_u32 s97, s15, 1024
    s_lshr_b32 s97, s96, 4
    s_lshl_b32 s97, s97, 8
    s_add_u32 s97, s97, 23222272
    s_barrier
    s_cmp_eq_u32 s3, 4
    s_cbranch_scc0 L_ns_s2l1g
    s_mov_b64 exec, 1
    s_cmp_eq_u32 s63, 0
    s_cbranch_scc1 L_hom_s2l1g
    buffer_wbl2 sc1
    s_waitcnt vmcnt(0)
    buffer_store_dword v40, v43, s[44:47], s15 offen sc1
    s_branch L_sg_s2l1g
L_hom_s2l1g:
    buffer_store_dword v40, v43, s[44:47], s15 offen
L_sg_s2l1g:
    s_mov_b64 exec, -1
    s_and_b32 s85, s96, 31
    s_cmp_eq_u32 s85, 0
    s_cbranch_scc0 L_nl_s2l1g
    s_mov_b32 s84, 131072
    s_mov_b32 exec_hi, 0
L_poll_gs2l1g:
    buffer_load_dword v44, v42, s[44:47], s15 offen sc1
    s_waitcnt vmcnt(0)
    v_cmp_eq_u32 vcc, 0, v44
    s_nop 1
    s_cbranch_vccz L_pok_gs2l1g
    s_sub_u32 s84, s84, 1
    s_cbranch_scc1 L_pok_gs2l1g
    s_sleep 0
    s_branch L_poll_gs2l1g
L_pok_gs2l1g:
    s_mov_b64 exec, -1
    s_mov_b32 s85, 23222272
    s_mov_b64 exec, 0xffff
    buffer_store_dword v40, v48, s[44:47], s85 offen sc1
    s_mov_b64 exec, -1
    s_branch L_nl2_s2l1g
L_nl_s2l1g:
    s_sleep 16
L_nl2_s2l1g:
    s_mov_b32 s84, 131072
    s_mov_b64 exec, 255
L_poll_s2l1g:
    buffer_load_dword v44, v42, s[44:47], s97 offen sc1
    s_waitcnt vmcnt(0)
    v_cmp_eq_u32 vcc, 0, v44
    s_nop 1
    s_cbranch_vccz L_pok_s2l1g
    s_sub_u32 s84, s84, 1
    s_cbranch_scc1 L_pok_s2l1g
    s_sleep 0
    s_branch L_poll_s2l1g
L_pok_s2l1g:
    s_mov_b64 exec, -1
L_ns_s2l1g:
    s_barrier
    s_lshl_b32 s15, s60, 7
    s_add_u32 s15, s15, 23207936
    s_barrier
    s_cmp_eq_u32 s3, 4
    s_cbranch_scc0 L_ns_s2l1t
    s_mov_b64 exec, 1
    s_cmp_eq_u32 s63, 0
    s_cbranch_scc1 L_hom_s2l1t
    buffer_wbl2 sc1
    s_waitcnt vmcnt(0)
    buffer_store_dword v40, v41, s[44:47], s15 offen sc1
    s_branch L_sg_s2l1t
L_hom_s2l1t:
    buffer_store_dword v40, v41, s[44:47], s15 offen
L_sg_s2l1t:
    s_mov_b64 exec, -1
L_ns_s2l1t:
    s_mov_b32 s84, 131072
    s_mov_b64 exec, 65535
L_poll_s2l1t:
    buffer_load_dword v44, v42, s[44:47], s15 offen sc1
    s_waitcnt vmcnt(0)
    v_cmp_eq_u32 vcc, 0, v44
    s_nop 1
    s_cbranch_vccz L_pok_s2l1t
    s_sub_u32 s84, s84, 1
    s_cbranch_scc1 L_pok_s2l1t
    s_sleep 0
    s_branch L_poll_s2l1t
L_pok_s2l1t:
    s_mov_b64 exec, -1
L_li_s2l1:
    s_add_u32 m0, s5, 0
    s_nop 0
    buffer_load_dwordx4 v8, s[36:39], s6 offen sc1 lds
    s_add_u32 m0, s5, 2048
    s_nop 0
    buffer_load_dwordx4 v9, s[36:39], s6 offen sc1 lds
    s_add_u32 s6, s6, 1024
    s_cmp_eq_u32 s6, 16384
    s_cselect_b32 s6, 0, s6
    s_add_u32 m0, s5, 4096
    s_nop 0
    buffer_load_dwordx4 v8, s[36:39], s6 offen sc1 lds
    s_add_u32 m0, s5, 6144
    s_nop 0
    buffer_load_dwordx4 v9, s[36:39], s6 offen sc1 lds
    s_add_u32 s6, s6, 1024
    s_cmp_eq_u32 s6, 16384
    s_cselect_b32 s6, 0, s6
    s_add_u32 s5, s5, 8192
    s_cmp_eq_u32 s5, s11
    s_cselect_b32 s5, s10, s5
    s_add_u32 s9, s9, 1
    s_cmp_lt_u32 s9, 4
    s_cbranch_scc1 L_li_s2l1
    s_waitcnt vmcnt(12)
    s_barrier
    s_cmp_lt_u32 s9, 8
    s_cbranch_scc1 L_li_s2l1
    s_waitcnt vmcnt(8)
    s_barrier
    s_waitcnt vmcnt(4)
    s_barrier
    s_waitcnt vmcnt(0)
    s_barrier
    s_barrier
    s_mov_b32 s12, s60
    s_mov_b32 s13, s61
    s_mov_b32 s14, s61
    s_lshl_b32 s8, s12, 17
    s_add_u32 s8, s8, 4194304
    s_mul_i32 s10, s4, 16384
    s_add_u32 s10, s10, s8
    v_lshl_add_u32 v8, v1, 4, s10
    v_add_u32 v9, 32768, v8
    v_add_u32 v10, 65536, v8
    v_add_u32 v11, 98304, v8
    s_mul_i32 s6, s14, 1024
    s_lshl_b32 s10, s4, 10
    s_add_u32 s10, s10, 98304
    s_mov_b32 s5, s10
    s_add_u32 s11, s10, 49152
    s_mov_b32 s9, 0
    s_cmp_eq_u32 s61, 15
    s_cselect_b32 s38, 0, s38
    s_lshl_b32 s7, s12, 1
    s_add_u32 s7, s7, s4
    s_lshl_b32 s7, s7, 12
    s_add_u32 s7, s7, 23592960
    s_lshl_b32 s15, s60, 7
    s_add_u32 s15, s15, 23209984
    s_barrier
    s_cmp_eq_u32 s3, 4
    s_cbranch_scc0 L_ns_s3l1t
    s_mov_b64 exec, 1
    s_cmp_eq_u32 s63, 0
    s_cbranch_scc1 L_hom_s3l1t
    buffer_wbl2 sc1
    s_waitcnt vmcnt(0)
    buffer_store_dword v40, v41, s[44:47], s15 offen sc1
    s_branch L_sg_s3l1t
L_hom_s3l1t:
    buffer_store_dword v40, v41, s[44:47], s15 offen
L_sg_s3l1t:
    s_mov_b64 exec, -1
L_ns_s3l1t:
    s_mov_b32 s84, 131072
    s_mov_b64 exec, 65535
L_poll_s3l1t:
    buffer_load_dword v44, v42, s[44:47], s15 offen sc1
    s_waitcnt vmcnt(0)
    v_cmp_eq_u32 vcc, 0, v44
    s_nop 1
    s_cbranch_vccz L_pok_s3l1t
    s_sub_u32 s84, s84, 1
    s_cbranch_scc1 L_pok_s3l1t
    s_sleep 0
    s_branch L_poll_s3l1t
L_pok_s3l1t:
    s_mov_b64 exec, -1
    buffer_load_dwordx4 v[20:23], v16, s[44:47], s7 offen offset:0 sc1
    buffer_load_dwordx4 v[24:27], v16, s[44:47], s7 offen offset:1024 sc1
    buffer_load_dwordx4 v[28:31], v16, s[44:47], s7 offen offset:2048 sc1
    buffer_load_dwordx4 v[32:35], v16, s[44:47], s7 offen offset:3072 sc1
    s_add_u32 s7, s7, 131072
    buffer_load_dwordx4 v[56:59], v16, s[44:47], s7 offen offset:0 sc1
    buffer_load_dwordx4 v[60:63], v16, s[44:47], s7 offen offset:1024 sc1
    buffer_load_dwordx4 v[64:67], v16, s[44:47], s7 offen offset:2048 sc1
    buffer_load_dwordx4 v[68:71], v16, s[44:47], s7 offen offset:3072 sc1
L_li_s3l1:
    s_add_u32 m0, s5, 0
    s_nop 0
    buffer_load_dwordx4 v8, s[36:39], s6 offen sc1 lds
    s_add_u32 m0, s5, 2048
    s_nop 0
    buffer_load_dwordx4 v9, s[36:39], s6 offen sc1 lds
    s_add_u32 m0, s5, 4096
    s_nop 0
    buffer_load_dwordx4 v10, s[36:39], s6 offen sc1 lds
    s_add_u32 m0, s5, 6144
    s_nop 0
    buffer_load_dwordx4 v11, s[36:39], s6 offen sc1 lds
    s_add_u32 s6, s6, 1024
    s_cmp_eq_u32 s6, 16384
    s_cselect_b32 s6, 0, s6
    s_add_u32 m0, s5, 8192
    s_nop 0
    buffer_load_dwordx4 v8, s[36:39], s6 offen sc1 lds
    s_add_u32 m0, s5, 10240
    s_nop 0
    buffer_load_dwordx4 v9, s[36:39], s6 offen sc1 lds
    s_add_u32 m0, s5, 12288
    s_nop 0
    buffer_load_dwordx4 v10, s[36:39], s6 offen sc1 lds
    s_add_u32 m0, s5, 14336
    s_nop 0
    buffer_load_dwordx4 v11, s[36:39], s6 offen sc1 lds
    s_add_u32 s6, s6, 1024
    s_cmp_eq_u32 s6, 16384
    s_cselect_b32 s6, 0, s6
    s_add_u32 s5, s5, 16384
    s_cmp_eq_u32 s5, s11
    s_cselect_b32 s5, s10, s5
    s_add_u32 s9, s9, 1
    s_cmp_lt_u32 s9, 2
    s_cbranch_scc1 L_li_s3l1
    s_waitcnt vmcnt(8)
    s_barrier
    s_cmp_lt_u32 s9, 8
    s_cbranch_scc1 L_li_s3l1
    s_mul_i32 s53, s12, 352256
    s_mul_i32 s54, s13, 3072
    s_add_u32 s53, s53, s54
    s_add_u32 s53, s53, 8388608
    s_lshl_b32 s54, s4, 10
    s_add_u32 s54, s54, s53
    buffer_load_dword v52, v49, s[44:47], s54 offen sc1
    s_cmp_eq_u32 s4, 0
    s_cselect_b32 exec_lo, -1, 0
    s_cselect_b32 exec_hi, 0, -1
    buffer_load_dword v53, v49, s[44:47], s53 offen offset:2048 sc1
    s_mov_b64 exec, -1
    v_pk_add_f32 v[20:21], v[20:21], v[56:57] op_sel:[0,0] op_sel_hi:[1,1]
    v_pk_add_f32 v[22:23], v[22:23], v[58:59] op_sel:[0,0] op_sel_hi:[1,1]
    v_pk_add_f32 v[24:25], v[24:25], v[60:61] op_sel:[0,0] op_sel_hi:[1,1]
    v_pk_add_f32 v[26:27], v[26:27], v[62:63] op_sel:[0,0] op_sel_hi:[1,1]
    v_pk_add_f32 v[28:29], v[28:29], v[64:65] op_sel:[0,0] op_sel_hi:[1,1]
    v_pk_add_f32 v[30:31], v[30:31], v[66:67] op_sel:[0,0] op_sel_hi:[1,1]
    v_pk_add_f32 v[32:33], v[32:33], v[68:69] op_sel:[0,0] op_sel_hi:[1,1]
    v_pk_add_f32 v[34:35], v[34:35], v[70:71] op_sel:[0,0] op_sel_hi:[1,1]
    v_pk_add_f32 v[20:21], v[20:21], v[22:23] op_sel:[0,0] op_sel_hi:[1,1]
    v_pk_add_f32 v[24:25], v[24:25], v[26:27] op_sel:[0,0] op_sel_hi:[1,1]
    v_pk_add_f32 v[28:29], v[28:29], v[30:31] op_sel:[0,0] op_sel_hi:[1,1]
    v_pk_add_f32 v[32:33], v[32:33], v[34:35] op_sel:[0,0] op_sel_hi:[1,1]
    v_and_b32 v17, 1, v1
    v_cmp_eq_u32 vcc, 1, v17
    v_add_f32_dpp v20, v20, v20 quad_perm:[1,0,3,2] row_mask:0xf bank_mask:0xf
    v_add_f32_dpp v21, v21, v21 quad_perm:[1,0,3,2] row_mask:0xf bank_mask:0xf
    v_add_f32_dpp v24, v24, v24 quad_perm:[1,0,3,2] row_mask:0xf bank_mask:0xf
    v_add_f32_dpp v25, v25, v25 quad_perm:[1,0,3,2] row_mask:0xf bank_mask:0xf
    v_add_f32_dpp v28, v28, v28 quad_perm:[1,0,3,2] row_mask:0xf bank_mask:0xf
    v_add_f32_dpp v29, v29, v29 quad_perm:[1,0,3,2] row_mask:0xf bank_mask:0xf
    v_add_f32_dpp v32, v32, v32 quad_perm:[1,0,3,2] row_mask:0xf bank_mask:0xf
    v_add_f32_dpp v33, v33, v33 quad_perm:[1,0,3,2] row_mask:0xf bank_mask:0xf
    v_cndmask_b32 v20, v20, v24, vcc
    v_cndmask_b32 v21, v21, v25, vcc
    v_cndmask_b32 v28, v28, v32, vcc
    v_cndmask_b32 v29, v29, v33, vcc
    s_waitcnt vmcnt(2)
    s_barrier
    v_and_b32 v17, 2, v1
    v_cmp_eq_u32 vcc, 2, v17
    v_add_f32_dpp v20, v20, v20 quad_perm:[2,3,0,1] row_mask:0xf bank_mask:0xf
    v_add_f32_dpp v21, v21, v21 quad_perm:[2,3,0,1] row_mask:0xf bank_mask:0xf
    v_add_f32_dpp v28, v28, v28 quad_perm:[2,3,0,1] row_mask:0xf bank_mask:0xf
    v_add_f32_dpp v29, v29, v29 quad_perm:[2,3,0,1] row_mask:0xf bank_mask:0xf
    v_cndmask_b32 v20, v20, v28, vcc
    v_cndmask_b32 v21, v21, v29, vcc
    v_mul_f32 v22, 0x3b000000, v20
    v_mul_f32 v17, 0x3b000000, v21
    v_fma_f32 v17, -v22, v22, v17
    v_max_f32 v17, 0, v17
    v_add_f32 v17, 0x3727c5ac, v17
    v_rsq_f32 v23, v17
    s_lshl_b32 s8, s4, 8
    s_add_u32 s8, s8, 147456
    v_add_u32 v18, s8, v55
    ds_write_b32 v18, v22
    ds_write_b32 v18, v23 offset:512
    s_waitcnt lgkmcnt(0)
    s_barrier
    s_lshr_b32 s13, s61, 3
    s_lshl_b32 s12, s60, 1
    s_add_u32 s12, s12, s13
    s_and_b32 s13, s61, 7
    s_mul_i32 s14, s13, 5
    s_mul_i32 s8, s12, 176128
    s_add_u32 s8, s8, 8388608
    s_mul_i32 s10, s4, 44032
    s_add_u32 s10, s10, s8
    v_lshl_add_u32 v8, v1, 4, s10
    v_add_u32 v9, 88064, v8
    s_mul_i32 s6, s14, 1024
    s_lshl_b32 s10, s4, 10
    s_add_u32 s10, s10, 98304
    s_mov_b32 s5, s10
    s_add_u32 s11, s10, 49152
    s_mov_b32 s9, 0
    s_mov_b32 s38, 268435456
    s_lshl_b32 s15, s60, 7
    s_add_u32 s15, s15, 23212032
    s_barrier
    s_cmp_eq_u32 s3, 4
    s_cbranch_scc0 L_ns_s4l1t
    s_mov_b64 exec, 1
    s_cmp_eq_u32 s63, 0
    s_cbranch_scc1 L_hom_s4l1t
    buffer_wbl2 sc1
    s_waitcnt vmcnt(0)
    buffer_store_dword v40, v41, s[44:47], s15 offen sc1
    s_branch L_sg_s4l1t
L_hom_s4l1t:
    buffer_store_dword v40, v41, s[44:47], s15 offen
L_sg_s4l1t:
    s_mov_b64 exec, -1
L_ns_s4l1t:
    s_mov_b32 s84, 131072
    s_mov_b64 exec, 65535
L_poll_s4l1t:
    buffer_load_dword v44, v42, s[44:47], s15 offen sc1
    s_waitcnt vmcnt(0)
    v_cmp_eq_u32 vcc, 0, v44
    s_nop 1
    s_cbranch_vccz L_pok_s4l1t
    s_sub_u32 s84, s84, 1
    s_cbranch_scc1 L_pok_s4l1t
    s_sleep 0
    s_branch L_poll_s4l1t
L_pok_s4l1t:
    s_mov_b64 exec, -1
L_li_s4l1:
    s_cmp_eq_u32 s6, 44032
    s_cselect_b32 s8, 0x10000000, s6
    s_add_u32 m0, s5, 0
    s_nop 0
    buffer_load_dwordx4 v8, s[36:39], s8 offen sc1 lds
    s_add_u32 m0, s5, 2048
    s_nop 0
    buffer_load_dwordx4 v9, s[36:39], s8 offen sc1 lds
    s_add_u32 s6, s6, 1024
    s_cmp_eq_u32 s6, 45056
    s_cselect_b32 s6, 0, s6
    s_cmp_eq_u32 s6, 44032
    s_cselect_b32 s8, 0x10000000, s6
    s_add_u32 m0, s5, 4096
    s_nop 0
    buffer_load_dwordx4 v8, s[36:39], s8 offen sc1 lds
    s_add_u32 m0, s5, 6144
    s_nop 0
    buffer_load_dwordx4 v9, s[36:39], s8 offen sc1 lds
    s_add_u32 s6, s6, 1024
    s_cmp_eq_u32 s6, 45056
    s_cselect_b32 s6, 0, s6
    s_add_u32 s5, s5, 8192
    s_cmp_eq_u32 s5, s11
    s_cselect_b32 s5, s10, s5
    s_add_u32 s9, s9, 1
    s_cmp_lt_u32 s9, 4
    s_cbranch_scc1 L_li_s4l1
    s_waitcnt vmcnt(12)
    s_barrier
    s_cmp_lt_u32 s9, 22
    s_cbranch_scc1 L_li_s4l1
    s_waitcnt vmcnt(8)
    s_barrier
    s_waitcnt vmcnt(4)
    s_barrier
    s_waitcnt vmcnt(0)
    s_barrier
    s_endpgm
L_comp:
    s_mov_b32 s12, s60
    s_mov_b32 s13, s61
    s_lshl_b32 s14, s61, 1
    s_and_b32 s14, s14, 15
    s_lshl_b32 s4, s3, 11
    s_add_u32 s4, s4, 98304
    v_lshrrev_b32 v4, 2, v3
    v_sub_u32 v4, 4, v4
    v_and_b32 v4, 3, v4
    v_xor_b32 v4, v4, v2
    v_lshlrev_b32 v4, 4, v4
    v_lshl_add_u32 v8, v3, 6, v4
    v_add_u32 v8, s4, v8
    v_and_b32 v4, 1, v2
    v_lshlrev_b32 v4, 5, v4
    v_lshl_add_u32 v4, v2, 8, v4
    v_bfe_u32 v5, v1, 2, 2
    v_lshl_add_u32 v4, v5, 6, v4
    v_and_b32 v5, 3, v1
    v_lshl_add_u32 v9, v5, 3, v4
    v_xor_b32 v10, 32, v9
    v_add_u32 v11, 49152, v9
    v_add_u32 v12, 49152, v10
    s_lshl_b32 s10, s13, 11
    s_add_u32 s10, s10, 23068672
    s_lshl_b32 s6, s3, 9
    s_add_u32 s5, s10, s6
    v_lshl_add_u32 v17, v1, 2, s5
    s_lshl_b32 s11, s13, 7
    s_add_u32 s11, s11, 23101440
    v_lshl_add_u32 v18, v1, 2, s11
    v_lshlrev_b32 v14, 4, v2
    v_add_u32 v14, 157696, v14
    v_lshlrev_b32 v15, 2, v3
    v_add_u32 v15, 157696, v15
    v_lshrrev_b32 v4, 1, v1
    v_and_b32 v5, 1, v1
    v_lshlrev_b32 v4, 5, v4
    v_lshl_add_u32 v4, v5, 2, v4
    v_add_u32 v21, 4, v4
    s_lshl_b32 s7, s12, 3
    s_lshl_b32 s5, s3, 1
    s_add_u32 s7, s7, s5
    s_mul_i32 s7, s7, 43
    s_add_u32 s7, s7, s13
    s_lshl_b32 s7, s7, 10
    s_add_u32 s7, s7, 8388608
    v_mov_b32 v24, 0x3f803f80
    v_mov_b32 v25, 0x3f803f80
    v_mov_b32 v26, 0x3f803f80
    v_mov_b32 v27, 0x3f803f80
    v_mov_b32 v112, 0
    v_mov_b32 v113, 0
    v_mov_b32 v114, 0
    v_mov_b32 v115, 0
    v_mov_b32 v116, 0
    v_mov_b32 v117, 0
    v_mov_b32 v118, 0
    v_mov_b32 v119, 0
    v_mov_b32 v120, 0
    v_mov_b32 v121, 0
    v_mov_b32 v122, 0
    v_mov_b32 v123, 0
    v_mov_b32 v124, 0
    v_mov_b32 v125, 0
    v_mov_b32 v126, 0
    v_mov_b32 v127, 0
    s_cmp_eq_u32 s3, 1
    s_cbranch_scc0 L_noif
    s_cmp_lt_u32 s2, 16
    s_cbranch_scc0 L_noif
    s_mov_b64 exec, 1
    s_lshr_b32 s4, s2, 1
    s_lshl_b32 s4, s4, 5
    s_and_b32 s5, s2, 1
    s_lshl_b32 s5, s5, 2
    s_add_u32 s4, s4, s5
    s_add_u32 s4, s4, 4
    v_mov_b32 v22, s4
    v_mov_b32 v23, 1
    s_waitcnt vmcnt(0)
    buffer_store_dword v23, v22, s[48:51], 0 offen sc1
    s_mov_b64 exec, -1
L_noif:
    s_barrier
    ds_read_b128 v[128:131], v8 offset:0
    ds_read_b64_tr_b16 v[64:65], v9 offset:0
    ds_read_b64_tr_b16 v[66:67], v9 offset:1024
    ds_read_b128 v[132:135], v8 offset:1024
    ds_read_b64_tr_b16 v[68:69], v10 offset:0
    ds_read_b64_tr_b16 v[70:71], v10 offset:1024
    ds_read_b64_tr_b16 v[72:73], v9 offset:2048
    ds_read_b64_tr_b16 v[74:75], v9 offset:3072
    ds_read_b64_tr_b16 v[76:77], v10 offset:2048
    ds_read_b64_tr_b16 v[78:79], v10 offset:3072
    s_waitcnt lgkmcnt(7)
    v_mfma_f32_16x16x32_bf16 v[32:35], v[128:131], v[64:67], 0
    ds_read_b128 v[136:139], v8 offset:8192
    s_waitcnt lgkmcnt(7)
    v_mfma_f32_16x16x32_bf16 v[36:39], v[132:135], v[64:67], 0
    ds_read_b64_tr_b16 v[80:81], v9 offset:4096
    s_waitcnt lgkmcnt(6)
    v_mfma_f32_16x16x32_bf16 v[40:43], v[128:131], v[68:71], 0
    ds_read_b64_tr_b16 v[82:83], v9 offset:5120
    v_mfma_f32_16x16x32_bf16 v[44:47], v[132:135], v[68:71], 0
    ds_read_b128 v[140:143], v8 offset:9216
    v_mfma_f32_16x16x32_bf16 v[96:99], v[24:27], v[128:131], 0
    ds_read_b64_tr_b16 v[84:85], v10 offset:4096
    v_mfma_f32_16x16x32_bf16 v[104:107], v[128:131], v[128:131], 0
    ds_read_b64_tr_b16 v[86:87], v10 offset:5120
    s_waitcnt lgkmcnt(8)
    v_mfma_f32_16x16x32_bf16 v[48:51], v[128:131], v[72:75], 0
    ds_read_b64_tr_b16 v[88:89], v9 offset:6144
    v_mfma_f32_16x16x32_bf16 v[52:55], v[132:135], v[72:75], 0
    ds_read_b64_tr_b16 v[90:91], v9 offset:7168
    s_waitcnt lgkmcnt(8)
    v_mfma_f32_16x16x32_bf16 v[56:59], v[128:131], v[76:79], 0
    ds_read_b64_tr_b16 v[92:93], v10 offset:6144
    v_mfma_f32_16x16x32_bf16 v[60:63], v[132:135], v[76:79], 0
    ds_read_b64_tr_b16 v[94:95], v10 offset:7168
    v_mfma_f32_16x16x32_bf16 v[100:103], v[24:27], v[132:135], 0
    v_mfma_f32_16x16x32_bf16 v[108:111], v[132:135], v[132:135], 0
    v_mfma_f32_16x16x32_bf16 v[112:115], v[24:27], v[64:67], v[112:115]
    v_mfma_f32_16x16x32_bf16 v[116:119], v[24:27], v[68:71], v[116:119]
    v_mfma_f32_16x16x32_bf16 v[120:123], v[24:27], v[72:75], v[120:123]
    v_mfma_f32_16x16x32_bf16 v[124:127], v[24:27], v[76:79], v[124:127]
    s_waitcnt lgkmcnt(0)
    s_barrier
    v_mfma_f32_16x16x32_bf16 v[32:35], v[136:139], v[80:83], v[32:35]
    ds_read_b128 v[144:147], v8 offset:16384
    v_mfma_f32_16x16x32_bf16 v[36:39], v[140:143], v[80:83], v[36:39]
    ds_read_b64_tr_b16 v[64:65], v9 offset:8192
    v_mfma_f32_16x16x32_bf16 v[40:43], v[136:139], v[84:87], v[40:43]
    ds_read_b64_tr_b16 v[66:67], v9 offset:9216
    v_mfma_f32_16x16x32_bf16 v[44:47], v[140:143], v[84:87], v[44:47]
    ds_read_b128 v[148:151], v8 offset:17408
    v_mfma_f32_16x16x32_bf16 v[96:99], v[24:27], v[136:139], v[96:99]
    ds_read_b64_tr_b16 v[68:69], v10 offset:8192
    v_mfma_f32_16x16x32_bf16 v[104:107], v[136:139], v[136:139], v[104:107]
    ds_read_b64_tr_b16 v[70:71], v10 offset:9216
    v_mfma_f32_16x16x32_bf16 v[48:51], v[136:139], v[88:91], v[48:51]
    ds_read_b64_tr_b16 v[72:73], v9 offset:10240
    v_mfma_f32_16x16x32_bf16 v[52:55], v[140:143], v[88:91], v[52:55]
    ds_read_b64_tr_b16 v[74:75], v9 offset:11264
    v_mfma_f32_16x16x32_bf16 v[56:59], v[136:139], v[92:95], v[56:59]
    ds_read_b64_tr_b16 v[76:77], v10 offset:10240
    v_mfma_f32_16x16x32_bf16 v[60:63], v[140:143], v[92:95], v[60:63]
    ds_read_b64_tr_b16 v[78:79], v10 offset:11264
    v_mfma_f32_16x16x32_bf16 v[100:103], v[24:27], v[140:143], v[100:103]
    v_mfma_f32_16x16x32_bf16 v[108:111], v[140:143], v[140:143], v[108:111]
    v_mfma_f32_16x16x32_bf16 v[112:115], v[24:27], v[80:83], v[112:115]
    v_mfma_f32_16x16x32_bf16 v[116:119], v[24:27], v[84:87], v[116:119]
    v_mfma_f32_16x16x32_bf16 v[120:123], v[24:27], v[88:91], v[120:123]
    v_mfma_f32_16x16x32_bf16 v[124:127], v[24:27], v[92:95], v[124:127]
    s_waitcnt lgkmcnt(7)
    v_mfma_f32_16x16x32_bf16 v[32:35], v[144:147], v[64:67], v[32:35]
    ds_read_b128 v[152:155], v8 offset:24576
    s_waitcnt lgkmcnt(7)
    v_mfma_f32_16x16x32_bf16 v[36:39], v[148:151], v[64:67], v[36:39]
    ds_read_b64_tr_b16 v[80:81], v9 offset:12288
    s_waitcnt lgkmcnt(6)
    v_mfma_f32_16x16x32_bf16 v[40:43], v[144:147], v[68:71], v[40:43]
    ds_read_b64_tr_b16 v[82:83], v9 offset:13312
    v_mfma_f32_16x16x32_bf16 v[44:47], v[148:151], v[68:71], v[44:47]
    ds_read_b128 v[156:159], v8 offset:25600
    v_mfma_f32_16x16x32_bf16 v[96:99], v[24:27], v[144:147], v[96:99]
    ds_read_b64_tr_b16 v[84:85], v10 offset:12288
    v_mfma_f32_16x16x32_bf16 v[104:107], v[144:147], v[144:147], v[104:107]
    ds_read_b64_tr_b16 v[86:87], v10 offset:13312
    s_waitcnt lgkmcnt(8)
    v_mfma_f32_16x16x32_bf16 v[48:51], v[144:147], v[72:75], v[48:51]
    ds_read_b64_tr_b16 v[88:89], v9 offset:14336
    v_mfma_f32_16x16x32_bf16 v[52:55], v[148:151], v[72:75], v[52:55]
    ds_read_b64_tr_b16 v[90:91], v9 offset:15360
    s_waitcnt lgkmcnt(8)
    v_mfma_f32_16x16x32_bf16 v[56:59], v[144:147], v[76:79], v[56:59]
    ds_read_b64_tr_b16 v[92:93], v10 offset:14336
    v_mfma_f32_16x16x32_bf16 v[60:63], v[148:151], v[76:79], v[60:63]
    ds_read_b64_tr_b16 v[94:95], v10 offset:15360
    v_mfma_f32_16x16x32_bf16 v[100:103], v[24:27], v[148:151], v[100:103]
    v_mfma_f32_16x16x32_bf16 v[108:111], v[148:151], v[148:151], v[108:111]
    v_mfma_f32_16x16x32_bf16 v[112:115], v[24:27], v[64:67], v[112:115]
    v_mfma_f32_16x16x32_bf16 v[116:119], v[24:27], v[68:71], v[116:119]
    v_mfma_f32_16x16x32_bf16 v[120:123], v[24:27], v[72:75], v[120:123]
    v_mfma_f32_16x16x32_bf16 v[124:127], v[24:27], v[76:79], v[124:127]
    s_waitcnt lgkmcnt(0)
    s_barrier
    v_mfma_f32_16x16x32_bf16 v[32:35], v[152:155], v[80:83], v[32:35]
    ds_read_b128 v[160:163], v8 offset:32768
    v_mfma_f32_16x16x32_bf16 v[36:39], v[156:159], v[80:83], v[36:39]
    ds_read_b64_tr_b16 v[64:65], v9 offset:16384
    v_mfma_f32_16x16x32_bf16 v[40:43], v[152:155], v[84:87], v[40:43]
    ds_read_b64_tr_b16 v[66:67], v9 offset:17408
    v_mfma_f32_16x16x32_bf16 v[44:47], v[156:159], v[84:87], v[44:47]
    ds_read_b128 v[164:167], v8 offset:33792
    v_mfma_f32_16x16x32_bf16 v[96:99], v[24:27], v[152:155], v[96:99]
    ds_read_b64_tr_b16 v[68:69], v10 offset:16384
    v_mfma_f32_16x16x32_bf16 v[104:107], v[152:155], v[152:155], v[104:107]
    ds_read_b64_tr_b16 v[70:71], v10 offset:17408
    v_mfma_f32_16x16x32_bf16 v[48:51], v[152:155], v[88:91], v[48:51]
    ds_read_b64_tr_b16 v[72:73], v9 offset:18432
    v_mfma_f32_16x16x32_bf16 v[52:55], v[156:159], v[88:91], v[52:55]
    ds_read_b64_tr_b16 v[74:75], v9 offset:19456
    v_mfma_f32_16x16x32_bf16 v[56:59], v[152:155], v[92:95], v[56:59]
    ds_read_b64_tr_b16 v[76:77], v10 offset:18432
    v_mfma_f32_16x16x32_bf16 v[60:63], v[156:159], v[92:95], v[60:63]
    ds_read_b64_tr_b16 v[78:79], v10 offset:19456
    v_mfma_f32_16x16x32_bf16 v[100:103], v[24:27], v[156:159], v[100:103]
    v_mfma_f32_16x16x32_bf16 v[108:111], v[156:159], v[156:159], v[108:111]
    v_mfma_f32_16x16x32_bf16 v[112:115], v[24:27], v[80:83], v[112:115]
    v_mfma_f32_16x16x32_bf16 v[116:119], v[24:27], v[84:87], v[116:119]
    v_mfma_f32_16x16x32_bf16 v[120:123], v[24:27], v[88:91], v[120:123]
    v_mfma_f32_16x16x32_bf16 v[124:127], v[24:27], v[92:95], v[124:127]
    s_waitcnt lgkmcnt(7)
    v_mfma_f32_16x16x32_bf16 v[32:35], v[160:163], v[64:67], v[32:35]
    ds_read_b128 v[168:171], v8 offset:40960
    s_waitcnt lgkmcnt(7)
    v_mfma_f32_16x16x32_bf16 v[36:39], v[164:167], v[64:67], v[36:39]
    ds_read_b64_tr_b16 v[80:81], v9 offset:20480
    s_waitcnt lgkmcnt(6)
    v_mfma_f32_16x16x32_bf16 v[40:43], v[160:163], v[68:71], v[40:43]
    ds_read_b64_tr_b16 v[82:83], v9 offset:21504
    v_mfma_f32_16x16x32_bf16 v[44:47], v[164:167], v[68:71], v[44:47]
    ds_read_b128 v[172:175], v8 offset:41984
    v_mfma_f32_16x16x32_bf16 v[96:99], v[24:27], v[160:163], v[96:99]
    ds_read_b64_tr_b16 v[84:85], v10 offset:20480
    v_mfma_f32_16x16x32_bf16 v[104:107], v[160:163], v[160:163], v[104:107]
    ds_read_b64_tr_b16 v[86:87], v10 offset:21504
    s_waitcnt lgkmcnt(8)
    v_mfma_f32_16x16x32_bf16 v[48:51], v[160:163], v[72:75], v[48:51]
    ds_read_b64_tr_b16 v[88:89], v9 offset:22528
    v_mfma_f32_16x16x32_bf16 v[52:55], v[164:167], v[72:75], v[52:55]
    ds_read_b64_tr_b16 v[90:91], v9 offset:23552
    s_waitcnt lgkmcnt(8)
    v_mfma_f32_16x16x32_bf16 v[56:59], v[160:163], v[76:79], v[56:59]
    ds_read_b64_tr_b16 v[92:93], v10 offset:22528
    v_mfma_f32_16x16x32_bf16 v[60:63], v[164:167], v[76:79], v[60:63]
    ds_read_b64_tr_b16 v[94:95], v10 offset:23552
    v_mfma_f32_16x16x32_bf16 v[100:103], v[24:27], v[164:167], v[100:103]
    v_mfma_f32_16x16x32_bf16 v[108:111], v[164:167], v[164:167], v[108:111]
    v_mfma_f32_16x16x32_bf16 v[112:115], v[24:27], v[64:67], v[112:115]
    v_mfma_f32_16x16x32_bf16 v[116:119], v[24:27], v[68:71], v[116:119]
    v_mfma_f32_16x16x32_bf16 v[120:123], v[24:27], v[72:75], v[120:123]
    v_mfma_f32_16x16x32_bf16 v[124:127], v[24:27], v[76:79], v[124:127]
    s_waitcnt lgkmcnt(0)
    s_barrier
    v_mfma_f32_16x16x32_bf16 v[32:35], v[168:171], v[80:83], v[32:35]
    ds_read_b128 v[176:179], v8 offset:0
    v_mfma_f32_16x16x32_bf16 v[36:39], v[172:175], v[80:83], v[36:39]
    ds_read_b64_tr_b16 v[64:65], v9 offset:24576
    v_mfma_f32_16x16x32_bf16 v[40:43], v[168:171], v[84:87], v[40:43]
    ds_read_b64_tr_b16 v[66:67], v9 offset:25600
    v_mfma_f32_16x16x32_bf16 v[44:47], v[172:175], v[84:87], v[44:47]
    ds_read_b128 v[180:183], v8 offset:1024
    v_mfma_f32_16x16x32_bf16 v[96:99], v[24:27], v[168:171], v[96:99]
    ds_read_b64_tr_b16 v[68:69], v10 offset:24576
    v_mfma_f32_16x16x32_bf16 v[104:107], v[168:171], v[168:171], v[104:107]
    ds_read_b64_tr_b16 v[70:71], v10 offset:25600
    v_mfma_f32_16x16x32_bf16 v[48:51], v[168:171], v[88:91], v[48:51]
    ds_read_b64_tr_b16 v[72:73], v9 offset:26624
    v_mfma_f32_16x16x32_bf16 v[52:55], v[172:175], v[88:91], v[52:55]
    ds_read_b64_tr_b16 v[74:75], v9 offset:27648
    v_mfma_f32_16x16x32_bf16 v[56:59], v[168:171], v[92:95], v[56:59]
    ds_read_b64_tr_b16 v[76:77], v10 offset:26624
    v_mfma_f32_16x16x32_bf16 v[60:63], v[172:175], v[92:95], v[60:63]
    ds_read_b64_tr_b16 v[78:79], v10 offset:27648
    v_mfma_f32_16x16x32_bf16 v[100:103], v[24:27], v[172:175], v[100:103]
    v_mfma_f32_16x16x32_bf16 v[108:111], v[172:175], v[172:175], v[108:111]
    v_mfma_f32_16x16x32_bf16 v[112:115], v[24:27], v[80:83], v[112:115]
    v_mfma_f32_16x16x32_bf16 v[116:119], v[24:27], v[84:87], v[116:119]
    v_mfma_f32_16x16x32_bf16 v[120:123], v[24:27], v[88:91], v[120:123]
    v_mfma_f32_16x16x32_bf16 v[124:127], v[24:27], v[92:95], v[124:127]
    s_waitcnt lgkmcnt(7)
    v_mfma_f32_16x16x32_bf16 v[32:35], v[176:179], v[64:67], v[32:35]
    ds_read_b128 v[184:187], v8 offset:8192
    s_waitcnt lgkmcnt(7)
    v_mfma_f32_16x16x32_bf16 v[36:39], v[180:183], v[64:67], v[36:39]
    ds_read_b64_tr_b16 v[80:81], v9 offset:28672
    s_waitcnt lgkmcnt(6)
    v_mfma_f32_16x16x32_bf16 v[40:43], v[176:179], v[68:71], v[40:43]
    ds_read_b64_tr_b16 v[82:83], v9 offset:29696
    v_mfma_f32_16x16x32_bf16 v[44:47], v[180:183], v[68:71], v[44:47]
    ds_read_b128 v[188:191], v8 offset:9216
    v_mfma_f32_16x16x32_bf16 v[96:99], v[24:27], v[176:179], v[96:99]
    ds_read_b64_tr_b16 v[84:85], v10 offset:28672
    v_mfma_f32_16x16x32_bf16 v[104:107], v[176:179], v[176:179], v[104:107]
    ds_read_b64_tr_b16 v[86:87], v10 offset:29696
    s_waitcnt lgkmcnt(8)
    v_mfma_f32_16x16x32_bf16 v[48:51], v[176:179], v[72:75], v[48:51]
    ds_read_b64_tr_b16 v[88:89], v9 offset:30720
    v_mfma_f32_16x16x32_bf16 v[52:55], v[180:183], v[72:75], v[52:55]
    ds_read_b64_tr_b16 v[90:91], v9 offset:31744
    s_waitcnt lgkmcnt(8)
    v_mfma_f32_16x16x32_bf16 v[56:59], v[176:179], v[76:79], v[56:59]
    ds_read_b64_tr_b16 v[92:93], v10 offset:30720
    v_mfma_f32_16x16x32_bf16 v[60:63], v[180:183], v[76:79], v[60:63]
    ds_read_b64_tr_b16 v[94:95], v10 offset:31744
    v_mfma_f32_16x16x32_bf16 v[100:103], v[24:27], v[180:183], v[100:103]
    v_mfma_f32_16x16x32_bf16 v[108:111], v[180:183], v[180:183], v[108:111]
    v_mfma_f32_16x16x32_bf16 v[112:115], v[24:27], v[64:67], v[112:115]
    v_mfma_f32_16x16x32_bf16 v[116:119], v[24:27], v[68:71], v[116:119]
    v_mfma_f32_16x16x32_bf16 v[120:123], v[24:27], v[72:75], v[120:123]
    v_mfma_f32_16x16x32_bf16 v[124:127], v[24:27], v[76:79], v[124:127]
    s_waitcnt lgkmcnt(0)
    s_barrier
    v_mfma_f32_16x16x32_bf16 v[32:35], v[184:187], v[80:83], v[32:35]
    ds_read_b128 v[192:195], v8 offset:16384
    v_mfma_f32_16x16x32_bf16 v[36:39], v[188:191], v[80:83], v[36:39]
    ds_read_b64_tr_b16 v[64:65], v9 offset:32768
    v_mfma_f32_16x16x32_bf16 v[40:43], v[184:187], v[84:87], v[40:43]
    ds_read_b64_tr_b16 v[66:67], v9 offset:33792
    v_mfma_f32_16x16x32_bf16 v[44:47], v[188:191], v[84:87], v[44:47]
    ds_read_b128 v[196:199], v8 offset:17408
    v_mfma_f32_16x16x32_bf16 v[96:99], v[24:27], v[184:187], v[96:99]
    ds_read_b64_tr_b16 v[68:69], v10 offset:32768
    v_mfma_f32_16x16x32_bf16 v[104:107], v[184:187], v[184:187], v[104:107]
    ds_read_b64_tr_b16 v[70:71], v10 offset:33792
    v_mfma_f32_16x16x32_bf16 v[48:51], v[184:187], v[88:91], v[48:51]
    ds_read_b64_tr_b16 v[72:73], v9 offset:34816
    v_mfma_f32_16x16x32_bf16 v[52:55], v[188:191], v[88:91], v[52:55]
    ds_read_b64_tr_b16 v[74:75], v9 offset:35840
    v_mfma_f32_16x16x32_bf16 v[56:59], v[184:187], v[92:95], v[56:59]
    ds_read_b64_tr_b16 v[76:77], v10 offset:34816
    v_mfma_f32_16x16x32_bf16 v[60:63], v[188:191], v[92:95], v[60:63]
    ds_read_b64_tr_b16 v[78:79], v10 offset:35840
    v_mfma_f32_16x16x32_bf16 v[100:103], v[24:27], v[188:191], v[100:103]
    v_mfma_f32_16x16x32_bf16 v[108:111], v[188:191], v[188:191], v[108:111]
    v_mfma_f32_16x16x32_bf16 v[112:115], v[24:27], v[80:83], v[112:115]
    v_mfma_f32_16x16x32_bf16 v[116:119], v[24:27], v[84:87], v[116:119]
    v_mfma_f32_16x16x32_bf16 v[120:123], v[24:27], v[88:91], v[120:123]
    v_mfma_f32_16x16x32_bf16 v[124:127], v[24:27], v[92:95], v[124:127]
    s_waitcnt lgkmcnt(7)
    v_mfma_f32_16x16x32_bf16 v[32:35], v[192:195], v[64:67], v[32:35]
    ds_read_b128 v[200:203], v8 offset:24576
    s_waitcnt lgkmcnt(7)
    v_mfma_f32_16x16x32_bf16 v[36:39], v[196:199], v[64:67], v[36:39]
    ds_read_b64_tr_b16 v[80:81], v9 offset:36864
    s_waitcnt lgkmcnt(6)
    v_mfma_f32_16x16x32_bf16 v[40:43], v[192:195], v[68:71], v[40:43]
    ds_read_b64_tr_b16 v[82:83], v9 offset:37888
    v_mfma_f32_16x16x32_bf16 v[44:47], v[196:199], v[68:71], v[44:47]
    ds_read_b128 v[204:207], v8 offset:25600
    v_mfma_f32_16x16x32_bf16 v[96:99], v[24:27], v[192:195], v[96:99]
    ds_read_b64_tr_b16 v[84:85], v10 offset:36864
    v_mfma_f32_16x16x32_bf16 v[104:107], v[192:195], v[192:195], v[104:107]
    ds_read_b64_tr_b16 v[86:87], v10 offset:37888
    s_waitcnt lgkmcnt(8)
    v_mfma_f32_16x16x32_bf16 v[48:51], v[192:195], v[72:75], v[48:51]
    ds_read_b64_tr_b16 v[88:89], v9 offset:38912
    v_mfma_f32_16x16x32_bf16 v[52:55], v[196:199], v[72:75], v[52:55]
    ds_read_b64_tr_b16 v[90:91], v9 offset:39936
    s_waitcnt lgkmcnt(8)
    v_mfma_f32_16x16x32_bf16 v[56:59], v[192:195], v[76:79], v[56:59]
    ds_read_b64_tr_b16 v[92:93], v10 offset:38912
    v_mfma_f32_16x16x32_bf16 v[60:63], v[196:199], v[76:79], v[60:63]
    ds_read_b64_tr_b16 v[94:95], v10 offset:39936
    v_mfma_f32_16x16x32_bf16 v[100:103], v[24:27], v[196:199], v[100:103]
    v_mfma_f32_16x16x32_bf16 v[108:111], v[196:199], v[196:199], v[108:111]
    v_mfma_f32_16x16x32_bf16 v[112:115], v[24:27], v[64:67], v[112:115]
    v_mfma_f32_16x16x32_bf16 v[116:119], v[24:27], v[68:71], v[116:119]
    v_mfma_f32_16x16x32_bf16 v[120:123], v[24:27], v[72:75], v[120:123]
    v_mfma_f32_16x16x32_bf16 v[124:127], v[24:27], v[76:79], v[124:127]
    s_waitcnt lgkmcnt(0)
    s_barrier
    v_mfma_f32_16x16x32_bf16 v[32:35], v[200:203], v[80:83], v[32:35]
    ds_read_b128 v[208:211], v8 offset:32768
    v_mfma_f32_16x16x32_bf16 v[36:39], v[204:207], v[80:83], v[36:39]
    ds_read_b64_tr_b16 v[64:65], v9 offset:40960
    v_mfma_f32_16x16x32_bf16 v[40:43], v[200:203], v[84:87], v[40:43]
    ds_read_b64_tr_b16 v[66:67], v9 offset:41984
    v_mfma_f32_16x16x32_bf16 v[44:47], v[204:207], v[84:87], v[44:47]
    ds_read_b128 v[212:215], v8 offset:33792
    v_mfma_f32_16x16x32_bf16 v[96:99], v[24:27], v[200:203], v[96:99]
    ds_read_b64_tr_b16 v[68:69], v10 offset:40960
    v_mfma_f32_16x16x32_bf16 v[104:107], v[200:203], v[200:203], v[104:107]
    ds_read_b64_tr_b16 v[70:71], v10 offset:41984
    v_mfma_f32_16x16x32_bf16 v[48:51], v[200:203], v[88:91], v[48:51]
    ds_read_b64_tr_b16 v[72:73], v9 offset:43008
    v_mfma_f32_16x16x32_bf16 v[52:55], v[204:207], v[88:91], v[52:55]
    ds_read_b64_tr_b16 v[74:75], v9 offset:44032
    v_mfma_f32_16x16x32_bf16 v[56:59], v[200:203], v[92:95], v[56:59]
    ds_read_b64_tr_b16 v[76:77], v10 offset:43008
    v_mfma_f32_16x16x32_bf16 v[60:63], v[204:207], v[92:95], v[60:63]
    ds_read_b64_tr_b16 v[78:79], v10 offset:44032
    v_mfma_f32_16x16x32_bf16 v[100:103], v[24:27], v[204:207], v[100:103]
    v_mfma_f32_16x16x32_bf16 v[108:111], v[204:207], v[204:207], v[108:111]
    v_mfma_f32_16x16x32_bf16 v[112:115], v[24:27], v[80:83], v[112:115]
    v_mfma_f32_16x16x32_bf16 v[116:119], v[24:27], v[84:87], v[116:119]
    v_mfma_f32_16x16x32_bf16 v[120:123], v[24:27], v[88:91], v[120:123]
    v_mfma_f32_16x16x32_bf16 v[124:127], v[24:27], v[92:95], v[124:127]
    s_waitcnt lgkmcnt(7)
    v_mfma_f32_16x16x32_bf16 v[32:35], v[208:211], v[64:67], v[32:35]
    ds_read_b128 v[216:219], v8 offset:40960
    s_waitcnt lgkmcnt(7)
    v_mfma_f32_16x16x32_bf16 v[36:39], v[212:215], v[64:67], v[36:39]
    ds_read_b64_tr_b16 v[80:81], v9 offset:45056
    s_waitcnt lgkmcnt(6)
    v_mfma_f32_16x16x32_bf16 v[40:43], v[208:211], v[68:71], v[40:43]
    ds_read_b64_tr_b16 v[82:83], v9 offset:46080
    v_mfma_f32_16x16x32_bf16 v[44:47], v[212:215], v[68:71], v[44:47]
    ds_read_b128 v[220:223], v8 offset:41984
    v_mfma_f32_16x16x32_bf16 v[96:99], v[24:27], v[208:211], v[96:99]
    ds_read_b64_tr_b16 v[84:85], v10 offset:45056
    v_mfma_f32_16x16x32_bf16 v[104:107], v[208:211], v[208:211], v[104:107]
    ds_read_b64_tr_b16 v[86:87], v10 offset:46080
    s_waitcnt lgkmcnt(8)
    v_mfma_f32_16x16x32_bf16 v[48:51], v[208:211], v[72:75], v[48:51]
    ds_read_b64_tr_b16 v[88:89], v9 offset:47104
    v_mfma_f32_16x16x32_bf16 v[52:55], v[212:215], v[72:75], v[52:55]
    ds_read_b64_tr_b16 v[90:91], v9 offset:48128
    s_waitcnt lgkmcnt(8)
    v_mfma_f32_16x16x32_bf16 v[56:59], v[208:211], v[76:79], v[56:59]
    ds_read_b64_tr_b16 v[92:93], v10 offset:47104
    v_mfma_f32_16x16x32_bf16 v[60:63], v[212:215], v[76:79], v[60:63]
    ds_read_b64_tr_b16 v[94:95], v10 offset:48128
    v_mfma_f32_16x16x32_bf16 v[100:103], v[24:27], v[212:215], v[100:103]
    v_mfma_f32_16x16x32_bf16 v[108:111], v[212:215], v[212:215], v[108:111]
    v_mfma_f32_16x16x32_bf16 v[112:115], v[24:27], v[64:67], v[112:115]
    v_mfma_f32_16x16x32_bf16 v[116:119], v[24:27], v[68:71], v[116:119]
    v_mfma_f32_16x16x32_bf16 v[120:123], v[24:27], v[72:75], v[120:123]
    v_mfma_f32_16x16x32_bf16 v[124:127], v[24:27], v[76:79], v[124:127]
    s_waitcnt lgkmcnt(0)
    s_barrier
    v_mfma_f32_16x16x32_bf16 v[32:35], v[216:219], v[80:83], v[32:35]
    ds_read_b128 v[224:227], v8 offset:0
    v_mfma_f32_16x16x32_bf16 v[36:39], v[220:223], v[80:83], v[36:39]
    ds_read_b64_tr_b16 v[64:65], v11 offset:0
    v_mfma_f32_16x16x32_bf16 v[40:43], v[216:219], v[84:87], v[40:43]
    ds_read_b64_tr_b16 v[66:67], v11 offset:1024
    v_mfma_f32_16x16x32_bf16 v[44:47], v[220:223], v[84:87], v[44:47]
    ds_read_b128 v[228:231], v8 offset:1024
    v_mfma_f32_16x16x32_bf16 v[96:99], v[24:27], v[216:219], v[96:99]
    ds_read_b64_tr_b16 v[68:69], v12 offset:0
    v_mfma_f32_16x16x32_bf16 v[104:107], v[216:219], v[216:219], v[104:107]
    ds_read_b64_tr_b16 v[70:71], v12 offset:1024
    v_mfma_f32_16x16x32_bf16 v[48:51], v[216:219], v[88:91], v[48:51]
    ds_read_b64_tr_b16 v[72:73], v11 offset:2048
    v_mfma_f32_16x16x32_bf16 v[52:55], v[220:223], v[88:91], v[52:55]
    ds_read_b64_tr_b16 v[74:75], v11 offset:3072
    v_mfma_f32_16x16x32_bf16 v[56:59], v[216:219], v[92:95], v[56:59]
    ds_read_b64_tr_b16 v[76:77], v12 offset:2048
    v_mfma_f32_16x16x32_bf16 v[60:63], v[220:223], v[92:95], v[60:63]
    ds_read_b64_tr_b16 v[78:79], v12 offset:3072
    v_mfma_f32_16x16x32_bf16 v[100:103], v[24:27], v[220:223], v[100:103]
    v_mfma_f32_16x16x32_bf16 v[108:111], v[220:223], v[220:223], v[108:111]
    v_mfma_f32_16x16x32_bf16 v[112:115], v[24:27], v[80:83], v[112:115]
    v_mfma_f32_16x16x32_bf16 v[116:119], v[24:27], v[84:87], v[116:119]
    v_mfma_f32_16x16x32_bf16 v[120:123], v[24:27], v[88:91], v[120:123]
    v_mfma_f32_16x16x32_bf16 v[124:127], v[24:27], v[92:95], v[124:127]
    s_waitcnt lgkmcnt(7)
    v_mfma_f32_16x16x32_bf16 v[32:35], v[224:227], v[64:67], v[32:35]
    ds_read_b128 v[232:235], v8 offset:8192
    s_waitcnt lgkmcnt(7)
    v_mfma_f32_16x16x32_bf16 v[36:39], v[228:231], v[64:67], v[36:39]
    ds_read_b64_tr_b16 v[80:81], v11 offset:4096
    s_waitcnt lgkmcnt(6)
    v_mfma_f32_16x16x32_bf16 v[40:43], v[224:227], v[68:71], v[40:43]
    ds_read_b64_tr_b16 v[82:83], v11 offset:5120
    v_mfma_f32_16x16x32_bf16 v[44:47], v[228:231], v[68:71], v[44:47]
    ds_read_b128 v[236:239], v8 offset:9216
    v_mfma_f32_16x16x32_bf16 v[96:99], v[24:27], v[224:227], v[96:99]
    ds_read_b64_tr_b16 v[84:85], v12 offset:4096
    v_mfma_f32_16x16x32_bf16 v[104:107], v[224:227], v[224:227], v[104:107]
    ds_read_b64_tr_b16 v[86:87], v12 offset:5120
    s_waitcnt lgkmcnt(8)
    v_mfma_f32_16x16x32_bf16 v[48:51], v[224:227], v[72:75], v[48:51]
    ds_read_b64_tr_b16 v[88:89], v11 offset:6144
    v_mfma_f32_16x16x32_bf16 v[52:55], v[228:231], v[72:75], v[52:55]
    ds_read_b64_tr_b16 v[90:91], v11 offset:7168
    s_waitcnt lgkmcnt(8)
    v_mfma_f32_16x16x32_bf16 v[56:59], v[224:227], v[76:79], v[56:59]
    ds_read_b64_tr_b16 v[92:93], v12 offset:6144
    v_mfma_f32_16x16x32_bf16 v[60:63], v[228:231], v[76:79], v[60:63]
    ds_read_b64_tr_b16 v[94:95], v12 offset:7168
    v_mfma_f32_16x16x32_bf16 v[100:103], v[24:27], v[228:231], v[100:103]
    v_mfma_f32_16x16x32_bf16 v[108:111], v[228:231], v[228:231], v[108:111]
    v_mfma_f32_16x16x32_bf16 v[112:115], v[24:27], v[64:67], v[112:115]
    v_mfma_f32_16x16x32_bf16 v[116:119], v[24:27], v[68:71], v[116:119]
    v_mfma_f32_16x16x32_bf16 v[120:123], v[24:27], v[72:75], v[120:123]
    v_mfma_f32_16x16x32_bf16 v[124:127], v[24:27], v[76:79], v[124:127]
    s_waitcnt lgkmcnt(0)
    s_barrier
    v_mfma_f32_16x16x32_bf16 v[32:35], v[232:235], v[80:83], v[32:35]
    ds_read_b128 v[240:243], v8 offset:16384
    v_mfma_f32_16x16x32_bf16 v[36:39], v[236:239], v[80:83], v[36:39]
    ds_read_b64_tr_b16 v[64:65], v11 offset:8192
    v_mfma_f32_16x16x32_bf16 v[40:43], v[232:235], v[84:87], v[40:43]
    ds_read_b64_tr_b16 v[66:67], v11 offset:9216
    v_mfma_f32_16x16x32_bf16 v[44:47], v[236:239], v[84:87], v[44:47]
    ds_read_b128 v[244:247], v8 offset:17408
    v_mfma_f32_16x16x32_bf16 v[96:99], v[24:27], v[232:235], v[96:99]
    ds_read_b64_tr_b16 v[68:69], v12 offset:8192
    v_mfma_f32_16x16x32_bf16 v[104:107], v[232:235], v[232:235], v[104:107]
    ds_read_b64_tr_b16 v[70:71], v12 offset:9216
    v_mfma_f32_16x16x32_bf16 v[48:51], v[232:235], v[88:91], v[48:51]
    ds_read_b64_tr_b16 v[72:73], v11 offset:10240
    v_mfma_f32_16x16x32_bf16 v[52:55], v[236:239], v[88:91], v[52:55]
    ds_read_b64_tr_b16 v[74:75], v11 offset:11264
    v_mfma_f32_16x16x32_bf16 v[56:59], v[232:235], v[92:95], v[56:59]
    ds_read_b64_tr_b16 v[76:77], v12 offset:10240
    v_mfma_f32_16x16x32_bf16 v[60:63], v[236:239], v[92:95], v[60:63]
    ds_read_b64_tr_b16 v[78:79], v12 offset:11264
    v_mfma_f32_16x16x32_bf16 v[100:103], v[24:27], v[236:239], v[100:103]
    v_mfma_f32_16x16x32_bf16 v[108:111], v[236:239], v[236:239], v[108:111]
    v_mfma_f32_16x16x32_bf16 v[112:115], v[24:27], v[80:83], v[112:115]
    v_mfma_f32_16x16x32_bf16 v[116:119], v[24:27], v[84:87], v[116:119]
    v_mfma_f32_16x16x32_bf16 v[120:123], v[24:27], v[88:91], v[120:123]
    v_mfma_f32_16x16x32_bf16 v[124:127], v[24:27], v[92:95], v[124:127]
    s_waitcnt lgkmcnt(7)
    v_mfma_f32_16x16x32_bf16 v[32:35], v[240:243], v[64:67], v[32:35]
    ds_read_b128 v[248:251], v8 offset:24576
    s_waitcnt lgkmcnt(7)
    v_mfma_f32_16x16x32_bf16 v[36:39], v[244:247], v[64:67], v[36:39]
    ds_read_b64_tr_b16 v[80:81], v11 offset:12288
    s_waitcnt lgkmcnt(6)
    v_mfma_f32_16x16x32_bf16 v[40:43], v[240:243], v[68:71], v[40:43]
    ds_read_b64_tr_b16 v[82:83], v11 offset:13312
    v_mfma_f32_16x16x32_bf16 v[44:47], v[244:247], v[68:71], v[44:47]
    ds_read_b128 v[252:255], v8 offset:25600
    v_mfma_f32_16x16x32_bf16 v[96:99], v[24:27], v[240:243], v[96:99]
    ds_read_b64_tr_b16 v[84:85], v12 offset:12288
    v_mfma_f32_16x16x32_bf16 v[104:107], v[240:243], v[240:243], v[104:107]
    ds_read_b64_tr_b16 v[86:87], v12 offset:13312
    s_waitcnt lgkmcnt(8)
    v_mfma_f32_16x16x32_bf16 v[48:51], v[240:243], v[72:75], v[48:51]
    ds_read_b64_tr_b16 v[88:89], v11 offset:14336
    v_mfma_f32_16x16x32_bf16 v[52:55], v[244:247], v[72:75], v[52:55]
    ds_read_b64_tr_b16 v[90:91], v11 offset:15360
    s_waitcnt lgkmcnt(8)
    v_mfma_f32_16x16x32_bf16 v[56:59], v[240:243], v[76:79], v[56:59]
    ds_read_b64_tr_b16 v[92:93], v12 offset:14336
    v_mfma_f32_16x16x32_bf16 v[60:63], v[244:247], v[76:79], v[60:63]
    ds_read_b64_tr_b16 v[94:95], v12 offset:15360
    v_mfma_f32_16x16x32_bf16 v[100:103], v[24:27], v[244:247], v[100:103]
    v_mfma_f32_16x16x32_bf16 v[108:111], v[244:247], v[244:247], v[108:111]
    v_mfma_f32_16x16x32_bf16 v[112:115], v[24:27], v[64:67], v[112:115]
    v_mfma_f32_16x16x32_bf16 v[116:119], v[24:27], v[68:71], v[116:119]
    v_mfma_f32_16x16x32_bf16 v[120:123], v[24:27], v[72:75], v[120:123]
    v_mfma_f32_16x16x32_bf16 v[124:127], v[24:27], v[76:79], v[124:127]
    s_waitcnt lgkmcnt(0)
    s_barrier
    v_mfma_f32_16x16x32_bf16 v[32:35], v[248:251], v[80:83], v[32:35]
    v_mfma_f32_16x16x32_bf16 v[36:39], v[252:255], v[80:83], v[36:39]
    v_mfma_f32_16x16x32_bf16 v[40:43], v[248:251], v[84:87], v[40:43]
    v_mfma_f32_16x16x32_bf16 v[44:47], v[252:255], v[84:87], v[44:47]
    v_mfma_f32_16x16x32_bf16 v[96:99], v[24:27], v[248:251], v[96:99]
    v_mfma_f32_16x16x32_bf16 v[104:107], v[248:251], v[248:251], v[104:107]
    v_mfma_f32_16x16x32_bf16 v[48:51], v[248:251], v[88:91], v[48:51]
    v_mfma_f32_16x16x32_bf16 v[52:55], v[252:255], v[88:91], v[52:55]
    v_mfma_f32_16x16x32_bf16 v[56:59], v[248:251], v[92:95], v[56:59]
    v_mfma_f32_16x16x32_bf16 v[60:63], v[252:255], v[92:95], v[60:63]
    v_mfma_f32_16x16x32_bf16 v[100:103], v[24:27], v[252:255], v[100:103]
    v_mfma_f32_16x16x32_bf16 v[108:111], v[252:255], v[252:255], v[108:111]
    v_mfma_f32_16x16x32_bf16 v[112:115], v[24:27], v[80:83], v[112:115]
    v_mfma_f32_16x16x32_bf16 v[116:119], v[24:27], v[84:87], v[116:119]
    v_mfma_f32_16x16x32_bf16 v[120:123], v[24:27], v[88:91], v[120:123]
    v_mfma_f32_16x16x32_bf16 v[124:127], v[24:27], v[92:95], v[124:127]
    s_lshl_b32 s4, s3, 7
    s_add_u32 s4, s4, 156672
    v_lshl_add_u32 v6, v3, 2, s4
    v_lshl_add_u32 v7, v2, 4, s4
    s_lshl_b32 s5, s3, 2
    s_add_u32 s5, s5, 98304
    v_lshl_add_u32 v13, v3, 4, s5
    v_and_b32 v4, 3, v3
    v_cmp_eq_u32 s[52:53], 1, v4
    v_cmp_eq_u32 s[54:55], 2, v4
    v_cmp_eq_u32 s[56:57], 3, v4
    v_lshrrev_b32 v4, 2, v3
    v_cmp_eq_u32 vcc, v4, v2
    v_cndmask_b32 v104, v104, v105, s[52:53]
    v_cndmask_b32 v104, v104, v106, s[54:55]
    v_cndmask_b32 v104, v104, v107, s[56:57]
    v_cndmask_b32 v108, v108, v109, s[52:53]
    v_cndmask_b32 v108, v108, v110, s[54:55]
    v_cndmask_b32 v108, v108, v111, s[56:57]
    v_mul_f32 v28, 0x3b000000, v96
    v_mul_f32 v4, 0x3b000000, v104
    v_fma_f32 v4, -v28, v28, v4
    v_max_f32 v4, 0, v4
    v_add_f32 v4, 0x3727c5ac, v4
    v_rsq_f32 v94, v4
    v_mul_f32 v29, 0x3b000000, v100
    v_mul_f32 v5, 0x3b000000, v108
    v_fma_f32 v5, -v29, v29, v5
    v_max_f32 v5, 0, v5
    v_add_f32 v5, 0x3727c5ac, v5
    v_rsq_f32 v95, v5
    s_mov_b64 exec, vcc
    ds_write_b32 v6, v28 offset:0
    ds_write_b32 v6, v94 offset:512
    ds_write_b32 v6, v29 offset:64
    ds_write_b32 v6, v95 offset:576
    s_mov_b64 exec, -1
    v_lshlrev_b32 v13, 4, v3
    v_add_u32 v13, 98304, v13
    s_waitcnt lgkmcnt(0)
    ds_read_b128 v[64:67], v7 offset:0
    ds_read_b128 v[72:75], v7 offset:512
    ds_read_b128 v[68:71], v7 offset:64
    ds_read_b128 v[76:79], v7 offset:576
    ds_read_b32 v28, v6 offset:0
    ds_read_b32 v94, v6 offset:512
    ds_read_b32 v29, v6 offset:64
    ds_read_b32 v95, v6 offset:576
    v_mov_b32 v88, 1.0
    v_mov_b32 v89, 0x358637bd
    v_mov_b32 v90, 0x3fb8aa3b
    ds_write_b32 v15, v112 offset:128
    ds_write_b32 v15, v120 offset:256
    ds_write_b32 v15, v116 offset:192
    ds_write_b32 v15, v124 offset:320
    s_waitcnt lgkmcnt(10)
    v_pk_mul_f32 v[80:81], v[72:73], v[90:91] op_sel:[0,0] op_sel_hi:[1,0]
    v_pk_mul_f32 v[82:83], v[74:75], v[90:91] op_sel:[0,0] op_sel_hi:[1,0]
    s_waitcnt lgkmcnt(8)
    v_pk_mul_f32 v[84:85], v[76:77], v[90:91] op_sel:[0,0] op_sel_hi:[1,0]
    v_pk_mul_f32 v[86:87], v[78:79], v[90:91] op_sel:[0,0] op_sel_hi:[1,0]
    v_pk_fma_f32 v[32:33], v[64:65], v[112:113], v[32:33] op_sel:[0,0,0] op_sel_hi:[1,0,1] neg_lo:[1,0,0] neg_hi:[1,0,0]
    v_pk_fma_f32 v[34:35], v[66:67], v[112:113], v[34:35] op_sel:[0,0,0] op_sel_hi:[1,0,1] neg_lo:[1,0,0] neg_hi:[1,0,0]
    v_pk_fma_f32 v[36:37], v[68:69], v[112:113], v[36:37] op_sel:[0,0,0] op_sel_hi:[1,0,1] neg_lo:[1,0,0] neg_hi:[1,0,0]
    v_pk_fma_f32 v[38:39], v[70:71], v[112:113], v[38:39] op_sel:[0,0,0] op_sel_hi:[1,0,1] neg_lo:[1,0,0] neg_hi:[1,0,0]
    v_pk_fma_f32 v[40:41], v[64:65], v[116:117], v[40:41] op_sel:[0,0,0] op_sel_hi:[1,0,1] neg_lo:[1,0,0] neg_hi:[1,0,0]
    v_pk_fma_f32 v[42:43], v[66:67], v[116:117], v[42:43] op_sel:[0,0,0] op_sel_hi:[1,0,1] neg_lo:[1,0,0] neg_hi:[1,0,0]
    v_pk_fma_f32 v[44:45], v[68:69], v[116:117], v[44:45] op_sel:[0,0,0] op_sel_hi:[1,0,1] neg_lo:[1,0,0] neg_hi:[1,0,0]
    v_pk_fma_f32 v[46:47], v[70:71], v[116:117], v[46:47] op_sel:[0,0,0] op_sel_hi:[1,0,1] neg_lo:[1,0,0] neg_hi:[1,0,0]
    v_pk_mul_f32 v[96:97], v[32:33], v[80:81] op_sel:[0,0] op_sel_hi:[1,1]
    v_pk_mul_f32 v[98:99], v[34:35], v[82:83] op_sel:[0,0] op_sel_hi:[1,1]
    v_pk_mul_f32 v[100:101], v[36:37], v[84:85] op_sel:[0,0] op_sel_hi:[1,1]
    v_pk_mul_f32 v[102:103], v[38:39], v[86:87] op_sel:[0,0] op_sel_hi:[1,1]
    v_pk_mul_f32 v[104:105], v[40:41], v[80:81] op_sel:[0,0] op_sel_hi:[1,1]
    v_pk_mul_f32 v[106:107], v[42:43], v[82:83] op_sel:[0,0] op_sel_hi:[1,1]
    v_pk_mul_f32 v[108:109], v[44:45], v[84:85] op_sel:[0,0] op_sel_hi:[1,1]
    v_pk_mul_f32 v[110:111], v[46:47], v[86:87] op_sel:[0,0] op_sel_hi:[1,1]
    v_exp_f32 v96, v96 clamp
    v_exp_f32 v97, v97 clamp
    v_pk_fma_f32 v[32:33], v[32:33], v[72:73], v[88:89] op_sel:[0,0,0] op_sel_hi:[1,1,0]
    v_exp_f32 v98, v98 clamp
    v_exp_f32 v99, v99 clamp
    v_pk_fma_f32 v[34:35], v[34:35], v[74:75], v[88:89] op_sel:[0,0,0] op_sel_hi:[1,1,0]
    v_exp_f32 v100, v100 clamp
    v_exp_f32 v101, v101 clamp
    v_pk_fma_f32 v[36:37], v[36:37], v[76:77], v[88:89] op_sel:[0,0,0] op_sel_hi:[1,1,0]
    v_exp_f32 v102, v102 clamp
    v_exp_f32 v103, v103 clamp
    v_pk_fma_f32 v[38:39], v[38:39], v[78:79], v[88:89] op_sel:[0,0,0] op_sel_hi:[1,1,0]
    v_exp_f32 v104, v104 clamp
    v_exp_f32 v105, v105 clamp
    v_pk_fma_f32 v[40:41], v[40:41], v[72:73], v[88:89] op_sel:[0,0,0] op_sel_hi:[1,1,0]
    v_exp_f32 v106, v106 clamp
    v_exp_f32 v107, v107 clamp
    v_pk_fma_f32 v[42:43], v[42:43], v[74:75], v[88:89] op_sel:[0,0,0] op_sel_hi:[1,1,0]
    v_exp_f32 v108, v108 clamp
    v_exp_f32 v109, v109 clamp
    v_pk_fma_f32 v[44:45], v[44:45], v[76:77], v[88:89] op_sel:[0,0,0] op_sel_hi:[1,1,0]
    v_exp_f32 v110, v110 clamp
    v_exp_f32 v111, v111 clamp
    v_pk_fma_f32 v[46:47], v[46:47], v[78:79], v[88:89] op_sel:[0,0,0] op_sel_hi:[1,1,0]
    v_max_f32 v32, v32, v96
    v_max_f32 v33, v33, v97
    v_max_f32 v34, v34, v98
    v_max_f32 v35, v35, v99
    v_max_f32 v36, v36, v100
    v_max_f32 v37, v37, v101
    v_max_f32 v38, v38, v102
    v_max_f32 v39, v39, v103
    v_max_f32 v40, v40, v104
    v_max_f32 v41, v41, v105
    v_max_f32 v42, v42, v106
    v_max_f32 v43, v43, v107
    v_max_f32 v44, v44, v108
    v_max_f32 v45, v45, v109
    v_max_f32 v46, v46, v110
    v_max_f32 v47, v47, v111
    v_pk_add_f32 v[32:33], v[32:33], v[88:89] op_sel:[0,1] op_sel_hi:[1,1]
    v_pk_add_f32 v[34:35], v[34:35], v[88:89] op_sel:[0,1] op_sel_hi:[1,1]
    v_pk_add_f32 v[36:37], v[36:37], v[88:89] op_sel:[0,1] op_sel_hi:[1,1]
    v_pk_add_f32 v[38:39], v[38:39], v[88:89] op_sel:[0,1] op_sel_hi:[1,1]
    v_pk_add_f32 v[40:41], v[40:41], v[88:89] op_sel:[0,1] op_sel_hi:[1,1]
    v_pk_add_f32 v[42:43], v[42:43], v[88:89] op_sel:[0,1] op_sel_hi:[1,1]
    v_pk_add_f32 v[44:45], v[44:45], v[88:89] op_sel:[0,1] op_sel_hi:[1,1]
    v_pk_add_f32 v[46:47], v[46:47], v[88:89] op_sel:[0,1] op_sel_hi:[1,1]
    v_cvt_pk_bf16_f32 v32, v32, v33
    v_cvt_pk_bf16_f32 v33, v34, v35
    v_cvt_pk_bf16_f32 v34, v36, v37
    v_cvt_pk_bf16_f32 v35, v38, v39
    v_cvt_pk_bf16_f32 v36, v40, v41
    v_cvt_pk_bf16_f32 v37, v42, v43
    v_cvt_pk_bf16_f32 v38, v44, v45
    v_cvt_pk_bf16_f32 v39, v46, v47
    v_pk_fma_f32 v[48:49], v[64:65], v[120:121], v[48:49] op_sel:[0,0,0] op_sel_hi:[1,0,1] neg_lo:[1,0,0] neg_hi:[1,0,0]
    v_pk_fma_f32 v[50:51], v[66:67], v[120:121], v[50:51] op_sel:[0,0,0] op_sel_hi:[1,0,1] neg_lo:[1,0,0] neg_hi:[1,0,0]
    v_pk_fma_f32 v[52:53], v[68:69], v[120:121], v[52:53] op_sel:[0,0,0] op_sel_hi:[1,0,1] neg_lo:[1,0,0] neg_hi:[1,0,0]
    v_pk_fma_f32 v[54:55], v[70:71], v[120:121], v[54:55] op_sel:[0,0,0] op_sel_hi:[1,0,1] neg_lo:[1,0,0] neg_hi:[1,0,0]
    v_pk_fma_f32 v[56:57], v[64:65], v[124:125], v[56:57] op_sel:[0,0,0] op_sel_hi:[1,0,1] neg_lo:[1,0,0] neg_hi:[1,0,0]
    v_pk_fma_f32 v[58:59], v[66:67], v[124:125], v[58:59] op_sel:[0,0,0] op_sel_hi:[1,0,1] neg_lo:[1,0,0] neg_hi:[1,0,0]
    v_pk_fma_f32 v[60:61], v[68:69], v[124:125], v[60:61] op_sel:[0,0,0] op_sel_hi:[1,0,1] neg_lo:[1,0,0] neg_hi:[1,0,0]
    v_pk_fma_f32 v[62:63], v[70:71], v[124:125], v[62:63] op_sel:[0,0,0] op_sel_hi:[1,0,1] neg_lo:[1,0,0] neg_hi:[1,0,0]
    v_pk_mul_f32 v[48:49], v[48:49], v[72:73] op_sel:[0,0] op_sel_hi:[1,1]
    v_pk_mul_f32 v[50:51], v[50:51], v[74:75] op_sel:[0,0] op_sel_hi:[1,1]
    v_pk_mul_f32 v[52:53], v[52:53], v[76:77] op_sel:[0,0] op_sel_hi:[1,1]
    v_pk_mul_f32 v[54:55], v[54:55], v[78:79] op_sel:[0,0] op_sel_hi:[1,1]
    v_pk_mul_f32 v[56:57], v[56:57], v[72:73] op_sel:[0,0] op_sel_hi:[1,1]
    v_pk_mul_f32 v[58:59], v[58:59], v[74:75] op_sel:[0,0] op_sel_hi:[1,1]
    v_pk_mul_f32 v[60:61], v[60:61], v[76:77] op_sel:[0,0] op_sel_hi:[1,1]
    v_pk_mul_f32 v[62:63], v[62:63], v[78:79] op_sel:[0,0] op_sel_hi:[1,1]
    v_cvt_pk_bf16_f32 v48, v48, v49
    v_cvt_pk_bf16_f32 v49, v50, v51
    v_cvt_pk_bf16_f32 v50, v52, v53
    v_cvt_pk_bf16_f32 v51, v54, v55
    v_cvt_pk_bf16_f32 v52, v56, v57
    v_cvt_pk_bf16_f32 v53, v58, v59
    v_cvt_pk_bf16_f32 v54, v60, v61
    v_cvt_pk_bf16_f32 v55, v62, v63
    v_mfma_f32_16x16x32_bf16 v[96:99], v[32:35], v[48:51], 0
    v_mfma_f32_16x16x32_bf16 v[104:107], v[32:35], v[24:27], 0
    v_mfma_f32_16x16x32_bf16 v[100:103], v[36:39], v[52:55], 0
    v_mfma_f32_16x16x32_bf16 v[108:111], v[36:39], v[24:27], 0
    s_waitcnt lgkmcnt(6)
    v_mul_f32 v92, v90, v94
    s_waitcnt lgkmcnt(4)
    v_mul_f32 v93, v90, v95
    s_lshl_b32 s4, s3, 11
    s_add_u32 s4, s4, 147456
    v_lshl_add_u32 v6, v1, 4, s4
    s_lshl_b32 s4, s3, 7
    s_add_u32 s4, s4, 155648
    v_lshl_add_u32 v7, v2, 4, s4
    ds_write_b128 v6, v[96:99] offset:0
    ds_write_b128 v6, v[100:103] offset:1024
    s_mov_b32 exec_lo, 0x00010001
    s_mov_b32 exec_hi, 0x00010001
    ds_write_b128 v7, v[104:107] offset:0
    ds_write_b128 v7, v[108:111] offset:64
    s_mov_b64 exec, -1
    s_lshl_b32 s4, s3, 9
    s_add_u32 s4, s4, 147456
    v_lshl_add_u32 v6, v1, 2, s4
    v_and_b32 v7, 31, v1
    v_lshlrev_b32 v7, 2, v7
    v_add_u32 v7, 155648, v7
    s_waitcnt lgkmcnt(0)
    s_barrier
    ds_read_b32 v112, v6 offset:0
    ds_read_b32 v113, v6 offset:2048
    ds_read_b32 v114, v6 offset:4096
    ds_read_b32 v115, v6 offset:6144
    ds_read_b32 v116, v6 offset:256
    ds_read_b32 v117, v6 offset:2304
    ds_read_b32 v118, v6 offset:4352
    ds_read_b32 v119, v6 offset:6400
    ds_read_b32 v120, v7 offset:0
    ds_read_b32 v121, v7 offset:128
    ds_read_b32 v122, v7 offset:256
    ds_read_b32 v123, v7 offset:384
    s_waitcnt lgkmcnt(10)
    v_add_f32 v112, v112, v113
    s_waitcnt lgkmcnt(8)
    v_add_f32 v114, v114, v115
    s_waitcnt lgkmcnt(6)
    v_add_f32 v116, v116, v117
    s_waitcnt lgkmcnt(4)
    v_add_f32 v118, v118, v119
    s_waitcnt lgkmcnt(2)
    v_add_f32 v120, v120, v121
    s_waitcnt lgkmcnt(0)
    v_add_f32 v122, v122, v123
    v_add_f32 v112, v112, v114
    v_add_f32 v116, v116, v118
    v_add_f32 v120, v120, v122
    buffer_atomic_add_f32 v112, v17, s[44:47], 0 offen offset:0
    buffer_atomic_add_f32 v116, v17, s[44:47], 0 offen offset:256
    s_cmp_eq_u32 s3, 0
    s_cbranch_scc0 L_nz_s1l0
    s_mov_b32 exec_hi, 0
    buffer_atomic_add_f32 v120, v18, s[44:47], 0 offen
    s_mov_b64 exec, -1
L_nz_s1l0:
    s_waitcnt vmcnt(0)
    s_barrier
    ds_read_b64_tr_b16 v[64:65], v11 offset:16384
    ds_read_b64_tr_b16 v[66:67], v11 offset:17408
    ds_read_b64_tr_b16 v[68:69], v12 offset:16384
    ds_read_b64_tr_b16 v[70:71], v12 offset:17408
    s_waitcnt lgkmcnt(2)
    v_mfma_f32_16x16x32_bf16 v[32:35], v[64:67], v[128:131], 0
    ds_read_b64_tr_b16 v[72:73], v11 offset:18432
    v_mfma_f32_16x16x32_bf16 v[40:43], v[64:67], v[132:135], 0
    ds_read_b64_tr_b16 v[74:75], v11 offset:19456
    v_mfma_f32_16x16x32_bf16 v[96:99], v[64:67], v[24:27], 0
    ds_read_b64_tr_b16 v[76:77], v12 offset:18432
    s_waitcnt lgkmcnt(3)
    v_mfma_f32_16x16x32_bf16 v[36:39], v[68:71], v[128:131], 0
    ds_read_b64_tr_b16 v[78:79], v12 offset:19456
    v_mfma_f32_16x16x32_bf16 v[44:47], v[68:71], v[132:135], 0
    v_mfma_f32_16x16x32_bf16 v[100:103], v[68:71], v[24:27], 0
    s_waitcnt lgkmcnt(2)
    v_mfma_f32_16x16x32_bf16 v[32:35], v[72:75], v[136:139], v[32:35]
    ds_read_b64_tr_b16 v[64:65], v11 offset:20480
    v_mfma_f32_16x16x32_bf16 v[40:43], v[72:75], v[140:143], v[40:43]
    ds_read_b64_tr_b16 v[66:67], v11 offset:21504
    v_mfma_f32_16x16x32_bf16 v[96:99], v[72:75], v[24:27], v[96:99]
    ds_read_b64_tr_b16 v[68:69], v12 offset:20480
    s_waitcnt lgkmcnt(3)
    v_mfma_f32_16x16x32_bf16 v[36:39], v[76:79], v[136:139], v[36:39]
    ds_read_b64_tr_b16 v[70:71], v12 offset:21504
    v_mfma_f32_16x16x32_bf16 v[44:47], v[76:79], v[140:143], v[44:47]
    v_mfma_f32_16x16x32_bf16 v[100:103], v[76:79], v[24:27], v[100:103]
    s_waitcnt lgkmcnt(2)
    v_mfma_f32_16x16x32_bf16 v[32:35], v[64:67], v[144:147], v[32:35]
    ds_read_b64_tr_b16 v[72:73], v11 offset:22528
    v_mfma_f32_16x16x32_bf16 v[40:43], v[64:67], v[148:151], v[40:43]
    ds_read_b64_tr_b16 v[74:75], v11 offset:23552
    v_mfma_f32_16x16x32_bf16 v[96:99], v[64:67], v[24:27], v[96:99]
    ds_read_b64_tr_b16 v[76:77], v12 offset:22528
    s_waitcnt lgkmcnt(3)
    v_mfma_f32_16x16x32_bf16 v[36:39], v[68:71], v[144:147], v[36:39]
    ds_read_b64_tr_b16 v[78:79], v12 offset:23552
    v_mfma_f32_16x16x32_bf16 v[44:47], v[68:71], v[148:151], v[44:47]
    v_mfma_f32_16x16x32_bf16 v[100:103], v[68:71], v[24:27], v[100:103]
    s_waitcnt lgkmcnt(2)
    v_mfma_f32_16x16x32_bf16 v[32:35], v[72:75], v[152:155], v[32:35]
    ds_read_b64_tr_b16 v[64:65], v11 offset:24576
    v_mfma_f32_16x16x32_bf16 v[40:43], v[72:75], v[156:159], v[40:43]
    ds_read_b64_tr_b16 v[66:67], v11 offset:25600
    v_mfma_f32_16x16x32_bf16 v[96:99], v[72:75], v[24:27], v[96:99]
    ds_read_b64_tr_b16 v[68:69], v12 offset:24576
    s_waitcnt lgkmcnt(3)
    v_mfma_f32_16x16x32_bf16 v[36:39], v[76:79], v[152:155], v[36:39]
    ds_read_b64_tr_b16 v[70:71], v12 offset:25600
    v_mfma_f32_16x16x32_bf16 v[44:47], v[76:79], v[156:159], v[44:47]
    v_mfma_f32_16x16x32_bf16 v[100:103], v[76:79], v[24:27], v[100:103]
    s_waitcnt lgkmcnt(2)
    v_mfma_f32_16x16x32_bf16 v[32:35], v[64:67], v[160:163], v[32:35]
    ds_read_b64_tr_b16 v[72:73], v11 offset:26624
    v_mfma_f32_16x16x32_bf16 v[40:43], v[64:67], v[164:167], v[40:43]
    ds_read_b64_tr_b16 v[74:75], v11 offset:27648
    v_mfma_f32_16x16x32_bf16 v[96:99], v[64:67], v[24:27], v[96:99]
    ds_read_b64_tr_b16 v[76:77], v12 offset:26624
    s_waitcnt lgkmcnt(3)
    v_mfma_f32_16x16x32_bf16 v[36:39], v[68:71], v[160:163], v[36:39]
    ds_read_b64_tr_b16 v[78:79], v12 offset:27648
    v_mfma_f32_16x16x32_bf16 v[44:47], v[68:71], v[164:167], v[44:47]
    v_mfma_f32_16x16x32_bf16 v[100:103], v[68:71], v[24:27], v[100:103]
    s_waitcnt lgkmcnt(2)
    v_mfma_f32_16x16x32_bf16 v[32:35], v[72:75], v[168:171], v[32:35]
    ds_read_b64_tr_b16 v[64:65], v11 offset:28672
    v_mfma_f32_16x16x32_bf16 v[40:43], v[72:75], v[172:175], v[40:43]
    ds_read_b64_tr_b16 v[66:67], v11 offset:29696
    v_mfma_f32_16x16x32_bf16 v[96:99], v[72:75], v[24:27], v[96:99]
    ds_read_b64_tr_b16 v[68:69], v12 offset:28672
    s_waitcnt lgkmcnt(3)
    v_mfma_f32_16x16x32_bf16 v[36:39], v[76:79], v[168:171], v[36:39]
    ds_read_b64_tr_b16 v[70:71], v12 offset:29696
    v_mfma_f32_16x16x32_bf16 v[44:47], v[76:79], v[172:175], v[44:47]
    v_mfma_f32_16x16x32_bf16 v[100:103], v[76:79], v[24:27], v[100:103]
    s_waitcnt lgkmcnt(2)
    v_mfma_f32_16x16x32_bf16 v[32:35], v[64:67], v[176:179], v[32:35]
    ds_read_b64_tr_b16 v[72:73], v11 offset:30720
    v_mfma_f32_16x16x32_bf16 v[40:43], v[64:67], v[180:183], v[40:43]
    ds_read_b64_tr_b16 v[74:75], v11 offset:31744
    v_mfma_f32_16x16x32_bf16 v[96:99], v[64:67], v[24:27], v[96:99]
    ds_read_b64_tr_b16 v[76:77], v12 offset:30720
    s_waitcnt lgkmcnt(3)
    v_mfma_f32_16x16x32_bf16 v[36:39], v[68:71], v[176:179], v[36:39]
    ds_read_b64_tr_b16 v[78:79], v12 offset:31744
    v_mfma_f32_16x16x32_bf16 v[44:47], v[68:71], v[180:183], v[44:47]
    v_mfma_f32_16x16x32_bf16 v[100:103], v[68:71], v[24:27], v[100:103]
    s_waitcnt lgkmcnt(2)
    v_mfma_f32_16x16x32_bf16 v[32:35], v[72:75], v[184:187], v[32:35]
    ds_read_b64_tr_b16 v[64:65], v11 offset:32768
    v_mfma_f32_16x16x32_bf16 v[40:43], v[72:75], v[188:191], v[40:43]
    ds_read_b64_tr_b16 v[66:67], v11 offset:33792
    v_mfma_f32_16x16x32_bf16 v[96:99], v[72:75], v[24:27], v[96:99]
    ds_read_b64_tr_b16 v[68:69], v12 offset:32768
    s_waitcnt lgkmcnt(3)
    v_mfma_f32_16x16x32_bf16 v[36:39], v[76:79], v[184:187], v[36:39]
    ds_read_b64_tr_b16 v[70:71], v12 offset:33792
    v_mfma_f32_16x16x32_bf16 v[44:47], v[76:79], v[188:191], v[44:47]
    v_mfma_f32_16x16x32_bf16 v[100:103], v[76:79], v[24:27], v[100:103]
    s_waitcnt lgkmcnt(2)
    v_mfma_f32_16x16x32_bf16 v[32:35], v[64:67], v[192:195], v[32:35]
    ds_read_b64_tr_b16 v[72:73], v11 offset:34816
    v_mfma_f32_16x16x32_bf16 v[40:43], v[64:67], v[196:199], v[40:43]
    ds_read_b64_tr_b16 v[74:75], v11 offset:35840
    v_mfma_f32_16x16x32_bf16 v[96:99], v[64:67], v[24:27], v[96:99]
    ds_read_b64_tr_b16 v[76:77], v12 offset:34816
    s_waitcnt lgkmcnt(3)
    v_mfma_f32_16x16x32_bf16 v[36:39], v[68:71], v[192:195], v[36:39]
    ds_read_b64_tr_b16 v[78:79], v12 offset:35840
    v_mfma_f32_16x16x32_bf16 v[44:47], v[68:71], v[196:199], v[44:47]
    v_mfma_f32_16x16x32_bf16 v[100:103], v[68:71], v[24:27], v[100:103]
    s_waitcnt lgkmcnt(2)
    v_mfma_f32_16x16x32_bf16 v[32:35], v[72:75], v[200:203], v[32:35]
    ds_read_b64_tr_b16 v[64:65], v11 offset:36864
    v_mfma_f32_16x16x32_bf16 v[40:43], v[72:75], v[204:207], v[40:43]
    ds_read_b64_tr_b16 v[66:67], v11 offset:37888
    v_mfma_f32_16x16x32_bf16 v[96:99], v[72:75], v[24:27], v[96:99]
    ds_read_b64_tr_b16 v[68:69], v12 offset:36864
    s_waitcnt lgkmcnt(3)
    v_mfma_f32_16x16x32_bf16 v[36:39], v[76:79], v[200:203], v[36:39]
    ds_read_b64_tr_b16 v[70:71], v12 offset:37888
    v_mfma_f32_16x16x32_bf16 v[44:47], v[76:79], v[204:207], v[44:47]
    v_mfma_f32_16x16x32_bf16 v[100:103], v[76:79], v[24:27], v[100:103]
    s_waitcnt lgkmcnt(2)
    v_mfma_f32_16x16x32_bf16 v[32:35], v[64:67], v[208:211], v[32:35]
    ds_read_b64_tr_b16 v[72:73], v11 offset:38912
    v_mfma_f32_16x16x32_bf16 v[40:43], v[64:67], v[212:215], v[40:43]
    ds_read_b64_tr_b16 v[74:75], v11 offset:39936
    v_mfma_f32_16x16x32_bf16 v[96:99], v[64:67], v[24:27], v[96:99]
    ds_read_b64_tr_b16 v[76:77], v12 offset:38912
    s_waitcnt lgkmcnt(3)
    v_mfma_f32_16x16x32_bf16 v[36:39], v[68:71], v[208:211], v[36:39]
    ds_read_b64_tr_b16 v[78:79], v12 offset:39936
    v_mfma_f32_16x16x32_bf16 v[44:47], v[68:71], v[212:215], v[44:47]
    v_mfma_f32_16x16x32_bf16 v[100:103], v[68:71], v[24:27], v[100:103]
    s_waitcnt lgkmcnt(2)
    v_mfma_f32_16x16x32_bf16 v[32:35], v[72:75], v[216:219], v[32:35]
    ds_read_b64_tr_b16 v[64:65], v11 offset:40960
    v_mfma_f32_16x16x32_bf16 v[40:43], v[72:75], v[220:223], v[40:43]
    ds_read_b64_tr_b16 v[66:67], v11 offset:41984
    v_mfma_f32_16x16x32_bf16 v[96:99], v[72:75], v[24:27], v[96:99]
    ds_read_b64_tr_b16 v[68:69], v12 offset:40960
    s_waitcnt lgkmcnt(3)
    v_mfma_f32_16x16x32_bf16 v[36:39], v[76:79], v[216:219], v[36:39]
    ds_read_b64_tr_b16 v[70:71], v12 offset:41984
    v_mfma_f32_16x16x32_bf16 v[44:47], v[76:79], v[220:223], v[44:47]
    v_mfma_f32_16x16x32_bf16 v[100:103], v[76:79], v[24:27], v[100:103]
    s_waitcnt lgkmcnt(2)
    v_mfma_f32_16x16x32_bf16 v[32:35], v[64:67], v[224:227], v[32:35]
    ds_read_b64_tr_b16 v[72:73], v11 offset:43008
    v_mfma_f32_16x16x32_bf16 v[40:43], v[64:67], v[228:231], v[40:43]
    ds_read_b64_tr_b16 v[74:75], v11 offset:44032
    v_mfma_f32_16x16x32_bf16 v[96:99], v[64:67], v[24:27], v[96:99]
    ds_read_b64_tr_b16 v[76:77], v12 offset:43008
    s_waitcnt lgkmcnt(3)
    v_mfma_f32_16x16x32_bf16 v[36:39], v[68:71], v[224:227], v[36:39]
    ds_read_b64_tr_b16 v[78:79], v12 offset:44032
    v_mfma_f32_16x16x32_bf16 v[44:47], v[68:71], v[228:231], v[44:47]
    v_mfma_f32_16x16x32_bf16 v[100:103], v[68:71], v[24:27], v[100:103]
    s_waitcnt lgkmcnt(2)
    v_mfma_f32_16x16x32_bf16 v[32:35], v[72:75], v[232:235], v[32:35]
    ds_read_b64_tr_b16 v[64:65], v11 offset:45056
    v_mfma_f32_16x16x32_bf16 v[40:43], v[72:75], v[236:239], v[40:43]
    ds_read_b64_tr_b16 v[66:67], v11 offset:46080
    v_mfma_f32_16x16x32_bf16 v[96:99], v[72:75], v[24:27], v[96:99]
    ds_read_b64_tr_b16 v[68:69], v12 offset:45056
    s_waitcnt lgkmcnt(3)
    v_mfma_f32_16x16x32_bf16 v[36:39], v[76:79], v[232:235], v[36:39]
    ds_read_b64_tr_b16 v[70:71], v12 offset:46080
    v_mfma_f32_16x16x32_bf16 v[44:47], v[76:79], v[236:239], v[44:47]
    v_mfma_f32_16x16x32_bf16 v[100:103], v[76:79], v[24:27], v[100:103]
    s_waitcnt lgkmcnt(2)
    v_mfma_f32_16x16x32_bf16 v[32:35], v[64:67], v[240:243], v[32:35]
    ds_read_b64_tr_b16 v[72:73], v11 offset:47104
    v_mfma_f32_16x16x32_bf16 v[40:43], v[64:67], v[244:247], v[40:43]
    ds_read_b64_tr_b16 v[74:75], v11 offset:48128
    v_mfma_f32_16x16x32_bf16 v[96:99], v[64:67], v[24:27], v[96:99]
    ds_read_b64_tr_b16 v[76:77], v12 offset:47104
    s_waitcnt lgkmcnt(3)
    v_mfma_f32_16x16x32_bf16 v[36:39], v[68:71], v[240:243], v[36:39]
    ds_read_b64_tr_b16 v[78:79], v12 offset:48128
    v_mfma_f32_16x16x32_bf16 v[44:47], v[68:71], v[244:247], v[44:47]
    v_mfma_f32_16x16x32_bf16 v[100:103], v[68:71], v[24:27], v[100:103]
    s_waitcnt lgkmcnt(2)
    v_mfma_f32_16x16x32_bf16 v[32:35], v[72:75], v[248:251], v[32:35]
    v_mfma_f32_16x16x32_bf16 v[40:43], v[72:75], v[252:255], v[40:43]
    v_mfma_f32_16x16x32_bf16 v[96:99], v[72:75], v[24:27], v[96:99]
    s_waitcnt lgkmcnt(0)
    v_mfma_f32_16x16x32_bf16 v[36:39], v[76:79], v[248:251], v[36:39]
    v_mfma_f32_16x16x32_bf16 v[44:47], v[76:79], v[252:255], v[44:47]
    v_mfma_f32_16x16x32_bf16 v[100:103], v[76:79], v[24:27], v[100:103]
    s_nop 3
    ds_write_b128 v14, v[96:99] offset:0
    s_nop 2
    ds_write_b128 v14, v[100:103] offset:64
    v_pk_fma_f32 v[32:33], v[28:29], v[96:97], v[32:33] op_sel:[0,0,0] op_sel_hi:[0,1,1] neg_lo:[1,0,0] neg_hi:[1,0,0]
    v_pk_fma_f32 v[34:35], v[28:29], v[98:99], v[34:35] op_sel:[0,0,0] op_sel_hi:[0,1,1] neg_lo:[1,0,0] neg_hi:[1,0,0]
    v_pk_fma_f32 v[36:37], v[28:29], v[100:101], v[36:37] op_sel:[0,0,0] op_sel_hi:[0,1,1] neg_lo:[1,0,0] neg_hi:[1,0,0]
    v_pk_fma_f32 v[38:39], v[28:29], v[102:103], v[38:39] op_sel:[0,0,0] op_sel_hi:[0,1,1] neg_lo:[1,0,0] neg_hi:[1,0,0]
    v_pk_fma_f32 v[40:41], v[28:29], v[96:97], v[40:41] op_sel:[1,0,0] op_sel_hi:[1,1,1] neg_lo:[1,0,0] neg_hi:[1,0,0]
    v_pk_fma_f32 v[42:43], v[28:29], v[98:99], v[42:43] op_sel:[1,0,0] op_sel_hi:[1,1,1] neg_lo:[1,0,0] neg_hi:[1,0,0]
    v_pk_fma_f32 v[44:45], v[28:29], v[100:101], v[44:45] op_sel:[1,0,0] op_sel_hi:[1,1,1] neg_lo:[1,0,0] neg_hi:[1,0,0]
    v_pk_fma_f32 v[46:47], v[28:29], v[102:103], v[46:47] op_sel:[1,0,0] op_sel_hi:[1,1,1] neg_lo:[1,0,0] neg_hi:[1,0,0]
    v_pk_mul_f32 v[64:65], v[32:33], v[92:93] op_sel:[0,0] op_sel_hi:[1,0]
    v_pk_mul_f32 v[66:67], v[34:35], v[92:93] op_sel:[0,0] op_sel_hi:[1,0]
    v_pk_mul_f32 v[68:69], v[36:37], v[92:93] op_sel:[0,0] op_sel_hi:[1,0]
    v_pk_mul_f32 v[70:71], v[38:39], v[92:93] op_sel:[0,0] op_sel_hi:[1,0]
    v_pk_mul_f32 v[72:73], v[40:41], v[92:93] op_sel:[0,1] op_sel_hi:[1,1]
    v_pk_mul_f32 v[74:75], v[42:43], v[92:93] op_sel:[0,1] op_sel_hi:[1,1]
    v_pk_mul_f32 v[76:77], v[44:45], v[92:93] op_sel:[0,1] op_sel_hi:[1,1]
    v_pk_mul_f32 v[78:79], v[46:47], v[92:93] op_sel:[0,1] op_sel_hi:[1,1]
    v_exp_f32 v64, v64 clamp
    v_exp_f32 v65, v65 clamp
    v_pk_fma_f32 v[32:33], v[32:33], v[94:95], v[88:89] op_sel:[0,0,0] op_sel_hi:[1,0,0]
    v_exp_f32 v66, v66 clamp
    v_exp_f32 v67, v67 clamp
    v_pk_fma_f32 v[34:35], v[34:35], v[94:95], v[88:89] op_sel:[0,0,0] op_sel_hi:[1,0,0]
    v_exp_f32 v68, v68 clamp
    v_exp_f32 v69, v69 clamp
    v_pk_fma_f32 v[36:37], v[36:37], v[94:95], v[88:89] op_sel:[0,0,0] op_sel_hi:[1,0,0]
    v_exp_f32 v70, v70 clamp
    v_exp_f32 v71, v71 clamp
    v_pk_fma_f32 v[38:39], v[38:39], v[94:95], v[88:89] op_sel:[0,0,0] op_sel_hi:[1,0,0]
    v_exp_f32 v72, v72 clamp
    v_exp_f32 v73, v73 clamp
    v_pk_fma_f32 v[40:41], v[40:41], v[94:95], v[88:89] op_sel:[0,1,0] op_sel_hi:[1,1,0]
    v_exp_f32 v74, v74 clamp
    v_exp_f32 v75, v75 clamp
    v_pk_fma_f32 v[42:43], v[42:43], v[94:95], v[88:89] op_sel:[0,1,0] op_sel_hi:[1,1,0]
    v_exp_f32 v76, v76 clamp
    v_exp_f32 v77, v77 clamp
    v_pk_fma_f32 v[44:45], v[44:45], v[94:95], v[88:89] op_sel:[0,1,0] op_sel_hi:[1,1,0]
    v_exp_f32 v78, v78 clamp
    v_exp_f32 v79, v79 clamp
    v_pk_fma_f32 v[46:47], v[46:47], v[94:95], v[88:89] op_sel:[0,1,0] op_sel_hi:[1,1,0]
    v_max_f32 v32, v32, v64
    v_max_f32 v33, v33, v65
    v_max_f32 v34, v34, v66
    v_max_f32 v35, v35, v67
    v_max_f32 v36, v36, v68
    v_max_f32 v37, v37, v69
    v_max_f32 v38, v38, v70
    v_max_f32 v39, v39, v71
    v_max_f32 v40, v40, v72
    v_max_f32 v41, v41, v73
    v_max_f32 v42, v42, v74
    v_max_f32 v43, v43, v75
    v_max_f32 v44, v44, v76
    v_max_f32 v45, v45, v77
    v_max_f32 v46, v46, v78
    v_max_f32 v47, v47, v79
    v_pk_add_f32 v[32:33], v[32:33], v[88:89] op_sel:[0,1] op_sel_hi:[1,1]
    v_pk_add_f32 v[34:35], v[34:35], v[88:89] op_sel:[0,1] op_sel_hi:[1,1]
    v_pk_add_f32 v[36:37], v[36:37], v[88:89] op_sel:[0,1] op_sel_hi:[1,1]
    v_pk_add_f32 v[38:39], v[38:39], v[88:89] op_sel:[0,1] op_sel_hi:[1,1]
    v_pk_add_f32 v[40:41], v[40:41], v[88:89] op_sel:[0,1] op_sel_hi:[1,1]
    v_pk_add_f32 v[42:43], v[42:43], v[88:89] op_sel:[0,1] op_sel_hi:[1,1]
    v_pk_add_f32 v[44:45], v[44:45], v[88:89] op_sel:[0,1] op_sel_hi:[1,1]
    v_pk_add_f32 v[46:47], v[46:47], v[88:89] op_sel:[0,1] op_sel_hi:[1,1]
    v_cvt_pk_bf16_f32 v32, v32, v33
    v_cvt_pk_bf16_f32 v33, v34, v35
    v_cvt_pk_bf16_f32 v34, v36, v37
    v_cvt_pk_bf16_f32 v35, v38, v39
    v_cvt_pk_bf16_f32 v36, v40, v41
    v_cvt_pk_bf16_f32 v37, v42, v43
    v_cvt_pk_bf16_f32 v38, v44, v45
    v_cvt_pk_bf16_f32 v39, v46, v47
    v_lshlrev_b32 v6, 4, v1
    v_and_b32 v4, 1, v1
    v_cmp_eq_u32 vcc, 1, v4
    v_lshlrev_b32 v4, 6, v4
    v_lshl_add_u32 v7, v2, 4, v4
    v_mov_b32 v140, 0x358637bd
    v_mov_b32 v141, 0x358637bd
    v_mov_b32 v142, 0x358637bd
    v_mov_b32 v143, 0x358637bd
    s_add_u32 s5, s7, 44032
    s_waitcnt lgkmcnt(0)
    s_barrier
    buffer_load_dwordx4 v[136:139], v7, s[44:47], s11 offen
    buffer_load_dwordx4 v[128:131], v6, s[44:47], s10 offen offset:0
    buffer_load_dwordx4 v[132:135], v6, s[44:47], s10 offen offset:1024
    s_waitcnt vmcnt(2)
    v_cvt_pk_bf16_f32 v4, v136, v137
    v_cvt_pk_bf16_f32 v5, v138, v139
    v_cndmask_b32 v136, v4, 0, vcc
    v_cndmask_b32 v137, v5, 0, vcc
    v_cndmask_b32 v138, 0, v4, vcc
    v_cndmask_b32 v139, 0, v5, vcc
    s_nop 1
    v_mfma_f32_16x16x32_bf16 v[152:155], v[136:139], v[32:35], v[140:143]
    v_mfma_f32_16x16x32_bf16 v[164:167], v[136:139], v[36:39], v[140:143]
    s_waitcnt vmcnt(1)
    v_cvt_pk_bf16_f32 v128, v128, v129
    v_cvt_pk_bf16_f32 v129, v130, v131
    s_waitcnt vmcnt(0)
    v_cvt_pk_bf16_f32 v130, v132, v133
    v_cvt_pk_bf16_f32 v131, v134, v135
    v_mfma_f32_16x16x16_bf16 v[144:147], v[128:129], v[32:33], 0
    s_nop 0
    v_mfma_f32_16x16x16_bf16 v[148:151], v[130:131], v[34:35], 0
    v_mfma_f32_16x16x16_bf16 v[156:159], v[128:129], v[36:37], 0
    v_mfma_f32_16x16x16_bf16 v[160:163], v[130:131], v[38:39], 0
    v_rcp_f32 v152, v152
    v_rcp_f32 v153, v153
    v_rcp_f32 v164, v164
    v_rcp_f32 v165, v165
    v_pk_mul_f32 v[144:145], v[144:145], v[152:153] op_sel:[0,0] op_sel_hi:[1,0]
    v_pk_mul_f32 v[146:147], v[146:147], v[152:153] op_sel:[0,0] op_sel_hi:[1,0]
    v_pk_mul_f32 v[148:149], v[148:149], v[152:153] op_sel:[0,1] op_sel_hi:[1,1]
    v_pk_mul_f32 v[150:151], v[150:151], v[152:153] op_sel:[0,1] op_sel_hi:[1,1]
    v_cvt_pk_bf16_f32 v176, v144, v145
    v_cvt_pk_bf16_f32 v177, v146, v147
    v_cvt_pk_bf16_f32 v178, v148, v149
    v_cvt_pk_bf16_f32 v179, v150, v151
    buffer_store_dwordx4 v[176:179], v6, s[44:47], s7 offen
    v_pk_mul_f32 v[156:157], v[156:157], v[164:165] op_sel:[0,0] op_sel_hi:[1,0]
    v_pk_mul_f32 v[158:159], v[158:159], v[164:165] op_sel:[0,0] op_sel_hi:[1,0]
    v_pk_mul_f32 v[160:161], v[160:161], v[164:165] op_sel:[0,1] op_sel_hi:[1,1]
    v_pk_mul_f32 v[162:163], v[162:163], v[164:165] op_sel:[0,1] op_sel_hi:[1,1]
    v_cvt_pk_bf16_f32 v180, v156, v157
    v_cvt_pk_bf16_f32 v181, v158, v159
    v_cvt_pk_bf16_f32 v182, v160, v161
    v_cvt_pk_bf16_f32 v183, v162, v163
    buffer_store_dwordx4 v[180:183], v6, s[44:47], s5 offen
    s_waitcnt vmcnt(0)
    s_barrier
    s_lshr_b32 s13, s61, 3
    s_lshl_b32 s12, s60, 1
    s_add_u32 s12, s12, s13
    s_and_b32 s13, s61, 7
    s_lshl_b32 s14, s13, 1
    s_lshr_b32 s10, s3, 1
    s_and_b32 s11, s3, 1
    s_lshl_b32 s15, s12, 2
    s_lshl_b32 s5, s10, 1
    s_add_u32 s15, s15, s5
    v_lshlrev_b32 v16, 4, v1
    s_lshl_b32 s6, s15, 4
    s_lshl_b32 s5, s13, 1
    s_add_u32 s6, s6, s5
    s_add_u32 s6, s6, s11
    s_lshl_b32 s6, s6, 10
    s_add_u32 s7, s6, 4194304
    s_add_u32 s6, s6, 4194304
    s_lshl_b32 s8, s15, 14
    s_lshl_b32 s5, s13, 7
    s_add_u32 s8, s8, s5
    s_lshl_b32 s5, s11, 6
    s_add_u32 s8, s8, s5
    v_lshlrev_b32 v4, 10, v3
    v_lshl_add_u32 v17, v2, 3, v4
    s_add_u32 s5, s8, 16384
    buffer_load_dwordx2 v[24:25], v17, s[36:39], s8 offen offset:0
    buffer_load_dwordx2 v[26:27], v17, s[36:39], s8 offen offset:32
    buffer_load_dwordx2 v[28:29], v17, s[36:39], s5 offen offset:0
    buffer_load_dwordx2 v[30:31], v17, s[36:39], s5 offen offset:32
    s_lshl_b32 s4, s10, 11
    s_add_u32 s4, s4, 98304
    v_lshl_add_u32 v8, v1, 4, s4
    v_and_b32 v4, 1, v2
    v_lshlrev_b32 v4, 5, v4
    v_lshl_add_u32 v4, v2, 8, v4
    v_bfe_u32 v5, v1, 2, 2
    v_lshl_add_u32 v4, v5, 6, v4
    v_and_b32 v5, 3, v1
    v_lshl_add_u32 v9, v5, 3, v4
    v_xor_b32 v10, 32, v9
    s_lshl_b32 s4, s11, 11
    v_add_u32 v9, s4, v9
    v_add_u32 v10, s4, v10
    v_mov_b32 v128, 0x3f803f80
    v_mov_b32 v129, 0x3f803f80
    v_mov_b32 v130, 0x3f803f80
    v_mov_b32 v131, 0x3f803f80
    s_waitcnt vmcnt(3)
    v_lshlrev_b32 v32, 16, v24
    v_and_b32 v33, 0xffff0000, v24
    v_lshlrev_b32 v34, 16, v25
    v_and_b32 v35, 0xffff0000, v25
    s_waitcnt vmcnt(2)
    v_lshlrev_b32 v36, 16, v26
    v_and_b32 v37, 0xffff0000, v26
    v_lshlrev_b32 v38, 16, v27
    v_and_b32 v39, 0xffff0000, v27
    s_waitcnt vmcnt(1)
    v_lshlrev_b32 v40, 16, v28
    v_and_b32 v41, 0xffff0000, v28
    v_lshlrev_b32 v42, 16, v29
    v_and_b32 v43, 0xffff0000, v29
    s_waitcnt vmcnt(0)
    v_lshlrev_b32 v44, 16, v30
    v_and_b32 v45, 0xffff0000, v30
    v_lshlrev_b32 v46, 16, v31
    v_and_b32 v47, 0xffff0000, v31
    s_mov_b32 s58, 0
    s_mov_b32 s59, 0
    s_mov_b32 s9, 0
    v_mov_b32 v11, v8
    v_add_u32 v12, s59, v9
    v_add_u32 v13, s59, v10
    s_barrier
    ds_read_b128 v[48:51], v11 offset:0
    ds_read_b64_tr_b16 v[64:65], v12 offset:0
    ds_read_b64_tr_b16 v[66:67], v12 offset:1024
    ds_read_b128 v[52:55], v11 offset:1024
    ds_read_b64_tr_b16 v[68:69], v13 offset:0
    ds_read_b64_tr_b16 v[70:71], v13 offset:1024
    ds_read_b128 v[56:59], v11 offset:4096
    ds_read_b64_tr_b16 v[72:73], v12 offset:4096
    ds_read_b64_tr_b16 v[74:75], v12 offset:5120
    ds_read_b128 v[60:63], v11 offset:5120
    ds_read_b64_tr_b16 v[76:77], v13 offset:4096
    ds_read_b64_tr_b16 v[78:79], v13 offset:5120
L_ml_s2l0:
    s_barrier
    s_waitcnt lgkmcnt(9)
    v_mfma_f32_16x16x32_bf16 v[32:35], v[64:67], v[48:51], v[32:35]
    ds_read_b128 v[80:83], v11 offset:8192
    ds_read_b64_tr_b16 v[96:97], v12 offset:8192
    s_waitcnt lgkmcnt(10)
    v_mfma_f32_16x16x32_bf16 v[40:43], v[64:67], v[52:55], v[40:43]
    ds_read_b64_tr_b16 v[98:99], v12 offset:9216
    ds_read_b128 v[84:87], v11 offset:9216
    s_waitcnt lgkmcnt(10)
    v_mfma_f32_16x16x32_bf16 v[36:39], v[68:71], v[48:51], v[36:39]
    ds_read_b64_tr_b16 v[100:101], v13 offset:8192
    ds_read_b64_tr_b16 v[102:103], v13 offset:9216
    v_mfma_f32_16x16x32_bf16 v[44:47], v[68:71], v[52:55], v[44:47]
    ds_read_b128 v[88:91], v11 offset:12288
    ds_read_b64_tr_b16 v[104:105], v12 offset:12288
    s_waitcnt lgkmcnt(11)
    v_mfma_f32_16x16x32_bf16 v[32:35], v[72:75], v[56:59], v[32:35]
    ds_read_b64_tr_b16 v[106:107], v12 offset:13312
    ds_read_b128 v[92:95], v11 offset:13312
    s_waitcnt lgkmcnt(12)
    v_mfma_f32_16x16x32_bf16 v[40:43], v[72:75], v[60:63], v[40:43]
    ds_read_b64_tr_b16 v[108:109], v13 offset:12288
    ds_read_b64_tr_b16 v[110:111], v13 offset:13312
    s_waitcnt lgkmcnt(12)
    v_mfma_f32_16x16x32_bf16 v[36:39], v[76:79], v[56:59], v[36:39]
    s_add_u32 s58, s58, 16384
    s_cmp_eq_u32 s58, 49152
    s_cselect_b32 s58, 0, s58
    s_add_u32 s59, s59, 16384
    s_cmp_eq_u32 s59, 98304
    v_mfma_f32_16x16x32_bf16 v[44:47], v[76:79], v[60:63], v[44:47]
    s_cselect_b32 s59, 0, s59
    v_add_u32 v11, s58, v8
    v_add_u32 v12, s59, v9
    v_add_u32 v13, s59, v10
    s_barrier
    s_waitcnt lgkmcnt(9)
    v_mfma_f32_16x16x32_bf16 v[32:35], v[96:99], v[80:83], v[32:35]
    ds_read_b128 v[48:51], v11 offset:0
    ds_read_b64_tr_b16 v[64:65], v12 offset:0
    s_waitcnt lgkmcnt(10)
    v_mfma_f32_16x16x32_bf16 v[40:43], v[96:99], v[84:87], v[40:43]
    ds_read_b64_tr_b16 v[66:67], v12 offset:1024
    ds_read_b128 v[52:55], v11 offset:1024
    s_waitcnt lgkmcnt(10)
    v_mfma_f32_16x16x32_bf16 v[36:39], v[100:103], v[80:83], v[36:39]
    ds_read_b64_tr_b16 v[68:69], v13 offset:0
    ds_read_b64_tr_b16 v[70:71], v13 offset:1024
    v_mfma_f32_16x16x32_bf16 v[44:47], v[100:103], v[84:87], v[44:47]
    ds_read_b128 v[56:59], v11 offset:4096
    ds_read_b64_tr_b16 v[72:73], v12 offset:4096
    s_waitcnt lgkmcnt(11)
    v_mfma_f32_16x16x32_bf16 v[32:35], v[104:107], v[88:91], v[32:35]
    ds_read_b64_tr_b16 v[74:75], v12 offset:5120
    ds_read_b128 v[60:63], v11 offset:5120
    s_waitcnt lgkmcnt(12)
    v_mfma_f32_16x16x32_bf16 v[40:43], v[104:107], v[92:95], v[40:43]
    ds_read_b64_tr_b16 v[76:77], v13 offset:4096
    ds_read_b64_tr_b16 v[78:79], v13 offset:5120
    s_waitcnt lgkmcnt(12)
    v_mfma_f32_16x16x32_bf16 v[36:39], v[108:111], v[88:91], v[36:39]
    s_add_u32 s9, s9, 1
    v_mfma_f32_16x16x32_bf16 v[44:47], v[108:111], v[92:95], v[44:47]
    s_cmp_lt_u32 s9, 4
    s_cbranch_scc1 L_ml_s2l0
    s_waitcnt lgkmcnt(0)
    v_cvt_pk_bf16_f32 v24, v32, v33
    v_cvt_pk_bf16_f32 v25, v34, v35
    s_nop 0
    v_cvt_pk_bf16_f32 v26, v36, v37
    v_cvt_pk_bf16_f32 v27, v38, v39
    v_cvt_pk_bf16_f32 v28, v40, v41
    v_cvt_pk_bf16_f32 v29, v42, v43
    v_cvt_pk_bf16_f32 v30, v44, v45
    v_cvt_pk_bf16_f32 v31, v46, v47
    v_mfma_f32_16x16x32_bf16 v[112:115], v[128:131], v[24:27], 0
    v_mfma_f32_16x16x32_bf16 v[116:119], v[24:27], v[24:27], 0
    v_mfma_f32_16x16x32_bf16 v[120:123], v[128:131], v[28:31], 0
    v_mfma_f32_16x16x32_bf16 v[124:127], v[28:31], v[28:31], 0
    s_add_u32 s5, s6, 16384
    buffer_store_dwordx4 v[24:27], v16, s[44:47], s6 offen
    buffer_store_dwordx4 v[28:31], v16, s[44:47], s5 offen
    s_lshl_b32 s4, s15, 10
    s_lshl_b32 s5, s13, 3
    s_add_u32 s4, s4, s5
    s_lshl_b32 s5, s11, 17
    s_add_u32 s4, s4, s5
    s_add_u32 s4, s4, 23592960
    v_lshlrev_b32 v5, 6, v3
    v_and_b32 v6, 3, v3
    v_cmp_eq_u32 s[52:53], 1, v6
    v_cmp_eq_u32 s[54:55], 2, v6
    v_cmp_eq_u32 s[56:57], 3, v6
    v_lshrrev_b32 v6, 2, v3
    v_cmp_eq_u32 vcc, v6, v2
    v_cndmask_b32 v113, v116, v117, s[52:53]
    v_cndmask_b32 v113, v113, v118, s[54:55]
    v_cndmask_b32 v113, v113, v119, s[56:57]
    v_cndmask_b32 v121, v124, v125, s[52:53]
    v_cndmask_b32 v121, v121, v126, s[54:55]
    v_cndmask_b32 v121, v121, v127, s[56:57]
    s_mov_b64 exec, vcc
    buffer_store_dwordx2 v[112:113], v5, s[44:47], s4 offen offset:0
    buffer_store_dwordx2 v[120:121], v5, s[44:47], s4 offen offset:1024
    s_mov_b64 exec, -1
    s_waitcnt vmcnt(0)
    s_barrier
    s_mov_b32 s12, s60
    s_mov_b32 s13, s61
    s_mov_b32 s14, s61
    s_lshr_b32 s6, s3, 1
    s_and_b32 s11, s3, 1
    s_lshl_b32 s15, s12, 3
    s_lshl_b32 s5, s6, 2
    s_add_u32 s15, s15, s5
    s_lshl_b32 s4, s6, 12
    s_add_u32 s4, s4, 98304
    v_lshl_add_u32 v8, v1, 4, s4
    v_and_b32 v4, 1, v2
    v_lshlrev_b32 v4, 5, v4
    v_lshl_add_u32 v4, v2, 8, v4
    v_bfe_u32 v5, v1, 2, 2
    v_lshl_add_u32 v4, v5, 6, v4
    v_and_b32 v5, 3, v1
    v_lshl_add_u32 v9, v5, 3, v4
    v_xor_b32 v10, 32, v9
    s_lshl_b32 s4, s11, 5
    v_xor_b32 v11, s4, v9
    v_add_u32 v11, 4096, v11
    s_lshl_b32 s4, s11, 13
    v_add_u32 v9, s4, v9
    v_add_u32 v10, s4, v10
    s_mul_i32 s4, s15, 43
    s_mul_i32 s5, s13, 3
    s_add_u32 s4, s4, s5
    s_lshl_b32 s4, s4, 10
    s_add_u32 s4, s4, 8388608
    s_lshl_b32 s7, s11, 11
    s_add_u32 s7, s7, s4
    s_lshl_b32 s8, s11, 3
    s_add_u32 s8, s8, s4
    s_add_u32 s8, s8, 1024
    s_cmp_ge_u32 s13, 14
    s_cselect_b32 s8, 24117248, s8
    s_cselect_b32 s5, s11, 0
    s_cmp_eq_u32 s13, 15
    s_cselect_b32 s5, 1, s5
    s_cmp_lg_u32 s5, 0
    s_cselect_b32 s7, 24117248, s7
    s_mul_i32 s4, s11, 384
    s_add_u32 s4, s4, 158720
    v_lshl_add_u32 v16, v2, 4, s4
    v_mov_b32 v240, 0x3f803f80
    v_mov_b32 v241, 0x3f803f80
    v_mov_b32 v242, 0x3f803f80
    v_mov_b32 v243, 0x3f803f80
    v_mov_b32 v40, 0
    v_mov_b32 v41, 0
    v_mov_b32 v42, 0
    v_mov_b32 v43, 0
    v_mov_b32 v44, 0
    v_mov_b32 v45, 0
    v_mov_b32 v46, 0
    v_mov_b32 v47, 0
    v_mov_b32 v48, 0
    v_mov_b32 v49, 0
    v_mov_b32 v50, 0
    v_mov_b32 v51, 0
    v_mov_b32 v52, 0
    v_mov_b32 v53, 0
    v_mov_b32 v54, 0
    v_mov_b32 v55, 0
    v_mov_b32 v56, 0
    v_mov_b32 v57, 0
    v_mov_b32 v58, 0
    v_mov_b32 v59, 0
    v_mov_b32 v60, 0
    v_mov_b32 v61, 0
    v_mov_b32 v62, 0
    v_mov_b32 v63, 0
    v_mov_b32 v64, 0
    v_mov_b32 v65, 0
    v_mov_b32 v66, 0
    v_mov_b32 v67, 0
    v_mov_b32 v68, 0
    v_mov_b32 v69, 0
    v_mov_b32 v70, 0
    v_mov_b32 v71, 0
    v_mov_b32 v72, 0
    v_mov_b32 v73, 0
    v_mov_b32 v74, 0
    v_mov_b32 v75, 0
    v_mov_b32 v76, 0
    v_mov_b32 v77, 0
    v_mov_b32 v78, 0
    v_mov_b32 v79, 0
    v_mov_b32 v80, 0
    v_mov_b32 v81, 0
    v_mov_b32 v82, 0
    v_mov_b32 v83, 0
    v_mov_b32 v84, 0
    v_mov_b32 v85, 0
    v_mov_b32 v86, 0
    v_mov_b32 v87, 0
    v_mov_b32 v88, 0
    v_mov_b32 v89, 0
    v_mov_b32 v90, 0
    v_mov_b32 v91, 0
    v_mov_b32 v92, 0
    v_mov_b32 v93, 0
    v_mov_b32 v94, 0
    v_mov_b32 v95, 0
    v_mov_b32 v96, 0
    v_mov_b32 v97, 0
    v_mov_b32 v98, 0
    v_mov_b32 v99, 0
    v_mov_b32 v100, 0
    v_mov_b32 v101, 0
    v_mov_b32 v102, 0
    v_mov_b32 v103, 0
    v_mov_b32 v104, 0
    v_mov_b32 v105, 0
    v_mov_b32 v106, 0
    v_mov_b32 v107, 0
    v_mov_b32 v108, 0
    v_mov_b32 v109, 0
    v_mov_b32 v110, 0
    v_mov_b32 v111, 0
    v_mov_b32 v112, 0
    v_mov_b32 v113, 0
    v_mov_b32 v114, 0
    v_mov_b32 v115, 0
    v_mov_b32 v116, 0
    v_mov_b32 v117, 0
    v_mov_b32 v118, 0
    v_mov_b32 v119, 0
    v_mov_b32 v120, 0
    v_mov_b32 v121, 0
    v_mov_b32 v122, 0
    v_mov_b32 v123, 0
    v_mov_b32 v124, 0
    v_mov_b32 v125, 0
    v_mov_b32 v126, 0
    v_mov_b32 v127, 0
    v_mov_b32 v128, 0
    v_mov_b32 v129, 0
    v_mov_b32 v130, 0
    v_mov_b32 v131, 0
    v_mov_b32 v132, 0
    v_mov_b32 v133, 0
    v_mov_b32 v134, 0
    v_mov_b32 v135, 0
    v_mov_b32 v136, 0
    v_mov_b32 v137, 0
    v_mov_b32 v138, 0
    v_mov_b32 v139, 0
    v_mov_b32 v140, 0
    v_mov_b32 v141, 0
    v_mov_b32 v142, 0
    v_mov_b32 v143, 0
    v_mov_b32 v144, 0
    v_mov_b32 v145, 0
    v_mov_b32 v146, 0
    v_mov_b32 v147, 0
    v_mov_b32 v148, 0
    v_mov_b32 v149, 0
    v_mov_b32 v150, 0
    v_mov_b32 v151, 0
    v_mov_b32 v152, 0
    v_mov_b32 v153, 0
    v_mov_b32 v154, 0
    v_mov_b32 v155, 0
    v_mov_b32 v156, 0
    v_mov_b32 v157, 0
    v_mov_b32 v158, 0
    v_mov_b32 v159, 0
    s_lshl_b32 s4, s6, 8
    s_add_u32 s4, s4, 147456
    v_lshl_add_u32 v6, v3, 2, s4
    v_lshlrev_b32 v4, 4, v1
    s_mov_b32 s58, 0
    s_mov_b32 s59, 73728
    s_mov_b32 s9, 0
    v_mov_b32 v12, v8
    v_add_u32 v13, s59, v9
    v_add_u32 v14, s59, v10
    v_add_u32 v15, s59, v11
    s_barrier
    ds_read_b64_tr_b16 v[176:177], v13 offset:0
    ds_read_b64_tr_b16 v[178:179], v13 offset:1024
    ds_read_b128 v[160:163], v12 offset:0
    ds_read_b128 v[164:167], v12 offset:1024
    ds_read_b128 v[168:171], v12 offset:2048
    ds_read_b128 v[172:175], v12 offset:3072
    ds_read_b64_tr_b16 v[180:181], v13 offset:2048
    ds_read_b64_tr_b16 v[182:183], v13 offset:3072
    ds_read_b64_tr_b16 v[184:185], v14 offset:0
    ds_read_b64_tr_b16 v[186:187], v14 offset:1024
    ds_read_b64_tr_b16 v[188:189], v14 offset:2048
    ds_read_b64_tr_b16 v[190:191], v14 offset:3072
    ds_read_b64_tr_b16 v[192:193], v15 offset:0
    ds_read_b64_tr_b16 v[194:195], v15 offset:1024
    ds_read_b64_tr_b16 v[196:197], v15 offset:2048
    ds_read_b64_tr_b16 v[198:199], v15 offset:3072
L_ml_s3l0:
    s_waitcnt lgkmcnt(13)
    v_mfma_f32_16x16x32_bf16 v[40:43], v[176:179], v[160:163], v[40:43]
    ds_read_b64_tr_b16 v[216:217], v13 offset:12288
    s_waitcnt lgkmcnt(13)
    v_mfma_f32_16x16x32_bf16 v[52:55], v[176:179], v[164:167], v[52:55]
    ds_read_b64_tr_b16 v[218:219], v13 offset:13312
    s_waitcnt lgkmcnt(13)
    v_mfma_f32_16x16x32_bf16 v[64:67], v[176:179], v[168:171], v[64:67]
    ds_read_b128 v[200:203], v12 offset:8192
    s_waitcnt lgkmcnt(13)
    v_mfma_f32_16x16x32_bf16 v[76:79], v[176:179], v[172:175], v[76:79]
    ds_read_b128 v[204:207], v12 offset:9216
    s_waitcnt lgkmcnt(12)
    v_mfma_f32_16x16x32_bf16 v[88:91], v[180:183], v[160:163], v[88:91]
    ds_read_b128 v[208:211], v12 offset:10240
    v_mfma_f32_16x16x32_bf16 v[100:103], v[180:183], v[164:167], v[100:103]
    ds_read_b128 v[212:215], v12 offset:11264
    v_mfma_f32_16x16x32_bf16 v[112:115], v[180:183], v[168:171], v[112:115]
    ds_read_b64_tr_b16 v[220:221], v13 offset:14336
    v_mfma_f32_16x16x32_bf16 v[124:127], v[180:183], v[172:175], v[124:127]
    ds_read_b64_tr_b16 v[222:223], v13 offset:15360
    s_waitcnt lgkmcnt(14)
    v_mfma_f32_16x16x32_bf16 v[44:47], v[184:187], v[160:163], v[44:47]
    ds_read_b64_tr_b16 v[224:225], v14 offset:12288
    v_mfma_f32_16x16x32_bf16 v[56:59], v[184:187], v[164:167], v[56:59]
    ds_read_b64_tr_b16 v[226:227], v14 offset:13312
    v_mfma_f32_16x16x32_bf16 v[68:71], v[184:187], v[168:171], v[68:71]
    ds_read_b64_tr_b16 v[228:229], v14 offset:14336
    v_mfma_f32_16x16x32_bf16 v[80:83], v[184:187], v[172:175], v[80:83]
    ds_read_b64_tr_b16 v[230:231], v14 offset:15360
    s_waitcnt lgkmcnt(14)
    v_mfma_f32_16x16x32_bf16 v[92:95], v[188:191], v[160:163], v[92:95]
    ds_read_b64_tr_b16 v[232:233], v15 offset:12288
    v_mfma_f32_16x16x32_bf16 v[104:107], v[188:191], v[164:167], v[104:107]
    ds_read_b64_tr_b16 v[234:235], v15 offset:13312
    v_mfma_f32_16x16x32_bf16 v[116:119], v[188:191], v[168:171], v[116:119]
    ds_read_b64_tr_b16 v[236:237], v15 offset:14336
    v_mfma_f32_16x16x32_bf16 v[128:131], v[188:191], v[172:175], v[128:131]
    ds_read_b64_tr_b16 v[238:239], v15 offset:15360
    v_mfma_f32_16x16x32_bf16 v[48:51], v[192:195], v[160:163], v[48:51]
    s_add_u32 s58, s58, 16384
    s_cmp_eq_u32 s58, 49152
    v_mfma_f32_16x16x32_bf16 v[60:63], v[192:195], v[164:167], v[60:63]
    s_cselect_b32 s58, 0, s58
    s_add_u32 s59, s59, 24576
    v_mfma_f32_16x16x32_bf16 v[72:75], v[192:195], v[168:171], v[72:75]
    s_cmp_eq_u32 s59, 98304
    s_cselect_b32 s59, 0, s59
    v_mfma_f32_16x16x32_bf16 v[84:87], v[192:195], v[172:175], v[84:87]
    v_add_u32 v12, s58, v8
    v_add_u32 v13, s59, v9
    s_waitcnt lgkmcnt(14)
    v_mfma_f32_16x16x32_bf16 v[96:99], v[196:199], v[160:163], v[96:99]
    v_add_u32 v14, s59, v10
    v_add_u32 v15, s59, v11
    v_mfma_f32_16x16x32_bf16 v[108:111], v[196:199], v[164:167], v[108:111]
    s_add_u32 s9, s9, 1
    v_mfma_f32_16x16x32_bf16 v[120:123], v[196:199], v[168:171], v[120:123]
    v_mfma_f32_16x16x32_bf16 v[132:135], v[196:199], v[172:175], v[132:135]
    v_mfma_f32_16x16x32_bf16 v[136:139], v[176:179], v[240:243], v[136:139]
    v_mfma_f32_16x16x32_bf16 v[148:151], v[180:183], v[240:243], v[148:151]
    v_mfma_f32_16x16x32_bf16 v[140:143], v[184:187], v[240:243], v[140:143]
    v_mfma_f32_16x16x32_bf16 v[152:155], v[188:191], v[240:243], v[152:155]
    v_mfma_f32_16x16x32_bf16 v[144:147], v[192:195], v[240:243], v[144:147]
    v_mfma_f32_16x16x32_bf16 v[156:159], v[196:199], v[240:243], v[156:159]
    s_waitcnt lgkmcnt(0)
    s_barrier
    s_cmp_lt_u32 s9, 8
    s_cbranch_scc0 L_mx_s3l0
    v_mfma_f32_16x16x32_bf16 v[40:43], v[216:219], v[200:203], v[40:43]
    ds_read_b64_tr_b16 v[176:177], v13 offset:0
    v_mfma_f32_16x16x32_bf16 v[52:55], v[216:219], v[204:207], v[52:55]
    ds_read_b64_tr_b16 v[178:179], v13 offset:1024
    v_mfma_f32_16x16x32_bf16 v[64:67], v[216:219], v[208:211], v[64:67]
    ds_read_b128 v[160:163], v12 offset:0
    v_mfma_f32_16x16x32_bf16 v[76:79], v[216:219], v[212:215], v[76:79]
    ds_read_b128 v[164:167], v12 offset:1024
    v_mfma_f32_16x16x32_bf16 v[88:91], v[220:223], v[200:203], v[88:91]
    ds_read_b128 v[168:171], v12 offset:2048
    v_mfma_f32_16x16x32_bf16 v[100:103], v[220:223], v[204:207], v[100:103]
    ds_read_b128 v[172:175], v12 offset:3072
    v_mfma_f32_16x16x32_bf16 v[112:115], v[220:223], v[208:211], v[112:115]
    ds_read_b64_tr_b16 v[180:181], v13 offset:2048
    v_mfma_f32_16x16x32_bf16 v[124:127], v[220:223], v[212:215], v[124:127]
    ds_read_b64_tr_b16 v[182:183], v13 offset:3072
    v_mfma_f32_16x16x32_bf16 v[44:47], v[224:227], v[200:203], v[44:47]
    ds_read_b64_tr_b16 v[184:185], v14 offset:0
    v_mfma_f32_16x16x32_bf16 v[56:59], v[224:227], v[204:207], v[56:59]
    ds_read_b64_tr_b16 v[186:187], v14 offset:1024
    v_mfma_f32_16x16x32_bf16 v[68:71], v[224:227], v[208:211], v[68:71]
    ds_read_b64_tr_b16 v[188:189], v14 offset:2048
    v_mfma_f32_16x16x32_bf16 v[80:83], v[224:227], v[212:215], v[80:83]
    ds_read_b64_tr_b16 v[190:191], v14 offset:3072
    v_mfma_f32_16x16x32_bf16 v[92:95], v[228:231], v[200:203], v[92:95]
    ds_read_b64_tr_b16 v[192:193], v15 offset:0
    v_mfma_f32_16x16x32_bf16 v[104:107], v[228:231], v[204:207], v[104:107]
    ds_read_b64_tr_b16 v[194:195], v15 offset:1024
    v_mfma_f32_16x16x32_bf16 v[116:119], v[228:231], v[208:211], v[116:119]
    ds_read_b64_tr_b16 v[196:197], v15 offset:2048
    v_mfma_f32_16x16x32_bf16 v[128:131], v[228:231], v[212:215], v[128:131]
    ds_read_b64_tr_b16 v[198:199], v15 offset:3072
    v_mfma_f32_16x16x32_bf16 v[48:51], v[232:235], v[200:203], v[48:51]
    v_mfma_f32_16x16x32_bf16 v[60:63], v[232:235], v[204:207], v[60:63]
    v_mfma_f32_16x16x32_bf16 v[72:75], v[232:235], v[208:211], v[72:75]
    v_mfma_f32_16x16x32_bf16 v[84:87], v[232:235], v[212:215], v[84:87]
    v_mfma_f32_16x16x32_bf16 v[96:99], v[236:239], v[200:203], v[96:99]
    v_mfma_f32_16x16x32_bf16 v[108:111], v[236:239], v[204:207], v[108:111]
    v_mfma_f32_16x16x32_bf16 v[120:123], v[236:239], v[208:211], v[120:123]
    v_mfma_f32_16x16x32_bf16 v[132:135], v[236:239], v[212:215], v[132:135]
    v_mfma_f32_16x16x32_bf16 v[136:139], v[216:219], v[240:243], v[136:139]
    v_mfma_f32_16x16x32_bf16 v[148:151], v[220:223], v[240:243], v[148:151]
    v_mfma_f32_16x16x32_bf16 v[140:143], v[224:227], v[240:243], v[140:143]
    v_mfma_f32_16x16x32_bf16 v[152:155], v[228:231], v[240:243], v[152:155]
    v_mfma_f32_16x16x32_bf16 v[144:147], v[232:235], v[240:243], v[144:147]
    v_mfma_f32_16x16x32_bf16 v[156:159], v[236:239], v[240:243], v[156:159]
    s_branch L_ml_s3l0
L_mx_s3l0:
    v_mfma_f32_16x16x32_bf16 v[136:139], v[216:219], v[240:243], v[136:139]
    ds_read_b32 v24, v6 offset:0
    ds_read_b32 v28, v6 offset:512
    v_mfma_f32_16x16x32_bf16 v[148:151], v[220:223], v[240:243], v[148:151]
    ds_read_b32 v25, v6 offset:64
    ds_read_b32 v29, v6 offset:576
    v_mfma_f32_16x16x32_bf16 v[140:143], v[224:227], v[240:243], v[140:143]
    ds_read_b32 v26, v6 offset:128
    ds_read_b32 v30, v6 offset:640
    v_mfma_f32_16x16x32_bf16 v[152:155], v[228:231], v[240:243], v[152:155]
    ds_read_b32 v27, v6 offset:192
    ds_read_b32 v31, v6 offset:704
    v_mfma_f32_16x16x32_bf16 v[144:147], v[232:235], v[240:243], v[144:147]
    v_mfma_f32_16x16x32_bf16 v[156:159], v[236:239], v[240:243], v[156:159]
    v_mfma_f32_16x16x32_bf16 v[40:43], v[216:219], v[200:203], v[40:43]
    v_mfma_f32_16x16x32_bf16 v[88:91], v[220:223], v[200:203], v[88:91]
    v_mfma_f32_16x16x32_bf16 v[44:47], v[224:227], v[200:203], v[44:47]
    v_mfma_f32_16x16x32_bf16 v[92:95], v[228:231], v[200:203], v[92:95]
    v_mfma_f32_16x16x32_bf16 v[48:51], v[232:235], v[200:203], v[48:51]
    v_mfma_f32_16x16x32_bf16 v[96:99], v[236:239], v[200:203], v[96:99]
    v_mfma_f32_16x16x32_bf16 v[52:55], v[216:219], v[204:207], v[52:55]
    v_mfma_f32_16x16x32_bf16 v[100:103], v[220:223], v[204:207], v[100:103]
    v_mfma_f32_16x16x32_bf16 v[56:59], v[224:227], v[204:207], v[56:59]
    s_waitcnt lgkmcnt(6)
    v_mul_f32 v32, v28, v28
    s_waitcnt lgkmcnt(4)
    v_mul_f32 v33, v29, v29
    s_waitcnt lgkmcnt(2)
    v_mul_f32 v34, v30, v30
    s_waitcnt lgkmcnt(0)
    v_mul_f32 v35, v31, v31
    v_mfma_f32_16x16x32_bf16 v[104:107], v[228:231], v[204:207], v[104:107]
    v_pk_fma_f32 v[40:41], v[24:25], v[136:137], v[40:41] op_sel:[0,0,0] op_sel_hi:[0,1,1] neg_lo:[1,0,0] neg_hi:[1,0,0]
    v_pk_fma_f32 v[88:89], v[24:25], v[148:149], v[88:89] op_sel:[0,0,0] op_sel_hi:[0,1,1] neg_lo:[1,0,0] neg_hi:[1,0,0]
    v_pk_fma_f32 v[42:43], v[24:25], v[138:139], v[42:43] op_sel:[0,0,0] op_sel_hi:[0,1,1] neg_lo:[1,0,0] neg_hi:[1,0,0]
    v_pk_fma_f32 v[90:91], v[24:25], v[150:151], v[90:91] op_sel:[0,0,0] op_sel_hi:[0,1,1] neg_lo:[1,0,0] neg_hi:[1,0,0]
    v_pk_fma_f32 v[44:45], v[24:25], v[140:141], v[44:45] op_sel:[0,0,0] op_sel_hi:[0,1,1] neg_lo:[1,0,0] neg_hi:[1,0,0]
    v_mfma_f32_16x16x32_bf16 v[60:63], v[232:235], v[204:207], v[60:63]
    v_pk_fma_f32 v[92:93], v[24:25], v[152:153], v[92:93] op_sel:[0,0,0] op_sel_hi:[0,1,1] neg_lo:[1,0,0] neg_hi:[1,0,0]
    v_pk_fma_f32 v[46:47], v[24:25], v[142:143], v[46:47] op_sel:[0,0,0] op_sel_hi:[0,1,1] neg_lo:[1,0,0] neg_hi:[1,0,0]
    v_pk_fma_f32 v[94:95], v[24:25], v[154:155], v[94:95] op_sel:[0,0,0] op_sel_hi:[0,1,1] neg_lo:[1,0,0] neg_hi:[1,0,0]
    v_pk_fma_f32 v[48:49], v[24:25], v[144:145], v[48:49] op_sel:[0,0,0] op_sel_hi:[0,1,1] neg_lo:[1,0,0] neg_hi:[1,0,0]
    v_pk_fma_f32 v[96:97], v[24:25], v[156:157], v[96:97] op_sel:[0,0,0] op_sel_hi:[0,1,1] neg_lo:[1,0,0] neg_hi:[1,0,0]
    v_mfma_f32_16x16x32_bf16 v[108:111], v[236:239], v[204:207], v[108:111]
    v_pk_fma_f32 v[50:51], v[24:25], v[146:147], v[50:51] op_sel:[0,0,0] op_sel_hi:[0,1,1] neg_lo:[1,0,0] neg_hi:[1,0,0]
    v_pk_fma_f32 v[98:99], v[24:25], v[158:159], v[98:99] op_sel:[0,0,0] op_sel_hi:[0,1,1] neg_lo:[1,0,0] neg_hi:[1,0,0]
    v_max_f32 v40, 0, v40
    v_max_f32 v41, 0, v41
    v_pk_mul_f32 v[88:89], v[88:89], v[32:33] op_sel:[0,0] op_sel_hi:[1,0]
    v_mfma_f32_16x16x32_bf16 v[64:67], v[216:219], v[208:211], v[64:67]
    v_max_f32 v42, 0, v42
    v_max_f32 v43, 0, v43
    v_pk_mul_f32 v[90:91], v[90:91], v[32:33] op_sel:[0,0] op_sel_hi:[1,0]
    v_max_f32 v44, 0, v44
    v_max_f32 v45, 0, v45
    v_mfma_f32_16x16x32_bf16 v[112:115], v[220:223], v[208:211], v[112:115]
    v_pk_mul_f32 v[92:93], v[92:93], v[32:33] op_sel:[0,0] op_sel_hi:[1,0]
    v_max_f32 v46, 0, v46
    v_max_f32 v47, 0, v47
    v_pk_mul_f32 v[94:95], v[94:95], v[32:33] op_sel:[0,0] op_sel_hi:[1,0]
    v_max_f32 v48, 0, v48
    v_mfma_f32_16x16x32_bf16 v[68:71], v[224:227], v[208:211], v[68:71]
    v_max_f32 v49, 0, v49
    v_pk_mul_f32 v[96:97], v[96:97], v[32:33] op_sel:[0,0] op_sel_hi:[1,0]
    v_max_f32 v50, 0, v50
    v_max_f32 v51, 0, v51
    v_pk_mul_f32 v[98:99], v[98:99], v[32:33] op_sel:[0,0] op_sel_hi:[1,0]
    v_pk_mul_f32 v[40:41], v[40:41], v[88:89] op_sel:[0,0] op_sel_hi:[1,1]
    v_pk_mul_f32 v[42:43], v[42:43], v[90:91] op_sel:[0,0] op_sel_hi:[1,1]
    v_pk_mul_f32 v[44:45], v[44:45], v[92:93] op_sel:[0,0] op_sel_hi:[1,1]
    v_pk_mul_f32 v[46:47], v[46:47], v[94:95] op_sel:[0,0] op_sel_hi:[1,1]
    v_pk_mul_f32 v[48:49], v[48:49], v[96:97] op_sel:[0,0] op_sel_hi:[1,1]
    v_pk_mul_f32 v[50:51], v[50:51], v[98:99] op_sel:[0,0] op_sel_hi:[1,1]
    v_cvt_pk_bf16_f32 v160, v40, v41
    v_cvt_pk_bf16_f32 v161, v42, v43
    v_cvt_pk_bf16_f32 v162, v44, v45
    v_cvt_pk_bf16_f32 v163, v46, v47
    v_cvt_pk_bf16_f32 v164, v48, v49
    v_cvt_pk_bf16_f32 v165, v50, v51
    buffer_store_dwordx4 v[160:163], v4, s[44:47], s7 offen
    buffer_store_dwordx2 v[164:165], v4, s[44:47], s8 offen
    s_add_u32 s7, s7, 44032
    s_add_u32 s8, s8, 44032
    v_mfma_f32_16x16x32_bf16 v[116:119], v[228:231], v[208:211], v[116:119]
    v_pk_fma_f32 v[52:53], v[24:25], v[136:137], v[52:53] op_sel:[1,0,0] op_sel_hi:[1,1,1] neg_lo:[1,0,0] neg_hi:[1,0,0]
    v_pk_fma_f32 v[100:101], v[24:25], v[148:149], v[100:101] op_sel:[1,0,0] op_sel_hi:[1,1,1] neg_lo:[1,0,0] neg_hi:[1,0,0]
    v_pk_fma_f32 v[54:55], v[24:25], v[138:139], v[54:55] op_sel:[1,0,0] op_sel_hi:[1,1,1] neg_lo:[1,0,0] neg_hi:[1,0,0]
    v_pk_fma_f32 v[102:103], v[24:25], v[150:151], v[102:103] op_sel:[1,0,0] op_sel_hi:[1,1,1] neg_lo:[1,0,0] neg_hi:[1,0,0]
    v_pk_fma_f32 v[56:57], v[24:25], v[140:141], v[56:57] op_sel:[1,0,0] op_sel_hi:[1,1,1] neg_lo:[1,0,0] neg_hi:[1,0,0]
    v_mfma_f32_16x16x32_bf16 v[72:75], v[232:235], v[208:211], v[72:75]
    v_pk_fma_f32 v[104:105], v[24:25], v[152:153], v[104:105] op_sel:[1,0,0] op_sel_hi:[1,1,1] neg_lo:[1,0,0] neg_hi:[1,0,0]
    v_pk_fma_f32 v[58:59], v[24:25], v[142:143], v[58:59] op_sel:[1,0,0] op_sel_hi:[1,1,1] neg_lo:[1,0,0] neg_hi:[1,0,0]
    v_pk_fma_f32 v[106:107], v[24:25], v[154:155], v[106:107] op_sel:[1,0,0] op_sel_hi:[1,1,1] neg_lo:[1,0,0] neg_hi:[1,0,0]
    v_pk_fma_f32 v[60:61], v[24:25], v[144:145], v[60:61] op_sel:[1,0,0] op_sel_hi:[1,1,1] neg_lo:[1,0,0] neg_hi:[1,0,0]
    v_pk_fma_f32 v[108:109], v[24:25], v[156:157], v[108:109] op_sel:[1,0,0] op_sel_hi:[1,1,1] neg_lo:[1,0,0] neg_hi:[1,0,0]
    v_mfma_f32_16x16x32_bf16 v[120:123], v[236:239], v[208:211], v[120:123]
    v_pk_fma_f32 v[62:63], v[24:25], v[146:147], v[62:63] op_sel:[1,0,0] op_sel_hi:[1,1,1] neg_lo:[1,0,0] neg_hi:[1,0,0]
    v_pk_fma_f32 v[110:111], v[24:25], v[158:159], v[110:111] op_sel:[1,0,0] op_sel_hi:[1,1,1] neg_lo:[1,0,0] neg_hi:[1,0,0]
    v_max_f32 v52, 0, v52
    v_max_f32 v53, 0, v53
    v_pk_mul_f32 v[100:101], v[100:101], v[32:33] op_sel:[0,1] op_sel_hi:[1,1]
    v_mfma_f32_16x16x32_bf16 v[76:79], v[216:219], v[212:215], v[76:79]
    v_max_f32 v54, 0, v54
    v_max_f32 v55, 0, v55
    v_pk_mul_f32 v[102:103], v[102:103], v[32:33] op_sel:[0,1] op_sel_hi:[1,1]
    v_max_f32 v56, 0, v56
    v_max_f32 v57, 0, v57
    v_mfma_f32_16x16x32_bf16 v[124:127], v[220:223], v[212:215], v[124:127]
    v_pk_mul_f32 v[104:105], v[104:105], v[32:33] op_sel:[0,1] op_sel_hi:[1,1]
    v_max_f32 v58, 0, v58
    v_max_f32 v59, 0, v59
    v_pk_mul_f32 v[106:107], v[106:107], v[32:33] op_sel:[0,1] op_sel_hi:[1,1]
    v_max_f32 v60, 0, v60
    v_mfma_f32_16x16x32_bf16 v[80:83], v[224:227], v[212:215], v[80:83]
    v_max_f32 v61, 0, v61
    v_pk_mul_f32 v[108:109], v[108:109], v[32:33] op_sel:[0,1] op_sel_hi:[1,1]
    v_max_f32 v62, 0, v62
    v_max_f32 v63, 0, v63
    v_pk_mul_f32 v[110:111], v[110:111], v[32:33] op_sel:[0,1] op_sel_hi:[1,1]
    v_mfma_f32_16x16x32_bf16 v[128:131], v[228:231], v[212:215], v[128:131]
    v_pk_mul_f32 v[52:53], v[52:53], v[100:101] op_sel:[0,0] op_sel_hi:[1,1]
    v_pk_mul_f32 v[54:55], v[54:55], v[102:103] op_sel:[0,0] op_sel_hi:[1,1]
    v_pk_mul_f32 v[56:57], v[56:57], v[104:105] op_sel:[0,0] op_sel_hi:[1,1]
    v_pk_mul_f32 v[58:59], v[58:59], v[106:107] op_sel:[0,0] op_sel_hi:[1,1]
    v_pk_mul_f32 v[60:61], v[60:61], v[108:109] op_sel:[0,0] op_sel_hi:[1,1]
    v_mfma_f32_16x16x32_bf16 v[84:87], v[232:235], v[212:215], v[84:87]
    v_pk_mul_f32 v[62:63], v[62:63], v[110:111] op_sel:[0,0] op_sel_hi:[1,1]
    v_cvt_pk_bf16_f32 v168, v52, v53
    v_cvt_pk_bf16_f32 v169, v54, v55
    v_cvt_pk_bf16_f32 v170, v56, v57
    v_cvt_pk_bf16_f32 v171, v58, v59
    v_mfma_f32_16x16x32_bf16 v[132:135], v[236:239], v[212:215], v[132:135]
    v_cvt_pk_bf16_f32 v172, v60, v61
    v_cvt_pk_bf16_f32 v173, v62, v63
    buffer_store_dwordx4 v[168:171], v4, s[44:47], s7 offen
    buffer_store_dwordx2 v[172:173], v4, s[44:47], s8 offen
    s_add_u32 s7, s7, 44032
    s_add_u32 s8, s8, 44032
    v_pk_fma_f32 v[64:65], v[26:27], v[136:137], v[64:65] op_sel:[0,0,0] op_sel_hi:[0,1,1] neg_lo:[1,0,0] neg_hi:[1,0,0]
    v_pk_fma_f32 v[112:113], v[26:27], v[148:149], v[112:113] op_sel:[0,0,0] op_sel_hi:[0,1,1] neg_lo:[1,0,0] neg_hi:[1,0,0]
    v_pk_fma_f32 v[66:67], v[26:27], v[138:139], v[66:67] op_sel:[0,0,0] op_sel_hi:[0,1,1] neg_lo:[1,0,0] neg_hi:[1,0,0]
    v_pk_fma_f32 v[114:115], v[26:27], v[150:151], v[114:115] op_sel:[0,0,0] op_sel_hi:[0,1,1] neg_lo:[1,0,0] neg_hi:[1,0,0]
    v_pk_fma_f32 v[68:69], v[26:27], v[140:141], v[68:69] op_sel:[0,0,0] op_sel_hi:[0,1,1] neg_lo:[1,0,0] neg_hi:[1,0,0]
    v_pk_fma_f32 v[116:117], v[26:27], v[152:153], v[116:117] op_sel:[0,0,0] op_sel_hi:[0,1,1] neg_lo:[1,0,0] neg_hi:[1,0,0]
    v_pk_fma_f32 v[70:71], v[26:27], v[142:143], v[70:71] op_sel:[0,0,0] op_sel_hi:[0,1,1] neg_lo:[1,0,0] neg_hi:[1,0,0]
    v_pk_fma_f32 v[118:119], v[26:27], v[154:155], v[118:119] op_sel:[0,0,0] op_sel_hi:[0,1,1] neg_lo:[1,0,0] neg_hi:[1,0,0]
    v_pk_fma_f32 v[72:73], v[26:27], v[144:145], v[72:73] op_sel:[0,0,0] op_sel_hi:[0,1,1] neg_lo:[1,0,0] neg_hi:[1,0,0]
    v_pk_fma_f32 v[120:121], v[26:27], v[156:157], v[120:121] op_sel:[0,0,0] op_sel_hi:[0,1,1] neg_lo:[1,0,0] neg_hi:[1,0,0]
    v_pk_fma_f32 v[74:75], v[26:27], v[146:147], v[74:75] op_sel:[0,0,0] op_sel_hi:[0,1,1] neg_lo:[1,0,0] neg_hi:[1,0,0]
    v_pk_fma_f32 v[122:123], v[26:27], v[158:159], v[122:123] op_sel:[0,0,0] op_sel_hi:[0,1,1] neg_lo:[1,0,0] neg_hi:[1,0,0]
    v_max_f32 v64, 0, v64
    v_max_f32 v65, 0, v65
    v_pk_mul_f32 v[112:113], v[112:113], v[34:35] op_sel:[0,0] op_sel_hi:[1,0]
    v_max_f32 v66, 0, v66
    v_max_f32 v67, 0, v67
    v_pk_mul_f32 v[114:115], v[114:115], v[34:35] op_sel:[0,0] op_sel_hi:[1,0]
    v_max_f32 v68, 0, v68
    v_max_f32 v69, 0, v69
    v_pk_mul_f32 v[116:117], v[116:117], v[34:35] op_sel:[0,0] op_sel_hi:[1,0]
    v_max_f32 v70, 0, v70
    v_max_f32 v71, 0, v71
    v_pk_mul_f32 v[118:119], v[118:119], v[34:35] op_sel:[0,0] op_sel_hi:[1,0]
    v_max_f32 v72, 0, v72
    v_max_f32 v73, 0, v73
    v_pk_mul_f32 v[120:121], v[120:121], v[34:35] op_sel:[0,0] op_sel_hi:[1,0]
    v_max_f32 v74, 0, v74
    v_max_f32 v75, 0, v75
    v_pk_mul_f32 v[122:123], v[122:123], v[34:35] op_sel:[0,0] op_sel_hi:[1,0]
    v_pk_mul_f32 v[64:65], v[64:65], v[112:113] op_sel:[0,0] op_sel_hi:[1,1]
    v_pk_mul_f32 v[66:67], v[66:67], v[114:115] op_sel:[0,0] op_sel_hi:[1,1]
    v_pk_mul_f32 v[68:69], v[68:69], v[116:117] op_sel:[0,0] op_sel_hi:[1,1]
    v_pk_mul_f32 v[70:71], v[70:71], v[118:119] op_sel:[0,0] op_sel_hi:[1,1]
    v_pk_mul_f32 v[72:73], v[72:73], v[120:121] op_sel:[0,0] op_sel_hi:[1,1]
    v_pk_mul_f32 v[74:75], v[74:75], v[122:123] op_sel:[0,0] op_sel_hi:[1,1]
    v_cvt_pk_bf16_f32 v176, v64, v65
    v_cvt_pk_bf16_f32 v177, v66, v67
    v_cvt_pk_bf16_f32 v178, v68, v69
    v_cvt_pk_bf16_f32 v179, v70, v71
    v_cvt_pk_bf16_f32 v180, v72, v73
    v_cvt_pk_bf16_f32 v181, v74, v75
    buffer_store_dwordx4 v[176:179], v4, s[44:47], s7 offen
    buffer_store_dwordx2 v[180:181], v4, s[44:47], s8 offen
    s_add_u32 s7, s7, 44032
    s_add_u32 s8, s8, 44032
    v_pk_fma_f32 v[76:77], v[26:27], v[136:137], v[76:77] op_sel:[1,0,0] op_sel_hi:[1,1,1] neg_lo:[1,0,0] neg_hi:[1,0,0]
    v_pk_fma_f32 v[124:125], v[26:27], v[148:149], v[124:125] op_sel:[1,0,0] op_sel_hi:[1,1,1] neg_lo:[1,0,0] neg_hi:[1,0,0]
    v_pk_fma_f32 v[78:79], v[26:27], v[138:139], v[78:79] op_sel:[1,0,0] op_sel_hi:[1,1,1] neg_lo:[1,0,0] neg_hi:[1,0,0]
    v_pk_fma_f32 v[126:127], v[26:27], v[150:151], v[126:127] op_sel:[1,0,0] op_sel_hi:[1,1,1] neg_lo:[1,0,0] neg_hi:[1,0,0]
    v_pk_fma_f32 v[80:81], v[26:27], v[140:141], v[80:81] op_sel:[1,0,0] op_sel_hi:[1,1,1] neg_lo:[1,0,0] neg_hi:[1,0,0]
    v_pk_fma_f32 v[128:129], v[26:27], v[152:153], v[128:129] op_sel:[1,0,0] op_sel_hi:[1,1,1] neg_lo:[1,0,0] neg_hi:[1,0,0]
    v_pk_fma_f32 v[82:83], v[26:27], v[142:143], v[82:83] op_sel:[1,0,0] op_sel_hi:[1,1,1] neg_lo:[1,0,0] neg_hi:[1,0,0]
    v_pk_fma_f32 v[130:131], v[26:27], v[154:155], v[130:131] op_sel:[1,0,0] op_sel_hi:[1,1,1] neg_lo:[1,0,0] neg_hi:[1,0,0]
    v_pk_fma_f32 v[84:85], v[26:27], v[144:145], v[84:85] op_sel:[1,0,0] op_sel_hi:[1,1,1] neg_lo:[1,0,0] neg_hi:[1,0,0]
    v_pk_fma_f32 v[132:133], v[26:27], v[156:157], v[132:133] op_sel:[1,0,0] op_sel_hi:[1,1,1] neg_lo:[1,0,0] neg_hi:[1,0,0]
    v_pk_fma_f32 v[86:87], v[26:27], v[146:147], v[86:87] op_sel:[1,0,0] op_sel_hi:[1,1,1] neg_lo:[1,0,0] neg_hi:[1,0,0]
    v_pk_fma_f32 v[134:135], v[26:27], v[158:159], v[134:135] op_sel:[1,0,0] op_sel_hi:[1,1,1] neg_lo:[1,0,0] neg_hi:[1,0,0]
    v_max_f32 v76, 0, v76
    v_max_f32 v77, 0, v77
    v_pk_mul_f32 v[124:125], v[124:125], v[34:35] op_sel:[0,1] op_sel_hi:[1,1]
    v_max_f32 v78, 0, v78
    v_max_f32 v79, 0, v79
    v_pk_mul_f32 v[126:127], v[126:127], v[34:35] op_sel:[0,1] op_sel_hi:[1,1]
    v_max_f32 v80, 0, v80
    v_max_f32 v81, 0, v81
    v_pk_mul_f32 v[128:129], v[128:129], v[34:35] op_sel:[0,1] op_sel_hi:[1,1]
    v_max_f32 v82, 0, v82
    v_max_f32 v83, 0, v83
    v_pk_mul_f32 v[130:131], v[130:131], v[34:35] op_sel:[0,1] op_sel_hi:[1,1]
    v_max_f32 v84, 0, v84
    v_max_f32 v85, 0, v85
    v_pk_mul_f32 v[132:133], v[132:133], v[34:35] op_sel:[0,1] op_sel_hi:[1,1]
    v_max_f32 v86, 0, v86
    v_max_f32 v87, 0, v87
    v_pk_mul_f32 v[134:135], v[134:135], v[34:35] op_sel:[0,1] op_sel_hi:[1,1]
    v_pk_mul_f32 v[76:77], v[76:77], v[124:125] op_sel:[0,0] op_sel_hi:[1,1]
    v_pk_mul_f32 v[78:79], v[78:79], v[126:127] op_sel:[0,0] op_sel_hi:[1,1]
    v_pk_mul_f32 v[80:81], v[80:81], v[128:129] op_sel:[0,0] op_sel_hi:[1,1]
    v_pk_mul_f32 v[82:83], v[82:83], v[130:131] op_sel:[0,0] op_sel_hi:[1,1]
    v_pk_mul_f32 v[84:85], v[84:85], v[132:133] op_sel:[0,0] op_sel_hi:[1,1]
    v_pk_mul_f32 v[86:87], v[86:87], v[134:135] op_sel:[0,0] op_sel_hi:[1,1]
    v_cvt_pk_bf16_f32 v184, v76, v77
    v_cvt_pk_bf16_f32 v185, v78, v79
    v_cvt_pk_bf16_f32 v186, v80, v81
    v_cvt_pk_bf16_f32 v187, v82, v83
    v_cvt_pk_bf16_f32 v188, v84, v85
    v_cvt_pk_bf16_f32 v189, v86, v87
    buffer_store_dwordx4 v[184:187], v4, s[44:47], s7 offen
    buffer_store_dwordx2 v[188:189], v4, s[44:47], s8 offen
    s_mov_b32 exec_lo, 0x00010001
    s_mov_b32 exec_hi, 0x00010001
    ds_write_b128 v16, v[136:139] offset:0
    ds_write_b128 v16, v[140:143] offset:64
    ds_write_b128 v16, v[144:147] offset:128
    ds_write_b128 v16, v[148:151] offset:192
    ds_write_b128 v16, v[152:155] offset:256
    ds_write_b128 v16, v[156:159] offset:320
    s_mov_b64 exec, -1
    s_waitcnt lgkmcnt(0)
    s_waitcnt vmcnt(0)
    s_barrier
    s_lshr_b32 s13, s61, 3
    s_lshl_b32 s12, s60, 1
    s_add_u32 s12, s12, s13
    s_and_b32 s13, s61, 7
    s_mul_i32 s14, s13, 5
    s_lshr_b32 s10, s3, 1
    s_and_b32 s11, s3, 1
    s_lshl_b32 s15, s12, 2
    s_lshl_b32 s5, s10, 1
    s_add_u32 s15, s15, s5
    v_lshlrev_b32 v16, 4, v1
    s_lshl_b32 s6, s15, 4
    s_lshl_b32 s5, s13, 1
    s_add_u32 s6, s6, s5
    s_add_u32 s6, s6, s11
    s_lshl_b32 s6, s6, 10
    s_add_u32 s7, s6, 4194304
    s_add_u32 s6, s6, 4194304
    s_lshl_b32 s8, s15, 14
    s_lshl_b32 s5, s13, 7
    s_add_u32 s8, s8, s5
    s_lshl_b32 s5, s11, 6
    s_add_u32 s8, s8, s5
    s_add_u32 s5, s7, 16384
    buffer_load_dwordx4 v[24:27], v16, s[44:47], s7 offen
    buffer_load_dwordx4 v[28:31], v16, s[44:47], s5 offen
    s_lshl_b32 s4, s10, 11
    s_add_u32 s4, s4, 98304
    v_lshl_add_u32 v8, v1, 4, s4
    v_and_b32 v4, 1, v2
    v_lshlrev_b32 v4, 5, v4
    v_lshl_add_u32 v4, v2, 8, v4
    v_bfe_u32 v5, v1, 2, 2
    v_lshl_add_u32 v4, v5, 6, v4
    v_and_b32 v5, 3, v1
    v_lshl_add_u32 v9, v5, 3, v4
    v_xor_b32 v10, 32, v9
    s_lshl_b32 s4, s11, 11
    v_add_u32 v9, s4, v9
    v_add_u32 v10, s4, v10
    v_mov_b32 v128, 0x3f803f80
    v_mov_b32 v129, 0x3f803f80
    v_mov_b32 v130, 0x3f803f80
    v_mov_b32 v131, 0x3f803f80
    s_waitcnt vmcnt(1)
    v_lshlrev_b32 v32, 16, v24
    v_and_b32 v33, 0xffff0000, v24
    v_lshlrev_b32 v34, 16, v25
    v_and_b32 v35, 0xffff0000, v25
    v_lshlrev_b32 v36, 16, v26
    v_and_b32 v37, 0xffff0000, v26
    v_lshlrev_b32 v38, 16, v27
    v_and_b32 v39, 0xffff0000, v27
    s_waitcnt vmcnt(0)
    v_lshlrev_b32 v40, 16, v28
    v_and_b32 v41, 0xffff0000, v28
    v_lshlrev_b32 v42, 16, v29
    v_and_b32 v43, 0xffff0000, v29
    v_lshlrev_b32 v44, 16, v30
    v_and_b32 v45, 0xffff0000, v30
    v_lshlrev_b32 v46, 16, v31
    v_and_b32 v47, 0xffff0000, v31
    s_mov_b32 s58, 0
    s_mov_b32 s59, 81920
    s_mov_b32 s9, 0
    v_mov_b32 v11, v8
    v_add_u32 v12, s59, v9
    v_add_u32 v13, s59, v10
    s_barrier
    ds_read_b128 v[48:51], v11 offset:0
    ds_read_b64_tr_b16 v[64:65], v12 offset:0
    ds_read_b64_tr_b16 v[66:67], v12 offset:1024
    ds_read_b128 v[52:55], v11 offset:1024
    ds_read_b64_tr_b16 v[68:69], v13 offset:0
    ds_read_b64_tr_b16 v[70:71], v13 offset:1024
    ds_read_b128 v[56:59], v11 offset:4096
    ds_read_b64_tr_b16 v[72:73], v12 offset:4096
    ds_read_b64_tr_b16 v[74:75], v12 offset:5120
    ds_read_b128 v[60:63], v11 offset:5120
    ds_read_b64_tr_b16 v[76:77], v13 offset:4096
    ds_read_b64_tr_b16 v[78:79], v13 offset:5120
L_ml_s4l0:
    s_barrier
    s_waitcnt lgkmcnt(9)
    v_mfma_f32_16x16x32_bf16 v[32:35], v[64:67], v[48:51], v[32:35]
    ds_read_b128 v[80:83], v11 offset:8192
    ds_read_b64_tr_b16 v[96:97], v12 offset:8192
    s_waitcnt lgkmcnt(10)
    v_mfma_f32_16x16x32_bf16 v[40:43], v[64:67], v[52:55], v[40:43]
    ds_read_b64_tr_b16 v[98:99], v12 offset:9216
    ds_read_b128 v[84:87], v11 offset:9216
    s_waitcnt lgkmcnt(10)
    v_mfma_f32_16x16x32_bf16 v[36:39], v[68:71], v[48:51], v[36:39]
    ds_read_b64_tr_b16 v[100:101], v13 offset:8192
    ds_read_b64_tr_b16 v[102:103], v13 offset:9216
    v_mfma_f32_16x16x32_bf16 v[44:47], v[68:71], v[52:55], v[44:47]
    ds_read_b128 v[88:91], v11 offset:12288
    ds_read_b64_tr_b16 v[104:105], v12 offset:12288
    s_waitcnt lgkmcnt(11)
    v_mfma_f32_16x16x32_bf16 v[32:35], v[72:75], v[56:59], v[32:35]
    ds_read_b64_tr_b16 v[106:107], v12 offset:13312
    ds_read_b128 v[92:95], v11 offset:13312
    s_waitcnt lgkmcnt(12)
    v_mfma_f32_16x16x32_bf16 v[40:43], v[72:75], v[60:63], v[40:43]
    ds_read_b64_tr_b16 v[108:109], v13 offset:12288
    ds_read_b64_tr_b16 v[110:111], v13 offset:13312
    s_waitcnt lgkmcnt(12)
    v_mfma_f32_16x16x32_bf16 v[36:39], v[76:79], v[56:59], v[36:39]
    s_add_u32 s58, s58, 16384
    s_cmp_eq_u32 s58, 49152
    s_cselect_b32 s58, 0, s58
    s_add_u32 s59, s59, 16384
    s_cmp_eq_u32 s59, 98304
    v_mfma_f32_16x16x32_bf16 v[44:47], v[76:79], v[60:63], v[44:47]
    s_cselect_b32 s59, 0, s59
    v_add_u32 v11, s58, v8
    v_add_u32 v12, s59, v9
    v_add_u32 v13, s59, v10
    s_barrier
    s_waitcnt lgkmcnt(9)
    v_mfma_f32_16x16x32_bf16 v[32:35], v[96:99], v[80:83], v[32:35]
    ds_read_b128 v[48:51], v11 offset:0
    ds_read_b64_tr_b16 v[64:65], v12 offset:0
    s_waitcnt lgkmcnt(10)
    v_mfma_f32_16x16x32_bf16 v[40:43], v[96:99], v[84:87], v[40:43]
    ds_read_b64_tr_b16 v[66:67], v12 offset:1024
    ds_read_b128 v[52:55], v11 offset:1024
    s_waitcnt lgkmcnt(10)
    v_mfma_f32_16x16x32_bf16 v[36:39], v[100:103], v[80:83], v[36:39]
    ds_read_b64_tr_b16 v[68:69], v13 offset:0
    ds_read_b64_tr_b16 v[70:71], v13 offset:1024
    v_mfma_f32_16x16x32_bf16 v[44:47], v[100:103], v[84:87], v[44:47]
    ds_read_b128 v[56:59], v11 offset:4096
    ds_read_b64_tr_b16 v[72:73], v12 offset:4096
    s_waitcnt lgkmcnt(11)
    v_mfma_f32_16x16x32_bf16 v[32:35], v[104:107], v[88:91], v[32:35]
    ds_read_b64_tr_b16 v[74:75], v12 offset:5120
    ds_read_b128 v[60:63], v11 offset:5120
    s_waitcnt lgkmcnt(12)
    v_mfma_f32_16x16x32_bf16 v[40:43], v[104:107], v[92:95], v[40:43]
    ds_read_b64_tr_b16 v[76:77], v13 offset:4096
    ds_read_b64_tr_b16 v[78:79], v13 offset:5120
    s_waitcnt lgkmcnt(12)
    v_mfma_f32_16x16x32_bf16 v[36:39], v[108:111], v[88:91], v[36:39]
    s_add_u32 s9, s9, 1
    v_mfma_f32_16x16x32_bf16 v[44:47], v[108:111], v[92:95], v[44:47]
    s_cmp_lt_u32 s9, 11
    s_cbranch_scc1 L_ml_s4l0
    s_waitcnt lgkmcnt(0)
    v_cvt_pk_bf16_f32 v24, v32, v33
    v_cvt_pk_bf16_f32 v25, v34, v35
    s_nop 0
    v_cvt_pk_bf16_f32 v26, v36, v37
    v_cvt_pk_bf16_f32 v27, v38, v39
    v_cvt_pk_bf16_f32 v28, v40, v41
    v_cvt_pk_bf16_f32 v29, v42, v43
    v_cvt_pk_bf16_f32 v30, v44, v45
    v_cvt_pk_bf16_f32 v31, v46, v47
    v_mfma_f32_16x16x32_bf16 v[112:115], v[128:131], v[24:27], 0
    v_mfma_f32_16x16x32_bf16 v[116:119], v[24:27], v[24:27], 0
    v_mfma_f32_16x16x32_bf16 v[120:123], v[128:131], v[28:31], 0
    v_mfma_f32_16x16x32_bf16 v[124:127], v[28:31], v[28:31], 0
    s_add_u32 s5, s6, 16384
    buffer_store_dwordx4 v[24:27], v16, s[44:47], s6 offen
    buffer_store_dwordx4 v[28:31], v16, s[44:47], s5 offen
    s_lshl_b32 s4, s15, 10
    s_lshl_b32 s5, s13, 3
    s_add_u32 s4, s4, s5
    s_lshl_b32 s5, s11, 17
    s_add_u32 s4, s4, s5
    s_add_u32 s4, s4, 23592960
    v_lshlrev_b32 v5, 6, v3
    v_and_b32 v6, 3, v3
    v_cmp_eq_u32 s[52:53], 1, v6
    v_cmp_eq_u32 s[54:55], 2, v6
    v_cmp_eq_u32 s[56:57], 3, v6
    v_lshrrev_b32 v6, 2, v3
    v_cmp_eq_u32 vcc, v6, v2
    v_cndmask_b32 v113, v116, v117, s[52:53]
    v_cndmask_b32 v113, v113, v118, s[54:55]
    v_cndmask_b32 v113, v113, v119, s[56:57]
    v_cndmask_b32 v121, v124, v125, s[52:53]
    v_cndmask_b32 v121, v121, v126, s[54:55]
    v_cndmask_b32 v121, v121, v127, s[56:57]
    s_mov_b64 exec, vcc
    buffer_store_dwordx2 v[112:113], v5, s[44:47], s4 offen offset:0
    buffer_store_dwordx2 v[120:121], v5, s[44:47], s4 offen offset:1024
    s_mov_b64 exec, -1
    s_waitcnt vmcnt(0)
    s_barrier
    s_mov_b32 s12, s60
    s_mov_b32 s13, s61
    s_mov_b32 s14, s61
    s_lshl_b32 s4, s3, 11
    s_add_u32 s4, s4, 98304
    v_lshl_add_u32 v8, v1, 4, s4
    v_and_b32 v4, 1, v2
    v_lshlrev_b32 v4, 5, v4
    v_lshl_add_u32 v4, v2, 8, v4
    v_bfe_u32 v5, v1, 2, 2
    v_lshl_add_u32 v4, v5, 6, v4
    v_and_b32 v5, 3, v1
    v_lshl_add_u32 v9, v5, 3, v4
    v_xor_b32 v10, 32, v9
    v_add_u32 v11, 49152, v9
    v_add_u32 v12, 49152, v10
    s_lshl_b32 s10, s13, 11
    s_add_u32 s10, s10, 23134208
    s_lshl_b32 s6, s3, 9
    s_add_u32 s5, s10, s6
    v_lshl_add_u32 v17, v1, 2, s5
    s_lshl_b32 s11, s13, 7
    s_add_u32 s11, s11, 23166976
    v_lshl_add_u32 v18, v1, 2, s11
    v_lshlrev_b32 v14, 4, v2
    v_add_u32 v14, 157696, v14
    v_lshlrev_b32 v15, 2, v3
    v_add_u32 v15, 157696, v15
    s_lshl_b32 s7, s12, 3
    s_lshl_b32 s5, s3, 1
    s_add_u32 s7, s7, s5
    s_mul_i32 s7, s7, 43
    s_add_u32 s7, s7, s13
    s_lshl_b32 s7, s7, 10
    s_add_u32 s7, s7, 8388608
    v_mov_b32 v24, 0x3f803f80
    v_mov_b32 v25, 0x3f803f80
    v_mov_b32 v26, 0x3f803f80
    v_mov_b32 v27, 0x3f803f80
    s_barrier
    ds_read_b128 v[128:131], v8 offset:0
    ds_read_b64_tr_b16 v[64:65], v11 offset:16384
    ds_read_b64_tr_b16 v[66:67], v11 offset:17408
    ds_read_b128 v[132:135], v8 offset:1024
    ds_read_b64_tr_b16 v[68:69], v12 offset:16384
    ds_read_b64_tr_b16 v[70:71], v12 offset:17408
    ds_read_b64_tr_b16 v[72:73], v11 offset:18432
    ds_read_b64_tr_b16 v[74:75], v11 offset:19456
    ds_read_b64_tr_b16 v[76:77], v12 offset:18432
    ds_read_b64_tr_b16 v[78:79], v12 offset:19456
    s_waitcnt lgkmcnt(7)
    v_mfma_f32_16x16x32_bf16 v[32:35], v[128:131], v[64:67], 0
    ds_read_b128 v[136:139], v8 offset:8192
    ds_read_b64_tr_b16 v[80:81], v11 offset:20480
    s_waitcnt lgkmcnt(8)
    v_mfma_f32_16x16x32_bf16 v[36:39], v[132:135], v[64:67], 0
    ds_read_b64_tr_b16 v[82:83], v11 offset:21504
    ds_read_b128 v[140:143], v8 offset:9216
    s_waitcnt lgkmcnt(8)
    v_mfma_f32_16x16x32_bf16 v[40:43], v[128:131], v[68:71], 0
    ds_read_b64_tr_b16 v[84:85], v12 offset:20480
    ds_read_b64_tr_b16 v[86:87], v12 offset:21504
    v_mfma_f32_16x16x32_bf16 v[44:47], v[132:135], v[68:71], 0
    ds_read_b64_tr_b16 v[88:89], v11 offset:22528
    ds_read_b64_tr_b16 v[90:91], v11 offset:23552
    s_waitcnt lgkmcnt(10)
    v_mfma_f32_16x16x32_bf16 v[48:51], v[128:131], v[72:75], 0
    ds_read_b64_tr_b16 v[92:93], v12 offset:22528
    ds_read_b64_tr_b16 v[94:95], v12 offset:23552
    v_mfma_f32_16x16x32_bf16 v[52:55], v[132:135], v[72:75], 0
    s_waitcnt lgkmcnt(10)
    v_mfma_f32_16x16x32_bf16 v[56:59], v[128:131], v[76:79], 0
    v_mfma_f32_16x16x32_bf16 v[60:63], v[132:135], v[76:79], 0
    s_waitcnt lgkmcnt(0)
    s_barrier
    v_mfma_f32_16x16x32_bf16 v[32:35], v[136:139], v[80:83], v[32:35]
    ds_read_b128 v[144:147], v8 offset:16384
    ds_read_b64_tr_b16 v[64:65], v11 offset:24576
    v_mfma_f32_16x16x32_bf16 v[36:39], v[140:143], v[80:83], v[36:39]
    ds_read_b64_tr_b16 v[66:67], v11 offset:25600
    ds_read_b128 v[148:151], v8 offset:17408
    v_mfma_f32_16x16x32_bf16 v[40:43], v[136:139], v[84:87], v[40:43]
    ds_read_b64_tr_b16 v[68:69], v12 offset:24576
    ds_read_b64_tr_b16 v[70:71], v12 offset:25600
    v_mfma_f32_16x16x32_bf16 v[44:47], v[140:143], v[84:87], v[44:47]
    ds_read_b64_tr_b16 v[72:73], v11 offset:26624
    ds_read_b64_tr_b16 v[74:75], v11 offset:27648
    v_mfma_f32_16x16x32_bf16 v[48:51], v[136:139], v[88:91], v[48:51]
    ds_read_b64_tr_b16 v[76:77], v12 offset:26624
    ds_read_b64_tr_b16 v[78:79], v12 offset:27648
    v_mfma_f32_16x16x32_bf16 v[52:55], v[140:143], v[88:91], v[52:55]
    v_mfma_f32_16x16x32_bf16 v[56:59], v[136:139], v[92:95], v[56:59]
    v_mfma_f32_16x16x32_bf16 v[60:63], v[140:143], v[92:95], v[60:63]
    s_waitcnt lgkmcnt(7)
    v_mfma_f32_16x16x32_bf16 v[32:35], v[144:147], v[64:67], v[32:35]
    ds_read_b128 v[152:155], v8 offset:24576
    ds_read_b64_tr_b16 v[80:81], v11 offset:28672
    s_waitcnt lgkmcnt(8)
    v_mfma_f32_16x16x32_bf16 v[36:39], v[148:151], v[64:67], v[36:39]
    ds_read_b64_tr_b16 v[82:83], v11 offset:29696
    ds_read_b128 v[156:159], v8 offset:25600
    s_waitcnt lgkmcnt(8)
    v_mfma_f32_16x16x32_bf16 v[40:43], v[144:147], v[68:71], v[40:43]
    ds_read_b64_tr_b16 v[84:85], v12 offset:28672
    ds_read_b64_tr_b16 v[86:87], v12 offset:29696
    v_mfma_f32_16x16x32_bf16 v[44:47], v[148:151], v[68:71], v[44:47]
    ds_read_b64_tr_b16 v[88:89], v11 offset:30720
    ds_read_b64_tr_b16 v[90:91], v11 offset:31744
    s_waitcnt lgkmcnt(10)
    v_mfma_f32_16x16x32_bf16 v[48:51], v[144:147], v[72:75], v[48:51]
    ds_read_b64_tr_b16 v[92:93], v12 offset:30720
    ds_read_b64_tr_b16 v[94:95], v12 offset:31744
    v_mfma_f32_16x16x32_bf16 v[52:55], v[148:151], v[72:75], v[52:55]
    s_waitcnt lgkmcnt(10)
    v_mfma_f32_16x16x32_bf16 v[56:59], v[144:147], v[76:79], v[56:59]
    v_mfma_f32_16x16x32_bf16 v[60:63], v[148:151], v[76:79], v[60:63]
    s_waitcnt lgkmcnt(0)
    s_barrier
    v_mfma_f32_16x16x32_bf16 v[32:35], v[152:155], v[80:83], v[32:35]
    ds_read_b128 v[160:163], v8 offset:32768
    ds_read_b64_tr_b16 v[64:65], v11 offset:32768
    v_mfma_f32_16x16x32_bf16 v[36:39], v[156:159], v[80:83], v[36:39]
    ds_read_b64_tr_b16 v[66:67], v11 offset:33792
    ds_read_b128 v[164:167], v8 offset:33792
    v_mfma_f32_16x16x32_bf16 v[40:43], v[152:155], v[84:87], v[40:43]
    ds_read_b64_tr_b16 v[68:69], v12 offset:32768
    ds_read_b64_tr_b16 v[70:71], v12 offset:33792
    v_mfma_f32_16x16x32_bf16 v[44:47], v[156:159], v[84:87], v[44:47]
    ds_read_b64_tr_b16 v[72:73], v11 offset:34816
    ds_read_b64_tr_b16 v[74:75], v11 offset:35840
    v_mfma_f32_16x16x32_bf16 v[48:51], v[152:155], v[88:91], v[48:51]
    ds_read_b64_tr_b16 v[76:77], v12 offset:34816
    ds_read_b64_tr_b16 v[78:79], v12 offset:35840
    v_mfma_f32_16x16x32_bf16 v[52:55], v[156:159], v[88:91], v[52:55]
    v_mfma_f32_16x16x32_bf16 v[56:59], v[152:155], v[92:95], v[56:59]
    v_mfma_f32_16x16x32_bf16 v[60:63], v[156:159], v[92:95], v[60:63]
    s_waitcnt lgkmcnt(7)
    v_mfma_f32_16x16x32_bf16 v[32:35], v[160:163], v[64:67], v[32:35]
    ds_read_b128 v[168:171], v8 offset:40960
    ds_read_b64_tr_b16 v[80:81], v11 offset:36864
    s_waitcnt lgkmcnt(8)
    v_mfma_f32_16x16x32_bf16 v[36:39], v[164:167], v[64:67], v[36:39]
    ds_read_b64_tr_b16 v[82:83], v11 offset:37888
    ds_read_b128 v[172:175], v8 offset:41984
    s_waitcnt lgkmcnt(8)
    v_mfma_f32_16x16x32_bf16 v[40:43], v[160:163], v[68:71], v[40:43]
    ds_read_b64_tr_b16 v[84:85], v12 offset:36864
    ds_read_b64_tr_b16 v[86:87], v12 offset:37888
    v_mfma_f32_16x16x32_bf16 v[44:47], v[164:167], v[68:71], v[44:47]
    ds_read_b64_tr_b16 v[88:89], v11 offset:38912
    ds_read_b64_tr_b16 v[90:91], v11 offset:39936
    s_waitcnt lgkmcnt(10)
    v_mfma_f32_16x16x32_bf16 v[48:51], v[160:163], v[72:75], v[48:51]
    ds_read_b64_tr_b16 v[92:93], v12 offset:38912
    ds_read_b64_tr_b16 v[94:95], v12 offset:39936
    v_mfma_f32_16x16x32_bf16 v[52:55], v[164:167], v[72:75], v[52:55]
    s_waitcnt lgkmcnt(10)
    v_mfma_f32_16x16x32_bf16 v[56:59], v[160:163], v[76:79], v[56:59]
    v_mfma_f32_16x16x32_bf16 v[60:63], v[164:167], v[76:79], v[60:63]
    s_waitcnt lgkmcnt(0)
    s_barrier
    v_mfma_f32_16x16x32_bf16 v[32:35], v[168:171], v[80:83], v[32:35]
    ds_read_b128 v[176:179], v8 offset:0
    ds_read_b64_tr_b16 v[64:65], v11 offset:40960
    v_mfma_f32_16x16x32_bf16 v[36:39], v[172:175], v[80:83], v[36:39]
    ds_read_b64_tr_b16 v[66:67], v11 offset:41984
    ds_read_b128 v[180:183], v8 offset:1024
    v_mfma_f32_16x16x32_bf16 v[40:43], v[168:171], v[84:87], v[40:43]
    ds_read_b64_tr_b16 v[68:69], v12 offset:40960
    ds_read_b64_tr_b16 v[70:71], v12 offset:41984
    v_mfma_f32_16x16x32_bf16 v[44:47], v[172:175], v[84:87], v[44:47]
    ds_read_b64_tr_b16 v[72:73], v11 offset:43008
    ds_read_b64_tr_b16 v[74:75], v11 offset:44032
    v_mfma_f32_16x16x32_bf16 v[48:51], v[168:171], v[88:91], v[48:51]
    ds_read_b64_tr_b16 v[76:77], v12 offset:43008
    ds_read_b64_tr_b16 v[78:79], v12 offset:44032
    v_mfma_f32_16x16x32_bf16 v[52:55], v[172:175], v[88:91], v[52:55]
    v_mfma_f32_16x16x32_bf16 v[56:59], v[168:171], v[92:95], v[56:59]
    v_mfma_f32_16x16x32_bf16 v[60:63], v[172:175], v[92:95], v[60:63]
    s_waitcnt lgkmcnt(7)
    v_mfma_f32_16x16x32_bf16 v[32:35], v[176:179], v[64:67], v[32:35]
    ds_read_b128 v[184:187], v8 offset:8192
    ds_read_b64_tr_b16 v[80:81], v11 offset:45056
    s_waitcnt lgkmcnt(8)
    v_mfma_f32_16x16x32_bf16 v[36:39], v[180:183], v[64:67], v[36:39]
    ds_read_b64_tr_b16 v[82:83], v11 offset:46080
    ds_read_b128 v[188:191], v8 offset:9216
    s_waitcnt lgkmcnt(8)
    v_mfma_f32_16x16x32_bf16 v[40:43], v[176:179], v[68:71], v[40:43]
    ds_read_b64_tr_b16 v[84:85], v12 offset:45056
    ds_read_b64_tr_b16 v[86:87], v12 offset:46080
    v_mfma_f32_16x16x32_bf16 v[44:47], v[180:183], v[68:71], v[44:47]
    ds_read_b64_tr_b16 v[88:89], v11 offset:47104
    ds_read_b64_tr_b16 v[90:91], v11 offset:48128
    s_waitcnt lgkmcnt(10)
    v_mfma_f32_16x16x32_bf16 v[48:51], v[176:179], v[72:75], v[48:51]
    ds_read_b64_tr_b16 v[92:93], v12 offset:47104
    ds_read_b64_tr_b16 v[94:95], v12 offset:48128
    v_mfma_f32_16x16x32_bf16 v[52:55], v[180:183], v[72:75], v[52:55]
    s_waitcnt lgkmcnt(10)
    v_mfma_f32_16x16x32_bf16 v[56:59], v[176:179], v[76:79], v[56:59]
    v_mfma_f32_16x16x32_bf16 v[60:63], v[180:183], v[76:79], v[60:63]
    s_waitcnt lgkmcnt(0)
    s_barrier
    v_mfma_f32_16x16x32_bf16 v[32:35], v[184:187], v[80:83], v[32:35]
    ds_read_b128 v[192:195], v8 offset:16384
    ds_read_b64_tr_b16 v[64:65], v9 offset:0
    v_mfma_f32_16x16x32_bf16 v[36:39], v[188:191], v[80:83], v[36:39]
    ds_read_b64_tr_b16 v[66:67], v9 offset:1024
    ds_read_b128 v[196:199], v8 offset:17408
    v_mfma_f32_16x16x32_bf16 v[40:43], v[184:187], v[84:87], v[40:43]
    ds_read_b64_tr_b16 v[68:69], v10 offset:0
    ds_read_b64_tr_b16 v[70:71], v10 offset:1024
    v_mfma_f32_16x16x32_bf16 v[44:47], v[188:191], v[84:87], v[44:47]
    ds_read_b64_tr_b16 v[72:73], v9 offset:2048
    ds_read_b64_tr_b16 v[74:75], v9 offset:3072
    v_mfma_f32_16x16x32_bf16 v[48:51], v[184:187], v[88:91], v[48:51]
    ds_read_b64_tr_b16 v[76:77], v10 offset:2048
    ds_read_b64_tr_b16 v[78:79], v10 offset:3072
    v_mfma_f32_16x16x32_bf16 v[52:55], v[188:191], v[88:91], v[52:55]
    v_mfma_f32_16x16x32_bf16 v[56:59], v[184:187], v[92:95], v[56:59]
    v_mfma_f32_16x16x32_bf16 v[60:63], v[188:191], v[92:95], v[60:63]
    s_waitcnt lgkmcnt(7)
    v_mfma_f32_16x16x32_bf16 v[32:35], v[192:195], v[64:67], v[32:35]
    ds_read_b128 v[200:203], v8 offset:24576
    ds_read_b64_tr_b16 v[80:81], v9 offset:4096
    s_waitcnt lgkmcnt(8)
    v_mfma_f32_16x16x32_bf16 v[36:39], v[196:199], v[64:67], v[36:39]
    ds_read_b64_tr_b16 v[82:83], v9 offset:5120
    ds_read_b128 v[204:207], v8 offset:25600
    s_waitcnt lgkmcnt(8)
    v_mfma_f32_16x16x32_bf16 v[40:43], v[192:195], v[68:71], v[40:43]
    ds_read_b64_tr_b16 v[84:85], v10 offset:4096
    ds_read_b64_tr_b16 v[86:87], v10 offset:5120
    v_mfma_f32_16x16x32_bf16 v[44:47], v[196:199], v[68:71], v[44:47]
    ds_read_b64_tr_b16 v[88:89], v9 offset:6144
    ds_read_b64_tr_b16 v[90:91], v9 offset:7168
    s_waitcnt lgkmcnt(10)
    v_mfma_f32_16x16x32_bf16 v[48:51], v[192:195], v[72:75], v[48:51]
    ds_read_b64_tr_b16 v[92:93], v10 offset:6144
    ds_read_b64_tr_b16 v[94:95], v10 offset:7168
    v_mfma_f32_16x16x32_bf16 v[52:55], v[196:199], v[72:75], v[52:55]
    s_waitcnt lgkmcnt(10)
    v_mfma_f32_16x16x32_bf16 v[56:59], v[192:195], v[76:79], v[56:59]
    v_mfma_f32_16x16x32_bf16 v[60:63], v[196:199], v[76:79], v[60:63]
    s_waitcnt lgkmcnt(0)
    s_barrier
    v_mfma_f32_16x16x32_bf16 v[32:35], v[200:203], v[80:83], v[32:35]
    ds_read_b128 v[208:211], v8 offset:32768
    ds_read_b64_tr_b16 v[64:65], v9 offset:8192
    v_mfma_f32_16x16x32_bf16 v[36:39], v[204:207], v[80:83], v[36:39]
    ds_read_b64_tr_b16 v[66:67], v9 offset:9216
    ds_read_b128 v[212:215], v8 offset:33792
    v_mfma_f32_16x16x32_bf16 v[40:43], v[200:203], v[84:87], v[40:43]
    ds_read_b64_tr_b16 v[68:69], v10 offset:8192
    ds_read_b64_tr_b16 v[70:71], v10 offset:9216
    v_mfma_f32_16x16x32_bf16 v[44:47], v[204:207], v[84:87], v[44:47]
    ds_read_b64_tr_b16 v[72:73], v9 offset:10240
    ds_read_b64_tr_b16 v[74:75], v9 offset:11264
    v_mfma_f32_16x16x32_bf16 v[48:51], v[200:203], v[88:91], v[48:51]
    ds_read_b64_tr_b16 v[76:77], v10 offset:10240
    ds_read_b64_tr_b16 v[78:79], v10 offset:11264
    v_mfma_f32_16x16x32_bf16 v[52:55], v[204:207], v[88:91], v[52:55]
    v_mfma_f32_16x16x32_bf16 v[56:59], v[200:203], v[92:95], v[56:59]
    v_mfma_f32_16x16x32_bf16 v[60:63], v[204:207], v[92:95], v[60:63]
    s_waitcnt lgkmcnt(7)
    v_mfma_f32_16x16x32_bf16 v[32:35], v[208:211], v[64:67], v[32:35]
    ds_read_b128 v[216:219], v8 offset:40960
    ds_read_b64_tr_b16 v[80:81], v9 offset:12288
    s_waitcnt lgkmcnt(8)
    v_mfma_f32_16x16x32_bf16 v[36:39], v[212:215], v[64:67], v[36:39]
    ds_read_b64_tr_b16 v[82:83], v9 offset:13312
    ds_read_b128 v[220:223], v8 offset:41984
    s_waitcnt lgkmcnt(8)
    v_mfma_f32_16x16x32_bf16 v[40:43], v[208:211], v[68:71], v[40:43]
    ds_read_b64_tr_b16 v[84:85], v10 offset:12288
    ds_read_b64_tr_b16 v[86:87], v10 offset:13312
    v_mfma_f32_16x16x32_bf16 v[44:47], v[212:215], v[68:71], v[44:47]
    ds_read_b64_tr_b16 v[88:89], v9 offset:14336
    ds_read_b64_tr_b16 v[90:91], v9 offset:15360
    s_waitcnt lgkmcnt(10)
    v_mfma_f32_16x16x32_bf16 v[48:51], v[208:211], v[72:75], v[48:51]
    ds_read_b64_tr_b16 v[92:93], v10 offset:14336
    ds_read_b64_tr_b16 v[94:95], v10 offset:15360
    v_mfma_f32_16x16x32_bf16 v[52:55], v[212:215], v[72:75], v[52:55]
    s_waitcnt lgkmcnt(10)
    v_mfma_f32_16x16x32_bf16 v[56:59], v[208:211], v[76:79], v[56:59]
    v_mfma_f32_16x16x32_bf16 v[60:63], v[212:215], v[76:79], v[60:63]
    s_waitcnt lgkmcnt(0)
    s_barrier
    v_mfma_f32_16x16x32_bf16 v[32:35], v[216:219], v[80:83], v[32:35]
    ds_read_b128 v[224:227], v8 offset:0
    ds_read_b64_tr_b16 v[64:65], v9 offset:16384
    v_mfma_f32_16x16x32_bf16 v[36:39], v[220:223], v[80:83], v[36:39]
    ds_read_b64_tr_b16 v[66:67], v9 offset:17408
    ds_read_b128 v[228:231], v8 offset:1024
    v_mfma_f32_16x16x32_bf16 v[40:43], v[216:219], v[84:87], v[40:43]
    ds_read_b64_tr_b16 v[68:69], v10 offset:16384
    ds_read_b64_tr_b16 v[70:71], v10 offset:17408
    v_mfma_f32_16x16x32_bf16 v[44:47], v[220:223], v[84:87], v[44:47]
    ds_read_b64_tr_b16 v[72:73], v9 offset:18432
    ds_read_b64_tr_b16 v[74:75], v9 offset:19456
    v_mfma_f32_16x16x32_bf16 v[48:51], v[216:219], v[88:91], v[48:51]
    ds_read_b64_tr_b16 v[76:77], v10 offset:18432
    ds_read_b64_tr_b16 v[78:79], v10 offset:19456
    v_mfma_f32_16x16x32_bf16 v[52:55], v[220:223], v[88:91], v[52:55]
    v_mfma_f32_16x16x32_bf16 v[56:59], v[216:219], v[92:95], v[56:59]
    v_mfma_f32_16x16x32_bf16 v[60:63], v[220:223], v[92:95], v[60:63]
    s_waitcnt lgkmcnt(7)
    v_mfma_f32_16x16x32_bf16 v[32:35], v[224:227], v[64:67], v[32:35]
    ds_read_b128 v[232:235], v8 offset:8192
    ds_read_b64_tr_b16 v[80:81], v9 offset:20480
    s_waitcnt lgkmcnt(8)
    v_mfma_f32_16x16x32_bf16 v[36:39], v[228:231], v[64:67], v[36:39]
    ds_read_b64_tr_b16 v[82:83], v9 offset:21504
    ds_read_b128 v[236:239], v8 offset:9216
    s_waitcnt lgkmcnt(8)
    v_mfma_f32_16x16x32_bf16 v[40:43], v[224:227], v[68:71], v[40:43]
    ds_read_b64_tr_b16 v[84:85], v10 offset:20480
    ds_read_b64_tr_b16 v[86:87], v10 offset:21504
    v_mfma_f32_16x16x32_bf16 v[44:47], v[228:231], v[68:71], v[44:47]
    ds_read_b64_tr_b16 v[88:89], v9 offset:22528
    ds_read_b64_tr_b16 v[90:91], v9 offset:23552
    s_waitcnt lgkmcnt(10)
    v_mfma_f32_16x16x32_bf16 v[48:51], v[224:227], v[72:75], v[48:51]
    ds_read_b64_tr_b16 v[92:93], v10 offset:22528
    ds_read_b64_tr_b16 v[94:95], v10 offset:23552
    v_mfma_f32_16x16x32_bf16 v[52:55], v[228:231], v[72:75], v[52:55]
    s_waitcnt lgkmcnt(10)
    v_mfma_f32_16x16x32_bf16 v[56:59], v[224:227], v[76:79], v[56:59]
    v_mfma_f32_16x16x32_bf16 v[60:63], v[228:231], v[76:79], v[60:63]
    s_waitcnt lgkmcnt(0)
    s_barrier
    v_mfma_f32_16x16x32_bf16 v[32:35], v[232:235], v[80:83], v[32:35]
    ds_read_b128 v[240:243], v8 offset:16384
    ds_read_b64_tr_b16 v[64:65], v9 offset:24576
    v_mfma_f32_16x16x32_bf16 v[36:39], v[236:239], v[80:83], v[36:39]
    ds_read_b64_tr_b16 v[66:67], v9 offset:25600
    ds_read_b128 v[244:247], v8 offset:17408
    v_mfma_f32_16x16x32_bf16 v[40:43], v[232:235], v[84:87], v[40:43]
    ds_read_b64_tr_b16 v[68:69], v10 offset:24576
    ds_read_b64_tr_b16 v[70:71], v10 offset:25600
    v_mfma_f32_16x16x32_bf16 v[44:47], v[236:239], v[84:87], v[44:47]
    ds_read_b64_tr_b16 v[72:73], v9 offset:26624
    ds_read_b64_tr_b16 v[74:75], v9 offset:27648
    v_mfma_f32_16x16x32_bf16 v[48:51], v[232:235], v[88:91], v[48:51]
    ds_read_b64_tr_b16 v[76:77], v10 offset:26624
    ds_read_b64_tr_b16 v[78:79], v10 offset:27648
    v_mfma_f32_16x16x32_bf16 v[52:55], v[236:239], v[88:91], v[52:55]
    v_mfma_f32_16x16x32_bf16 v[56:59], v[232:235], v[92:95], v[56:59]
    v_mfma_f32_16x16x32_bf16 v[60:63], v[236:239], v[92:95], v[60:63]
    s_waitcnt lgkmcnt(7)
    v_mfma_f32_16x16x32_bf16 v[32:35], v[240:243], v[64:67], v[32:35]
    ds_read_b128 v[248:251], v8 offset:24576
    ds_read_b64_tr_b16 v[80:81], v9 offset:28672
    s_waitcnt lgkmcnt(8)
    v_mfma_f32_16x16x32_bf16 v[36:39], v[244:247], v[64:67], v[36:39]
    ds_read_b64_tr_b16 v[82:83], v9 offset:29696
    ds_read_b128 v[252:255], v8 offset:25600
    s_waitcnt lgkmcnt(8)
    v_mfma_f32_16x16x32_bf16 v[40:43], v[240:243], v[68:71], v[40:43]
    ds_read_b64_tr_b16 v[84:85], v10 offset:28672
    ds_read_b64_tr_b16 v[86:87], v10 offset:29696
    v_mfma_f32_16x16x32_bf16 v[44:47], v[244:247], v[68:71], v[44:47]
    ds_read_b64_tr_b16 v[88:89], v9 offset:30720
    ds_read_b64_tr_b16 v[90:91], v9 offset:31744
    s_waitcnt lgkmcnt(10)
    v_mfma_f32_16x16x32_bf16 v[48:51], v[240:243], v[72:75], v[48:51]
    ds_read_b64_tr_b16 v[92:93], v10 offset:30720
    ds_read_b64_tr_b16 v[94:95], v10 offset:31744
    v_mfma_f32_16x16x32_bf16 v[52:55], v[244:247], v[72:75], v[52:55]
    s_waitcnt lgkmcnt(10)
    v_mfma_f32_16x16x32_bf16 v[56:59], v[240:243], v[76:79], v[56:59]
    v_mfma_f32_16x16x32_bf16 v[60:63], v[244:247], v[76:79], v[60:63]
    s_waitcnt lgkmcnt(0)
    s_barrier
    v_mfma_f32_16x16x32_bf16 v[32:35], v[248:251], v[80:83], v[32:35]
    v_mfma_f32_16x16x32_bf16 v[36:39], v[252:255], v[80:83], v[36:39]
    v_mfma_f32_16x16x32_bf16 v[40:43], v[248:251], v[84:87], v[40:43]
    v_mfma_f32_16x16x32_bf16 v[44:47], v[252:255], v[84:87], v[44:47]
    v_mfma_f32_16x16x32_bf16 v[48:51], v[248:251], v[88:91], v[48:51]
    v_mfma_f32_16x16x32_bf16 v[52:55], v[252:255], v[88:91], v[52:55]
    v_mfma_f32_16x16x32_bf16 v[56:59], v[248:251], v[92:95], v[56:59]
    v_mfma_f32_16x16x32_bf16 v[60:63], v[252:255], v[92:95], v[60:63]
    s_lshl_b32 s4, s3, 7
    s_add_u32 s4, s4, 156672
    v_lshl_add_u32 v6, v3, 2, s4
    v_lshl_add_u32 v7, v2, 4, s4
    ds_read_b32 v112, v15 offset:128
    ds_read_b32 v120, v15 offset:256
    ds_read_b32 v116, v15 offset:192
    ds_read_b32 v124, v15 offset:320
    ds_read_b128 v[64:67], v7 offset:0
    ds_read_b128 v[72:75], v7 offset:512
    ds_read_b128 v[68:71], v7 offset:64
    ds_read_b128 v[76:79], v7 offset:576
    ds_read_b32 v28, v6 offset:0
    ds_read_b32 v94, v6 offset:512
    ds_read_b32 v29, v6 offset:64
    ds_read_b32 v95, v6 offset:576
    v_mov_b32 v88, 1.0
    v_mov_b32 v89, 0x358637bd
    v_mov_b32 v90, 0x3fb8aa3b
    s_waitcnt lgkmcnt(6)
    v_pk_mul_f32 v[80:81], v[72:73], v[90:91] op_sel:[0,0] op_sel_hi:[1,0]
    v_pk_mul_f32 v[82:83], v[74:75], v[90:91] op_sel:[0,0] op_sel_hi:[1,0]
    s_waitcnt lgkmcnt(4)
    v_pk_mul_f32 v[84:85], v[76:77], v[90:91] op_sel:[0,0] op_sel_hi:[1,0]
    v_pk_mul_f32 v[86:87], v[78:79], v[90:91] op_sel:[0,0] op_sel_hi:[1,0]
    v_pk_fma_f32 v[32:33], v[64:65], v[112:113], v[32:33] op_sel:[0,0,0] op_sel_hi:[1,0,1] neg_lo:[1,0,0] neg_hi:[1,0,0]
    v_pk_fma_f32 v[34:35], v[66:67], v[112:113], v[34:35] op_sel:[0,0,0] op_sel_hi:[1,0,1] neg_lo:[1,0,0] neg_hi:[1,0,0]
    v_pk_fma_f32 v[36:37], v[68:69], v[112:113], v[36:37] op_sel:[0,0,0] op_sel_hi:[1,0,1] neg_lo:[1,0,0] neg_hi:[1,0,0]
    v_pk_fma_f32 v[38:39], v[70:71], v[112:113], v[38:39] op_sel:[0,0,0] op_sel_hi:[1,0,1] neg_lo:[1,0,0] neg_hi:[1,0,0]
    v_pk_fma_f32 v[40:41], v[64:65], v[116:117], v[40:41] op_sel:[0,0,0] op_sel_hi:[1,0,1] neg_lo:[1,0,0] neg_hi:[1,0,0]
    v_pk_fma_f32 v[42:43], v[66:67], v[116:117], v[42:43] op_sel:[0,0,0] op_sel_hi:[1,0,1] neg_lo:[1,0,0] neg_hi:[1,0,0]
    v_pk_fma_f32 v[44:45], v[68:69], v[116:117], v[44:45] op_sel:[0,0,0] op_sel_hi:[1,0,1] neg_lo:[1,0,0] neg_hi:[1,0,0]
    v_pk_fma_f32 v[46:47], v[70:71], v[116:117], v[46:47] op_sel:[0,0,0] op_sel_hi:[1,0,1] neg_lo:[1,0,0] neg_hi:[1,0,0]
    v_pk_mul_f32 v[96:97], v[32:33], v[80:81] op_sel:[0,0] op_sel_hi:[1,1]
    v_pk_mul_f32 v[98:99], v[34:35], v[82:83] op_sel:[0,0] op_sel_hi:[1,1]
    v_pk_mul_f32 v[100:101], v[36:37], v[84:85] op_sel:[0,0] op_sel_hi:[1,1]
    v_pk_mul_f32 v[102:103], v[38:39], v[86:87] op_sel:[0,0] op_sel_hi:[1,1]
    v_pk_mul_f32 v[104:105], v[40:41], v[80:81] op_sel:[0,0] op_sel_hi:[1,1]
    v_pk_mul_f32 v[106:107], v[42:43], v[82:83] op_sel:[0,0] op_sel_hi:[1,1]
    v_pk_mul_f32 v[108:109], v[44:45], v[84:85] op_sel:[0,0] op_sel_hi:[1,1]
    v_pk_mul_f32 v[110:111], v[46:47], v[86:87] op_sel:[0,0] op_sel_hi:[1,1]
    v_exp_f32 v96, v96 clamp
    v_exp_f32 v97, v97 clamp
    v_pk_fma_f32 v[32:33], v[32:33], v[72:73], v[88:89] op_sel:[0,0,0] op_sel_hi:[1,1,0]
    v_exp_f32 v98, v98 clamp
    v_exp_f32 v99, v99 clamp
    v_pk_fma_f32 v[34:35], v[34:35], v[74:75], v[88:89] op_sel:[0,0,0] op_sel_hi:[1,1,0]
    v_exp_f32 v100, v100 clamp
    v_exp_f32 v101, v101 clamp
    v_pk_fma_f32 v[36:37], v[36:37], v[76:77], v[88:89] op_sel:[0,0,0] op_sel_hi:[1,1,0]
    v_exp_f32 v102, v102 clamp
    v_exp_f32 v103, v103 clamp
    v_pk_fma_f32 v[38:39], v[38:39], v[78:79], v[88:89] op_sel:[0,0,0] op_sel_hi:[1,1,0]
    v_exp_f32 v104, v104 clamp
    v_exp_f32 v105, v105 clamp
    v_pk_fma_f32 v[40:41], v[40:41], v[72:73], v[88:89] op_sel:[0,0,0] op_sel_hi:[1,1,0]
    v_exp_f32 v106, v106 clamp
    v_exp_f32 v107, v107 clamp
    v_pk_fma_f32 v[42:43], v[42:43], v[74:75], v[88:89] op_sel:[0,0,0] op_sel_hi:[1,1,0]
    v_exp_f32 v108, v108 clamp
    v_exp_f32 v109, v109 clamp
    v_pk_fma_f32 v[44:45], v[44:45], v[76:77], v[88:89] op_sel:[0,0,0] op_sel_hi:[1,1,0]
    v_exp_f32 v110, v110 clamp
    v_exp_f32 v111, v111 clamp
    v_pk_fma_f32 v[46:47], v[46:47], v[78:79], v[88:89] op_sel:[0,0,0] op_sel_hi:[1,1,0]
    v_max_f32 v32, v32, v96
    v_max_f32 v33, v33, v97
    v_max_f32 v34, v34, v98
    v_max_f32 v35, v35, v99
    v_max_f32 v36, v36, v100
    v_max_f32 v37, v37, v101
    v_max_f32 v38, v38, v102
    v_max_f32 v39, v39, v103
    v_max_f32 v40, v40, v104
    v_max_f32 v41, v41, v105
    v_max_f32 v42, v42, v106
    v_max_f32 v43, v43, v107
    v_max_f32 v44, v44, v108
    v_max_f32 v45, v45, v109
    v_max_f32 v46, v46, v110
    v_max_f32 v47, v47, v111
    v_pk_add_f32 v[32:33], v[32:33], v[88:89] op_sel:[0,1] op_sel_hi:[1,1]
    v_pk_add_f32 v[34:35], v[34:35], v[88:89] op_sel:[0,1] op_sel_hi:[1,1]
    v_pk_add_f32 v[36:37], v[36:37], v[88:89] op_sel:[0,1] op_sel_hi:[1,1]
    v_pk_add_f32 v[38:39], v[38:39], v[88:89] op_sel:[0,1] op_sel_hi:[1,1]
    v_pk_add_f32 v[40:41], v[40:41], v[88:89] op_sel:[0,1] op_sel_hi:[1,1]
    v_pk_add_f32 v[42:43], v[42:43], v[88:89] op_sel:[0,1] op_sel_hi:[1,1]
    v_pk_add_f32 v[44:45], v[44:45], v[88:89] op_sel:[0,1] op_sel_hi:[1,1]
    v_pk_add_f32 v[46:47], v[46:47], v[88:89] op_sel:[0,1] op_sel_hi:[1,1]
    v_cvt_pk_bf16_f32 v32, v32, v33
    v_cvt_pk_bf16_f32 v33, v34, v35
    v_cvt_pk_bf16_f32 v34, v36, v37
    v_cvt_pk_bf16_f32 v35, v38, v39
    v_cvt_pk_bf16_f32 v36, v40, v41
    v_cvt_pk_bf16_f32 v37, v42, v43
    v_cvt_pk_bf16_f32 v38, v44, v45
    v_cvt_pk_bf16_f32 v39, v46, v47
    v_pk_fma_f32 v[48:49], v[64:65], v[120:121], v[48:49] op_sel:[0,0,0] op_sel_hi:[1,0,1] neg_lo:[1,0,0] neg_hi:[1,0,0]
    v_pk_fma_f32 v[50:51], v[66:67], v[120:121], v[50:51] op_sel:[0,0,0] op_sel_hi:[1,0,1] neg_lo:[1,0,0] neg_hi:[1,0,0]
    v_pk_fma_f32 v[52:53], v[68:69], v[120:121], v[52:53] op_sel:[0,0,0] op_sel_hi:[1,0,1] neg_lo:[1,0,0] neg_hi:[1,0,0]
    v_pk_fma_f32 v[54:55], v[70:71], v[120:121], v[54:55] op_sel:[0,0,0] op_sel_hi:[1,0,1] neg_lo:[1,0,0] neg_hi:[1,0,0]
    v_pk_fma_f32 v[56:57], v[64:65], v[124:125], v[56:57] op_sel:[0,0,0] op_sel_hi:[1,0,1] neg_lo:[1,0,0] neg_hi:[1,0,0]
    v_pk_fma_f32 v[58:59], v[66:67], v[124:125], v[58:59] op_sel:[0,0,0] op_sel_hi:[1,0,1] neg_lo:[1,0,0] neg_hi:[1,0,0]
    v_pk_fma_f32 v[60:61], v[68:69], v[124:125], v[60:61] op_sel:[0,0,0] op_sel_hi:[1,0,1] neg_lo:[1,0,0] neg_hi:[1,0,0]
    v_pk_fma_f32 v[62:63], v[70:71], v[124:125], v[62:63] op_sel:[0,0,0] op_sel_hi:[1,0,1] neg_lo:[1,0,0] neg_hi:[1,0,0]
    v_pk_mul_f32 v[48:49], v[48:49], v[72:73] op_sel:[0,0] op_sel_hi:[1,1]
    v_pk_mul_f32 v[50:51], v[50:51], v[74:75] op_sel:[0,0] op_sel_hi:[1,1]
    v_pk_mul_f32 v[52:53], v[52:53], v[76:77] op_sel:[0,0] op_sel_hi:[1,1]
    v_pk_mul_f32 v[54:55], v[54:55], v[78:79] op_sel:[0,0] op_sel_hi:[1,1]
    v_pk_mul_f32 v[56:57], v[56:57], v[72:73] op_sel:[0,0] op_sel_hi:[1,1]
    v_pk_mul_f32 v[58:59], v[58:59], v[74:75] op_sel:[0,0] op_sel_hi:[1,1]
    v_pk_mul_f32 v[60:61], v[60:61], v[76:77] op_sel:[0,0] op_sel_hi:[1,1]
    v_pk_mul_f32 v[62:63], v[62:63], v[78:79] op_sel:[0,0] op_sel_hi:[1,1]
    v_cvt_pk_bf16_f32 v48, v48, v49
    v_cvt_pk_bf16_f32 v49, v50, v51
    v_cvt_pk_bf16_f32 v50, v52, v53
    v_cvt_pk_bf16_f32 v51, v54, v55
    v_cvt_pk_bf16_f32 v52, v56, v57
    v_cvt_pk_bf16_f32 v53, v58, v59
    v_cvt_pk_bf16_f32 v54, v60, v61
    v_cvt_pk_bf16_f32 v55, v62, v63
    v_mfma_f32_16x16x32_bf16 v[96:99], v[32:35], v[48:51], 0
    v_mfma_f32_16x16x32_bf16 v[104:107], v[32:35], v[24:27], 0
    v_mfma_f32_16x16x32_bf16 v[100:103], v[36:39], v[52:55], 0
    v_mfma_f32_16x16x32_bf16 v[108:111], v[36:39], v[24:27], 0
    s_waitcnt lgkmcnt(2)
    v_mul_f32 v92, v90, v94
    s_waitcnt lgkmcnt(0)
    v_mul_f32 v93, v90, v95
    s_lshl_b32 s4, s3, 11
    s_add_u32 s4, s4, 147456
    v_lshl_add_u32 v6, v1, 4, s4
    s_lshl_b32 s4, s3, 7
    s_add_u32 s4, s4, 155648
    v_lshl_add_u32 v7, v2, 4, s4
    ds_write_b128 v6, v[96:99] offset:0
    ds_write_b128 v6, v[100:103] offset:1024
    s_mov_b32 exec_lo, 0x00010001
    s_mov_b32 exec_hi, 0x00010001
    ds_write_b128 v7, v[104:107] offset:0
    ds_write_b128 v7, v[108:111] offset:64
    s_mov_b64 exec, -1
    s_lshl_b32 s4, s3, 9
    s_add_u32 s4, s4, 147456
    v_lshl_add_u32 v6, v1, 2, s4
    v_and_b32 v7, 31, v1
    v_lshlrev_b32 v7, 2, v7
    v_add_u32 v7, 155648, v7
    s_waitcnt lgkmcnt(0)
    s_barrier
    ds_read_b32 v112, v6 offset:0
    ds_read_b32 v113, v6 offset:2048
    ds_read_b32 v114, v6 offset:4096
    ds_read_b32 v115, v6 offset:6144
    ds_read_b32 v116, v6 offset:256
    ds_read_b32 v117, v6 offset:2304
    ds_read_b32 v118, v6 offset:4352
    ds_read_b32 v119, v6 offset:6400
    ds_read_b32 v120, v7 offset:0
    ds_read_b32 v121, v7 offset:128
    ds_read_b32 v122, v7 offset:256
    ds_read_b32 v123, v7 offset:384
    s_waitcnt lgkmcnt(10)
    v_add_f32 v112, v112, v113
    s_waitcnt lgkmcnt(8)
    v_add_f32 v114, v114, v115
    s_waitcnt lgkmcnt(6)
    v_add_f32 v116, v116, v117
    s_waitcnt lgkmcnt(4)
    v_add_f32 v118, v118, v119
    s_waitcnt lgkmcnt(2)
    v_add_f32 v120, v120, v121
    s_waitcnt lgkmcnt(0)
    v_add_f32 v122, v122, v123
    v_add_f32 v112, v112, v114
    v_add_f32 v116, v116, v118
    v_add_f32 v120, v120, v122
    buffer_atomic_add_f32 v112, v17, s[44:47], 0 offen offset:0
    buffer_atomic_add_f32 v116, v17, s[44:47], 0 offen offset:256
    s_cmp_eq_u32 s3, 0
    s_cbranch_scc0 L_nz_s1l1
    s_mov_b32 exec_hi, 0
    buffer_atomic_add_f32 v120, v18, s[44:47], 0 offen
    s_mov_b64 exec, -1
L_nz_s1l1:
    s_waitcnt vmcnt(0)
    s_barrier
    ds_read_b64_tr_b16 v[64:65], v9 offset:32768
    ds_read_b64_tr_b16 v[66:67], v9 offset:33792
    ds_read_b64_tr_b16 v[68:69], v10 offset:32768
    ds_read_b64_tr_b16 v[70:71], v10 offset:33792
    ds_read_b128 v[96:99], v14 offset:0
    ds_read_b128 v[100:103], v14 offset:64
    s_waitcnt lgkmcnt(4)
    v_mfma_f32_16x16x32_bf16 v[32:35], v[64:67], v[128:131], 0
    ds_read_b64_tr_b16 v[72:73], v9 offset:34816
    v_mfma_f32_16x16x32_bf16 v[40:43], v[64:67], v[132:135], 0
    ds_read_b64_tr_b16 v[74:75], v9 offset:35840
    s_waitcnt lgkmcnt(4)
    v_mfma_f32_16x16x32_bf16 v[36:39], v[68:71], v[128:131], 0
    ds_read_b64_tr_b16 v[76:77], v10 offset:34816
    v_mfma_f32_16x16x32_bf16 v[44:47], v[68:71], v[132:135], 0
    ds_read_b64_tr_b16 v[78:79], v10 offset:35840
    s_waitcnt lgkmcnt(2)
    v_mfma_f32_16x16x32_bf16 v[32:35], v[72:75], v[136:139], v[32:35]
    ds_read_b64_tr_b16 v[64:65], v9 offset:36864
    v_mfma_f32_16x16x32_bf16 v[40:43], v[72:75], v[140:143], v[40:43]
    ds_read_b64_tr_b16 v[66:67], v9 offset:37888
    s_waitcnt lgkmcnt(2)
    v_mfma_f32_16x16x32_bf16 v[36:39], v[76:79], v[136:139], v[36:39]
    ds_read_b64_tr_b16 v[68:69], v10 offset:36864
    v_mfma_f32_16x16x32_bf16 v[44:47], v[76:79], v[140:143], v[44:47]
    ds_read_b64_tr_b16 v[70:71], v10 offset:37888
    s_waitcnt lgkmcnt(2)
    v_mfma_f32_16x16x32_bf16 v[32:35], v[64:67], v[144:147], v[32:35]
    ds_read_b64_tr_b16 v[72:73], v9 offset:38912
    v_mfma_f32_16x16x32_bf16 v[40:43], v[64:67], v[148:151], v[40:43]
    ds_read_b64_tr_b16 v[74:75], v9 offset:39936
    s_waitcnt lgkmcnt(2)
    v_mfma_f32_16x16x32_bf16 v[36:39], v[68:71], v[144:147], v[36:39]
    ds_read_b64_tr_b16 v[76:77], v10 offset:38912
    v_mfma_f32_16x16x32_bf16 v[44:47], v[68:71], v[148:151], v[44:47]
    ds_read_b64_tr_b16 v[78:79], v10 offset:39936
    s_waitcnt lgkmcnt(2)
    v_mfma_f32_16x16x32_bf16 v[32:35], v[72:75], v[152:155], v[32:35]
    ds_read_b64_tr_b16 v[64:65], v9 offset:40960
    v_mfma_f32_16x16x32_bf16 v[40:43], v[72:75], v[156:159], v[40:43]
    ds_read_b64_tr_b16 v[66:67], v9 offset:41984
    s_waitcnt lgkmcnt(2)
    v_mfma_f32_16x16x32_bf16 v[36:39], v[76:79], v[152:155], v[36:39]
    ds_read_b64_tr_b16 v[68:69], v10 offset:40960
    v_mfma_f32_16x16x32_bf16 v[44:47], v[76:79], v[156:159], v[44:47]
    ds_read_b64_tr_b16 v[70:71], v10 offset:41984
    s_waitcnt lgkmcnt(2)
    v_mfma_f32_16x16x32_bf16 v[32:35], v[64:67], v[160:163], v[32:35]
    ds_read_b64_tr_b16 v[72:73], v9 offset:43008
    v_mfma_f32_16x16x32_bf16 v[40:43], v[64:67], v[164:167], v[40:43]
    ds_read_b64_tr_b16 v[74:75], v9 offset:44032
    s_waitcnt lgkmcnt(2)
    v_mfma_f32_16x16x32_bf16 v[36:39], v[68:71], v[160:163], v[36:39]
    ds_read_b64_tr_b16 v[76:77], v10 offset:43008
    v_mfma_f32_16x16x32_bf16 v[44:47], v[68:71], v[164:167], v[44:47]
    ds_read_b64_tr_b16 v[78:79], v10 offset:44032
    s_waitcnt lgkmcnt(2)
    v_mfma_f32_16x16x32_bf16 v[32:35], v[72:75], v[168:171], v[32:35]
    ds_read_b64_tr_b16 v[64:65], v9 offset:45056
    v_mfma_f32_16x16x32_bf16 v[40:43], v[72:75], v[172:175], v[40:43]
    ds_read_b64_tr_b16 v[66:67], v9 offset:46080
    s_waitcnt lgkmcnt(2)
    v_mfma_f32_16x16x32_bf16 v[36:39], v[76:79], v[168:171], v[36:39]
    ds_read_b64_tr_b16 v[68:69], v10 offset:45056
    v_mfma_f32_16x16x32_bf16 v[44:47], v[76:79], v[172:175], v[44:47]
    ds_read_b64_tr_b16 v[70:71], v10 offset:46080
    s_waitcnt lgkmcnt(2)
    v_mfma_f32_16x16x32_bf16 v[32:35], v[64:67], v[176:179], v[32:35]
    ds_read_b64_tr_b16 v[72:73], v9 offset:47104
    v_mfma_f32_16x16x32_bf16 v[40:43], v[64:67], v[180:183], v[40:43]
    ds_read_b64_tr_b16 v[74:75], v9 offset:48128
    s_waitcnt lgkmcnt(2)
    v_mfma_f32_16x16x32_bf16 v[36:39], v[68:71], v[176:179], v[36:39]
    ds_read_b64_tr_b16 v[76:77], v10 offset:47104
    v_mfma_f32_16x16x32_bf16 v[44:47], v[68:71], v[180:183], v[44:47]
    ds_read_b64_tr_b16 v[78:79], v10 offset:48128
    s_waitcnt lgkmcnt(2)
    v_mfma_f32_16x16x32_bf16 v[32:35], v[72:75], v[184:187], v[32:35]
    ds_read_b64_tr_b16 v[64:65], v11 offset:0
    v_mfma_f32_16x16x32_bf16 v[40:43], v[72:75], v[188:191], v[40:43]
    ds_read_b64_tr_b16 v[66:67], v11 offset:1024
    s_waitcnt lgkmcnt(2)
    v_mfma_f32_16x16x32_bf16 v[36:39], v[76:79], v[184:187], v[36:39]
    ds_read_b64_tr_b16 v[68:69], v12 offset:0
    v_mfma_f32_16x16x32_bf16 v[44:47], v[76:79], v[188:191], v[44:47]
    ds_read_b64_tr_b16 v[70:71], v12 offset:1024
    s_waitcnt lgkmcnt(2)
    v_mfma_f32_16x16x32_bf16 v[32:35], v[64:67], v[192:195], v[32:35]
    ds_read_b64_tr_b16 v[72:73], v11 offset:2048
    v_mfma_f32_16x16x32_bf16 v[40:43], v[64:67], v[196:199], v[40:43]
    ds_read_b64_tr_b16 v[74:75], v11 offset:3072
    s_waitcnt lgkmcnt(2)
    v_mfma_f32_16x16x32_bf16 v[36:39], v[68:71], v[192:195], v[36:39]
    ds_read_b64_tr_b16 v[76:77], v12 offset:2048
    v_mfma_f32_16x16x32_bf16 v[44:47], v[68:71], v[196:199], v[44:47]
    ds_read_b64_tr_b16 v[78:79], v12 offset:3072
    s_waitcnt lgkmcnt(2)
    v_mfma_f32_16x16x32_bf16 v[32:35], v[72:75], v[200:203], v[32:35]
    ds_read_b64_tr_b16 v[64:65], v11 offset:4096
    v_mfma_f32_16x16x32_bf16 v[40:43], v[72:75], v[204:207], v[40:43]
    ds_read_b64_tr_b16 v[66:67], v11 offset:5120
    s_waitcnt lgkmcnt(2)
    v_mfma_f32_16x16x32_bf16 v[36:39], v[76:79], v[200:203], v[36:39]
    ds_read_b64_tr_b16 v[68:69], v12 offset:4096
    v_mfma_f32_16x16x32_bf16 v[44:47], v[76:79], v[204:207], v[44:47]
    ds_read_b64_tr_b16 v[70:71], v12 offset:5120
    s_waitcnt lgkmcnt(2)
    v_mfma_f32_16x16x32_bf16 v[32:35], v[64:67], v[208:211], v[32:35]
    ds_read_b64_tr_b16 v[72:73], v11 offset:6144
    v_mfma_f32_16x16x32_bf16 v[40:43], v[64:67], v[212:215], v[40:43]
    ds_read_b64_tr_b16 v[74:75], v11 offset:7168
    s_waitcnt lgkmcnt(2)
    v_mfma_f32_16x16x32_bf16 v[36:39], v[68:71], v[208:211], v[36:39]
    ds_read_b64_tr_b16 v[76:77], v12 offset:6144
    v_mfma_f32_16x16x32_bf16 v[44:47], v[68:71], v[212:215], v[44:47]
    ds_read_b64_tr_b16 v[78:79], v12 offset:7168
    s_waitcnt lgkmcnt(2)
    v_mfma_f32_16x16x32_bf16 v[32:35], v[72:75], v[216:219], v[32:35]
    ds_read_b64_tr_b16 v[64:65], v11 offset:8192
    v_mfma_f32_16x16x32_bf16 v[40:43], v[72:75], v[220:223], v[40:43]
    ds_read_b64_tr_b16 v[66:67], v11 offset:9216
    s_waitcnt lgkmcnt(2)
    v_mfma_f32_16x16x32_bf16 v[36:39], v[76:79], v[216:219], v[36:39]
    ds_read_b64_tr_b16 v[68:69], v12 offset:8192
    v_mfma_f32_16x16x32_bf16 v[44:47], v[76:79], v[220:223], v[44:47]
    ds_read_b64_tr_b16 v[70:71], v12 offset:9216
    s_waitcnt lgkmcnt(2)
    v_mfma_f32_16x16x32_bf16 v[32:35], v[64:67], v[224:227], v[32:35]
    ds_read_b64_tr_b16 v[72:73], v11 offset:10240
    v_mfma_f32_16x16x32_bf16 v[40:43], v[64:67], v[228:231], v[40:43]
    ds_read_b64_tr_b16 v[74:75], v11 offset:11264
    s_waitcnt lgkmcnt(2)
    v_mfma_f32_16x16x32_bf16 v[36:39], v[68:71], v[224:227], v[36:39]
    ds_read_b64_tr_b16 v[76:77], v12 offset:10240
    v_mfma_f32_16x16x32_bf16 v[44:47], v[68:71], v[228:231], v[44:47]
    ds_read_b64_tr_b16 v[78:79], v12 offset:11264
    s_waitcnt lgkmcnt(2)
    v_mfma_f32_16x16x32_bf16 v[32:35], v[72:75], v[232:235], v[32:35]
    ds_read_b64_tr_b16 v[64:65], v11 offset:12288
    v_mfma_f32_16x16x32_bf16 v[40:43], v[72:75], v[236:239], v[40:43]
    ds_read_b64_tr_b16 v[66:67], v11 offset:13312
    s_waitcnt lgkmcnt(2)
    v_mfma_f32_16x16x32_bf16 v[36:39], v[76:79], v[232:235], v[36:39]
    ds_read_b64_tr_b16 v[68:69], v12 offset:12288
    v_mfma_f32_16x16x32_bf16 v[44:47], v[76:79], v[236:239], v[44:47]
    ds_read_b64_tr_b16 v[70:71], v12 offset:13312
    s_waitcnt lgkmcnt(2)
    v_mfma_f32_16x16x32_bf16 v[32:35], v[64:67], v[240:243], v[32:35]
    ds_read_b64_tr_b16 v[72:73], v11 offset:14336
    v_mfma_f32_16x16x32_bf16 v[40:43], v[64:67], v[244:247], v[40:43]
    ds_read_b64_tr_b16 v[74:75], v11 offset:15360
    s_waitcnt lgkmcnt(2)
    v_mfma_f32_16x16x32_bf16 v[36:39], v[68:71], v[240:243], v[36:39]
    ds_read_b64_tr_b16 v[76:77], v12 offset:14336
    v_mfma_f32_16x16x32_bf16 v[44:47], v[68:71], v[244:247], v[44:47]
    ds_read_b64_tr_b16 v[78:79], v12 offset:15360
    s_waitcnt lgkmcnt(2)
    v_mfma_f32_16x16x32_bf16 v[32:35], v[72:75], v[248:251], v[32:35]
    v_mfma_f32_16x16x32_bf16 v[40:43], v[72:75], v[252:255], v[40:43]
    s_waitcnt lgkmcnt(0)
    v_mfma_f32_16x16x32_bf16 v[36:39], v[76:79], v[248:251], v[36:39]
    v_mfma_f32_16x16x32_bf16 v[44:47], v[76:79], v[252:255], v[44:47]
    s_nop 3
    v_pk_fma_f32 v[32:33], v[28:29], v[96:97], v[32:33] op_sel:[0,0,0] op_sel_hi:[0,1,1] neg_lo:[1,0,0] neg_hi:[1,0,0]
    v_pk_fma_f32 v[34:35], v[28:29], v[98:99], v[34:35] op_sel:[0,0,0] op_sel_hi:[0,1,1] neg_lo:[1,0,0] neg_hi:[1,0,0]
    s_nop 0
    v_pk_fma_f32 v[36:37], v[28:29], v[100:101], v[36:37] op_sel:[0,0,0] op_sel_hi:[0,1,1] neg_lo:[1,0,0] neg_hi:[1,0,0]
    v_pk_fma_f32 v[38:39], v[28:29], v[102:103], v[38:39] op_sel:[0,0,0] op_sel_hi:[0,1,1] neg_lo:[1,0,0] neg_hi:[1,0,0]
    v_pk_fma_f32 v[40:41], v[28:29], v[96:97], v[40:41] op_sel:[1,0,0] op_sel_hi:[1,1,1] neg_lo:[1,0,0] neg_hi:[1,0,0]
    v_pk_fma_f32 v[42:43], v[28:29], v[98:99], v[42:43] op_sel:[1,0,0] op_sel_hi:[1,1,1] neg_lo:[1,0,0] neg_hi:[1,0,0]
    v_pk_fma_f32 v[44:45], v[28:29], v[100:101], v[44:45] op_sel:[1,0,0] op_sel_hi:[1,1,1] neg_lo:[1,0,0] neg_hi:[1,0,0]
    v_pk_fma_f32 v[46:47], v[28:29], v[102:103], v[46:47] op_sel:[1,0,0] op_sel_hi:[1,1,1] neg_lo:[1,0,0] neg_hi:[1,0,0]
    v_pk_mul_f32 v[64:65], v[32:33], v[92:93] op_sel:[0,0] op_sel_hi:[1,0]
    v_pk_mul_f32 v[66:67], v[34:35], v[92:93] op_sel:[0,0] op_sel_hi:[1,0]
    v_pk_mul_f32 v[68:69], v[36:37], v[92:93] op_sel:[0,0] op_sel_hi:[1,0]
    v_pk_mul_f32 v[70:71], v[38:39], v[92:93] op_sel:[0,0] op_sel_hi:[1,0]
    v_pk_mul_f32 v[72:73], v[40:41], v[92:93] op_sel:[0,1] op_sel_hi:[1,1]
    v_pk_mul_f32 v[74:75], v[42:43], v[92:93] op_sel:[0,1] op_sel_hi:[1,1]
    v_pk_mul_f32 v[76:77], v[44:45], v[92:93] op_sel:[0,1] op_sel_hi:[1,1]
    v_pk_mul_f32 v[78:79], v[46:47], v[92:93] op_sel:[0,1] op_sel_hi:[1,1]
    v_exp_f32 v64, v64 clamp
    v_exp_f32 v65, v65 clamp
    v_pk_fma_f32 v[32:33], v[32:33], v[94:95], v[88:89] op_sel:[0,0,0] op_sel_hi:[1,0,0]
    v_exp_f32 v66, v66 clamp
    v_exp_f32 v67, v67 clamp
    v_pk_fma_f32 v[34:35], v[34:35], v[94:95], v[88:89] op_sel:[0,0,0] op_sel_hi:[1,0,0]
    v_exp_f32 v68, v68 clamp
    v_exp_f32 v69, v69 clamp
    v_pk_fma_f32 v[36:37], v[36:37], v[94:95], v[88:89] op_sel:[0,0,0] op_sel_hi:[1,0,0]
    v_exp_f32 v70, v70 clamp
    v_exp_f32 v71, v71 clamp
    v_pk_fma_f32 v[38:39], v[38:39], v[94:95], v[88:89] op_sel:[0,0,0] op_sel_hi:[1,0,0]
    v_exp_f32 v72, v72 clamp
    v_exp_f32 v73, v73 clamp
    v_pk_fma_f32 v[40:41], v[40:41], v[94:95], v[88:89] op_sel:[0,1,0] op_sel_hi:[1,1,0]
    v_exp_f32 v74, v74 clamp
    v_exp_f32 v75, v75 clamp
    v_pk_fma_f32 v[42:43], v[42:43], v[94:95], v[88:89] op_sel:[0,1,0] op_sel_hi:[1,1,0]
    v_exp_f32 v76, v76 clamp
    v_exp_f32 v77, v77 clamp
    v_pk_fma_f32 v[44:45], v[44:45], v[94:95], v[88:89] op_sel:[0,1,0] op_sel_hi:[1,1,0]
    v_exp_f32 v78, v78 clamp
    v_exp_f32 v79, v79 clamp
    v_pk_fma_f32 v[46:47], v[46:47], v[94:95], v[88:89] op_sel:[0,1,0] op_sel_hi:[1,1,0]
    v_max_f32 v32, v32, v64
    v_max_f32 v33, v33, v65
    v_max_f32 v34, v34, v66
    v_max_f32 v35, v35, v67
    v_max_f32 v36, v36, v68
    v_max_f32 v37, v37, v69
    v_max_f32 v38, v38, v70
    v_max_f32 v39, v39, v71
    v_max_f32 v40, v40, v72
    v_max_f32 v41, v41, v73
    v_max_f32 v42, v42, v74
    v_max_f32 v43, v43, v75
    v_max_f32 v44, v44, v76
    v_max_f32 v45, v45, v77
    v_max_f32 v46, v46, v78
    v_max_f32 v47, v47, v79
    v_pk_add_f32 v[32:33], v[32:33], v[88:89] op_sel:[0,1] op_sel_hi:[1,1]
    v_pk_add_f32 v[34:35], v[34:35], v[88:89] op_sel:[0,1] op_sel_hi:[1,1]
    v_pk_add_f32 v[36:37], v[36:37], v[88:89] op_sel:[0,1] op_sel_hi:[1,1]
    v_pk_add_f32 v[38:39], v[38:39], v[88:89] op_sel:[0,1] op_sel_hi:[1,1]
    v_pk_add_f32 v[40:41], v[40:41], v[88:89] op_sel:[0,1] op_sel_hi:[1,1]
    v_pk_add_f32 v[42:43], v[42:43], v[88:89] op_sel:[0,1] op_sel_hi:[1,1]
    v_pk_add_f32 v[44:45], v[44:45], v[88:89] op_sel:[0,1] op_sel_hi:[1,1]
    v_pk_add_f32 v[46:47], v[46:47], v[88:89] op_sel:[0,1] op_sel_hi:[1,1]
    v_cvt_pk_bf16_f32 v32, v32, v33
    v_cvt_pk_bf16_f32 v33, v34, v35
    v_cvt_pk_bf16_f32 v34, v36, v37
    v_cvt_pk_bf16_f32 v35, v38, v39
    v_cvt_pk_bf16_f32 v36, v40, v41
    v_cvt_pk_bf16_f32 v37, v42, v43
    v_cvt_pk_bf16_f32 v38, v44, v45
    v_cvt_pk_bf16_f32 v39, v46, v47
    v_lshlrev_b32 v6, 4, v1
    v_and_b32 v4, 1, v1
    v_cmp_eq_u32 vcc, 1, v4
    v_lshlrev_b32 v4, 6, v4
    v_lshl_add_u32 v7, v2, 4, v4
    v_mov_b32 v140, 0x358637bd
    v_mov_b32 v141, 0x358637bd
    v_mov_b32 v142, 0x358637bd
    v_mov_b32 v143, 0x358637bd
    s_add_u32 s5, s7, 44032
    s_barrier
    buffer_load_dwordx4 v[136:139], v7, s[44:47], s11 offen
    buffer_load_dwordx4 v[128:131], v6, s[44:47], s10 offen offset:0
    buffer_load_dwordx4 v[132:135], v6, s[44:47], s10 offen offset:1024
    s_waitcnt vmcnt(2)
    v_cvt_pk_bf16_f32 v4, v136, v137
    v_cvt_pk_bf16_f32 v5, v138, v139
    v_cndmask_b32 v136, v4, 0, vcc
    v_cndmask_b32 v137, v5, 0, vcc
    v_cndmask_b32 v138, 0, v4, vcc
    v_cndmask_b32 v139, 0, v5, vcc
    s_nop 1
    v_mfma_f32_16x16x32_bf16 v[152:155], v[136:139], v[32:35], v[140:143]
    v_mfma_f32_16x16x32_bf16 v[164:167], v[136:139], v[36:39], v[140:143]
    s_waitcnt vmcnt(1)
    v_cvt_pk_bf16_f32 v128, v128, v129
    v_cvt_pk_bf16_f32 v129, v130, v131
    s_waitcnt vmcnt(0)
    v_cvt_pk_bf16_f32 v130, v132, v133
    v_cvt_pk_bf16_f32 v131, v134, v135
    v_mfma_f32_16x16x16_bf16 v[144:147], v[128:129], v[32:33], 0
    s_nop 0
    v_mfma_f32_16x16x16_bf16 v[148:151], v[130:131], v[34:35], 0
    v_mfma_f32_16x16x16_bf16 v[156:159], v[128:129], v[36:37], 0
    v_mfma_f32_16x16x16_bf16 v[160:163], v[130:131], v[38:39], 0
    v_rcp_f32 v152, v152
    v_rcp_f32 v153, v153
    v_rcp_f32 v164, v164
    v_rcp_f32 v165, v165
    v_pk_mul_f32 v[144:145], v[144:145], v[152:153] op_sel:[0,0] op_sel_hi:[1,0]
    v_pk_mul_f32 v[146:147], v[146:147], v[152:153] op_sel:[0,0] op_sel_hi:[1,0]
    v_pk_mul_f32 v[148:149], v[148:149], v[152:153] op_sel:[0,1] op_sel_hi:[1,1]
    v_pk_mul_f32 v[150:151], v[150:151], v[152:153] op_sel:[0,1] op_sel_hi:[1,1]
    v_cvt_pk_bf16_f32 v176, v144, v145
    v_cvt_pk_bf16_f32 v177, v146, v147
    v_cvt_pk_bf16_f32 v178, v148, v149
    v_cvt_pk_bf16_f32 v179, v150, v151
    buffer_store_dwordx4 v[176:179], v6, s[44:47], s7 offen
    v_pk_mul_f32 v[156:157], v[156:157], v[164:165] op_sel:[0,0] op_sel_hi:[1,0]
    v_pk_mul_f32 v[158:159], v[158:159], v[164:165] op_sel:[0,0] op_sel_hi:[1,0]
    v_pk_mul_f32 v[160:161], v[160:161], v[164:165] op_sel:[0,1] op_sel_hi:[1,1]
    v_pk_mul_f32 v[162:163], v[162:163], v[164:165] op_sel:[0,1] op_sel_hi:[1,1]
    v_cvt_pk_bf16_f32 v180, v156, v157
    v_cvt_pk_bf16_f32 v181, v158, v159
    v_cvt_pk_bf16_f32 v182, v160, v161
    v_cvt_pk_bf16_f32 v183, v162, v163
    buffer_store_dwordx4 v[180:183], v6, s[44:47], s5 offen
    s_waitcnt vmcnt(0)
    s_barrier
    s_lshr_b32 s13, s61, 3
    s_lshl_b32 s12, s60, 1
    s_add_u32 s12, s12, s13
    s_and_b32 s13, s61, 7
    s_lshl_b32 s14, s13, 1
    s_lshr_b32 s10, s3, 1
    s_and_b32 s11, s3, 1
    s_lshl_b32 s15, s12, 2
    s_lshl_b32 s5, s10, 1
    s_add_u32 s15, s15, s5
    v_lshlrev_b32 v16, 4, v1
    s_lshl_b32 s6, s15, 4
    s_lshl_b32 s5, s13, 1
    s_add_u32 s6, s6, s5
    s_add_u32 s6, s6, s11
    s_lshl_b32 s6, s6, 10
    s_add_u32 s7, s6, 4194304
    s_add_u32 s6, s6, 4194304
    s_lshl_b32 s8, s15, 14
    s_lshl_b32 s5, s13, 7
    s_add_u32 s8, s8, s5
    s_lshl_b32 s5, s11, 6
    s_add_u32 s8, s8, s5
    s_add_u32 s5, s7, 16384
    buffer_load_dwordx4 v[24:27], v16, s[44:47], s7 offen
    buffer_load_dwordx4 v[28:31], v16, s[44:47], s5 offen
    s_lshl_b32 s4, s10, 11
    s_add_u32 s4, s4, 98304
    v_lshl_add_u32 v8, v1, 4, s4
    v_and_b32 v4, 1, v2
    v_lshlrev_b32 v4, 5, v4
    v_lshl_add_u32 v4, v2, 8, v4
    v_bfe_u32 v5, v1, 2, 2
    v_lshl_add_u32 v4, v5, 6, v4
    v_and_b32 v5, 3, v1
    v_lshl_add_u32 v9, v5, 3, v4
    v_xor_b32 v10, 32, v9
    s_lshl_b32 s4, s11, 11
    v_add_u32 v9, s4, v9
    v_add_u32 v10, s4, v10
    v_mov_b32 v128, 0x3f803f80
    v_mov_b32 v129, 0x3f803f80
    v_mov_b32 v130, 0x3f803f80
    v_mov_b32 v131, 0x3f803f80
    s_waitcnt vmcnt(1)
    v_lshlrev_b32 v32, 16, v24
    v_and_b32 v33, 0xffff0000, v24
    v_lshlrev_b32 v34, 16, v25
    v_and_b32 v35, 0xffff0000, v25
    v_lshlrev_b32 v36, 16, v26
    v_and_b32 v37, 0xffff0000, v26
    v_lshlrev_b32 v38, 16, v27
    v_and_b32 v39, 0xffff0000, v27
    s_waitcnt vmcnt(0)
    v_lshlrev_b32 v40, 16, v28
    v_and_b32 v41, 0xffff0000, v28
    v_lshlrev_b32 v42, 16, v29
    v_and_b32 v43, 0xffff0000, v29
    v_lshlrev_b32 v44, 16, v30
    v_and_b32 v45, 0xffff0000, v30
    v_lshlrev_b32 v46, 16, v31
    v_and_b32 v47, 0xffff0000, v31
    s_mov_b32 s58, 0
    s_mov_b32 s59, 65536
    s_mov_b32 s9, 0
    v_mov_b32 v11, v8
    v_add_u32 v12, s59, v9
    v_add_u32 v13, s59, v10
    s_barrier
    ds_read_b128 v[48:51], v11 offset:0
    ds_read_b64_tr_b16 v[64:65], v12 offset:0
    ds_read_b64_tr_b16 v[66:67], v12 offset:1024
    ds_read_b128 v[52:55], v11 offset:1024
    ds_read_b64_tr_b16 v[68:69], v13 offset:0
    ds_read_b64_tr_b16 v[70:71], v13 offset:1024
    ds_read_b128 v[56:59], v11 offset:4096
    ds_read_b64_tr_b16 v[72:73], v12 offset:4096
    ds_read_b64_tr_b16 v[74:75], v12 offset:5120
    ds_read_b128 v[60:63], v11 offset:5120
    ds_read_b64_tr_b16 v[76:77], v13 offset:4096
    ds_read_b64_tr_b16 v[78:79], v13 offset:5120
L_ml_s2l1:
    s_barrier
    s_waitcnt lgkmcnt(9)
    v_mfma_f32_16x16x32_bf16 v[32:35], v[64:67], v[48:51], v[32:35]
    ds_read_b128 v[80:83], v11 offset:8192
    ds_read_b64_tr_b16 v[96:97], v12 offset:8192
    s_waitcnt lgkmcnt(10)
    v_mfma_f32_16x16x32_bf16 v[40:43], v[64:67], v[52:55], v[40:43]
    ds_read_b64_tr_b16 v[98:99], v12 offset:9216
    ds_read_b128 v[84:87], v11 offset:9216
    s_waitcnt lgkmcnt(10)
    v_mfma_f32_16x16x32_bf16 v[36:39], v[68:71], v[48:51], v[36:39]
    ds_read_b64_tr_b16 v[100:101], v13 offset:8192
    ds_read_b64_tr_b16 v[102:103], v13 offset:9216
    v_mfma_f32_16x16x32_bf16 v[44:47], v[68:71], v[52:55], v[44:47]
    ds_read_b128 v[88:91], v11 offset:12288
    ds_read_b64_tr_b16 v[104:105], v12 offset:12288
    s_waitcnt lgkmcnt(11)
    v_mfma_f32_16x16x32_bf16 v[32:35], v[72:75], v[56:59], v[32:35]
    ds_read_b64_tr_b16 v[106:107], v12 offset:13312
    ds_read_b128 v[92:95], v11 offset:13312
    s_waitcnt lgkmcnt(12)
    v_mfma_f32_16x16x32_bf16 v[40:43], v[72:75], v[60:63], v[40:43]
    ds_read_b64_tr_b16 v[108:109], v13 offset:12288
    ds_read_b64_tr_b16 v[110:111], v13 offset:13312
    s_waitcnt lgkmcnt(12)
    v_mfma_f32_16x16x32_bf16 v[36:39], v[76:79], v[56:59], v[36:39]
    s_add_u32 s58, s58, 16384
    s_cmp_eq_u32 s58, 49152
    s_cselect_b32 s58, 0, s58
    s_add_u32 s59, s59, 16384
    s_cmp_eq_u32 s59, 98304
    v_mfma_f32_16x16x32_bf16 v[44:47], v[76:79], v[60:63], v[44:47]
    s_cselect_b32 s59, 0, s59
    v_add_u32 v11, s58, v8
    v_add_u32 v12, s59, v9
    v_add_u32 v13, s59, v10
    s_barrier
    s_waitcnt lgkmcnt(9)
    v_mfma_f32_16x16x32_bf16 v[32:35], v[96:99], v[80:83], v[32:35]
    ds_read_b128 v[48:51], v11 offset:0
    ds_read_b64_tr_b16 v[64:65], v12 offset:0
    s_waitcnt lgkmcnt(10)
    v_mfma_f32_16x16x32_bf16 v[40:43], v[96:99], v[84:87], v[40:43]
    ds_read_b64_tr_b16 v[66:67], v12 offset:1024
    ds_read_b128 v[52:55], v11 offset:1024
    s_waitcnt lgkmcnt(10)
    v_mfma_f32_16x16x32_bf16 v[36:39], v[100:103], v[80:83], v[36:39]
    ds_read_b64_tr_b16 v[68:69], v13 offset:0
    ds_read_b64_tr_b16 v[70:71], v13 offset:1024
    v_mfma_f32_16x16x32_bf16 v[44:47], v[100:103], v[84:87], v[44:47]
    ds_read_b128 v[56:59], v11 offset:4096
    ds_read_b64_tr_b16 v[72:73], v12 offset:4096
    s_waitcnt lgkmcnt(11)
    v_mfma_f32_16x16x32_bf16 v[32:35], v[104:107], v[88:91], v[32:35]
    ds_read_b64_tr_b16 v[74:75], v12 offset:5120
    ds_read_b128 v[60:63], v11 offset:5120
    s_waitcnt lgkmcnt(12)
    v_mfma_f32_16x16x32_bf16 v[40:43], v[104:107], v[92:95], v[40:43]
    ds_read_b64_tr_b16 v[76:77], v13 offset:4096
    ds_read_b64_tr_b16 v[78:79], v13 offset:5120
    s_waitcnt lgkmcnt(12)
    v_mfma_f32_16x16x32_bf16 v[36:39], v[108:111], v[88:91], v[36:39]
    s_add_u32 s9, s9, 1
    v_mfma_f32_16x16x32_bf16 v[44:47], v[108:111], v[92:95], v[44:47]
    s_cmp_lt_u32 s9, 4
    s_cbranch_scc1 L_ml_s2l1
    s_waitcnt lgkmcnt(0)
    v_cvt_pk_bf16_f32 v24, v32, v33
    v_cvt_pk_bf16_f32 v25, v34, v35
    s_nop 0
    v_cvt_pk_bf16_f32 v26, v36, v37
    v_cvt_pk_bf16_f32 v27, v38, v39
    v_cvt_pk_bf16_f32 v28, v40, v41
    v_cvt_pk_bf16_f32 v29, v42, v43
    v_cvt_pk_bf16_f32 v30, v44, v45
    v_cvt_pk_bf16_f32 v31, v46, v47
    v_mfma_f32_16x16x32_bf16 v[112:115], v[128:131], v[24:27], 0
    v_mfma_f32_16x16x32_bf16 v[116:119], v[24:27], v[24:27], 0
    v_mfma_f32_16x16x32_bf16 v[120:123], v[128:131], v[28:31], 0
    v_mfma_f32_16x16x32_bf16 v[124:127], v[28:31], v[28:31], 0
    s_add_u32 s5, s6, 16384
    buffer_store_dwordx4 v[24:27], v16, s[44:47], s6 offen
    buffer_store_dwordx4 v[28:31], v16, s[44:47], s5 offen
    s_lshl_b32 s4, s15, 10
    s_lshl_b32 s5, s13, 3
    s_add_u32 s4, s4, s5
    s_lshl_b32 s5, s11, 17
    s_add_u32 s4, s4, s5
    s_add_u32 s4, s4, 23592960
    v_lshlrev_b32 v5, 6, v3
    v_and_b32 v6, 3, v3
    v_cmp_eq_u32 s[52:53], 1, v6
    v_cmp_eq_u32 s[54:55], 2, v6
    v_cmp_eq_u32 s[56:57], 3, v6
    v_lshrrev_b32 v6, 2, v3
    v_cmp_eq_u32 vcc, v6, v2
    v_cndmask_b32 v113, v116, v117, s[52:53]
    v_cndmask_b32 v113, v113, v118, s[54:55]
    v_cndmask_b32 v113, v113, v119, s[56:57]
    v_cndmask_b32 v121, v124, v125, s[52:53]
    v_cndmask_b32 v121, v121, v126, s[54:55]
    v_cndmask_b32 v121, v121, v127, s[56:57]
    s_mov_b64 exec, vcc
    buffer_store_dwordx2 v[112:113], v5, s[44:47], s4 offen offset:0
    buffer_store_dwordx2 v[120:121], v5, s[44:47], s4 offen offset:1024
    s_mov_b64 exec, -1
    s_waitcnt vmcnt(0)
    s_barrier
    s_mov_b32 s12, s60
    s_mov_b32 s13, s61
    s_mov_b32 s14, s61
    s_lshr_b32 s6, s3, 1
    s_and_b32 s11, s3, 1
    s_lshl_b32 s15, s12, 3
    s_lshl_b32 s5, s6, 2
    s_add_u32 s15, s15, s5
    s_lshl_b32 s4, s6, 12
    s_add_u32 s4, s4, 98304
    v_lshl_add_u32 v8, v1, 4, s4
    v_and_b32 v4, 1, v2
    v_lshlrev_b32 v4, 5, v4
    v_lshl_add_u32 v4, v2, 8, v4
    v_bfe_u32 v5, v1, 2, 2
    v_lshl_add_u32 v4, v5, 6, v4
    v_and_b32 v5, 3, v1
    v_lshl_add_u32 v9, v5, 3, v4
    v_xor_b32 v10, 32, v9
    s_lshl_b32 s4, s11, 5
    v_xor_b32 v11, s4, v9
    v_add_u32 v11, 4096, v11
    s_lshl_b32 s4, s11, 13
    v_add_u32 v9, s4, v9
    v_add_u32 v10, s4, v10
    s_mul_i32 s4, s15, 43
    s_mul_i32 s5, s13, 3
    s_add_u32 s4, s4, s5
    s_lshl_b32 s4, s4, 10
    s_add_u32 s4, s4, 8388608
    s_lshl_b32 s7, s11, 11
    s_add_u32 s7, s7, s4
    s_lshl_b32 s8, s11, 3
    s_add_u32 s8, s8, s4
    s_add_u32 s8, s8, 1024
    s_cmp_ge_u32 s13, 14
    s_cselect_b32 s8, 24117248, s8
    s_cselect_b32 s5, s11, 0
    s_cmp_eq_u32 s13, 15
    s_cselect_b32 s5, 1, s5
    s_cmp_lg_u32 s5, 0
    s_cselect_b32 s7, 24117248, s7
    s_mul_i32 s4, s11, 384
    s_add_u32 s4, s4, 158720
    v_lshl_add_u32 v16, v2, 4, s4
    v_mov_b32 v240, 0x3f803f80
    v_mov_b32 v241, 0x3f803f80
    v_mov_b32 v242, 0x3f803f80
    v_mov_b32 v243, 0x3f803f80
    v_mov_b32 v40, 0
    v_mov_b32 v41, 0
    v_mov_b32 v42, 0
    v_mov_b32 v43, 0
    v_mov_b32 v44, 0
    v_mov_b32 v45, 0
    v_mov_b32 v46, 0
    v_mov_b32 v47, 0
    v_mov_b32 v48, 0
    v_mov_b32 v49, 0
    v_mov_b32 v50, 0
    v_mov_b32 v51, 0
    v_mov_b32 v52, 0
    v_mov_b32 v53, 0
    v_mov_b32 v54, 0
    v_mov_b32 v55, 0
    v_mov_b32 v56, 0
    v_mov_b32 v57, 0
    v_mov_b32 v58, 0
    v_mov_b32 v59, 0
    v_mov_b32 v60, 0
    v_mov_b32 v61, 0
    v_mov_b32 v62, 0
    v_mov_b32 v63, 0
    v_mov_b32 v64, 0
    v_mov_b32 v65, 0
    v_mov_b32 v66, 0
    v_mov_b32 v67, 0
    v_mov_b32 v68, 0
    v_mov_b32 v69, 0
    v_mov_b32 v70, 0
    v_mov_b32 v71, 0
    v_mov_b32 v72, 0
    v_mov_b32 v73, 0
    v_mov_b32 v74, 0
    v_mov_b32 v75, 0
    v_mov_b32 v76, 0
    v_mov_b32 v77, 0
    v_mov_b32 v78, 0
    v_mov_b32 v79, 0
    v_mov_b32 v80, 0
    v_mov_b32 v81, 0
    v_mov_b32 v82, 0
    v_mov_b32 v83, 0
    v_mov_b32 v84, 0
    v_mov_b32 v85, 0
    v_mov_b32 v86, 0
    v_mov_b32 v87, 0
    v_mov_b32 v88, 0
    v_mov_b32 v89, 0
    v_mov_b32 v90, 0
    v_mov_b32 v91, 0
    v_mov_b32 v92, 0
    v_mov_b32 v93, 0
    v_mov_b32 v94, 0
    v_mov_b32 v95, 0
    v_mov_b32 v96, 0
    v_mov_b32 v97, 0
    v_mov_b32 v98, 0
    v_mov_b32 v99, 0
    v_mov_b32 v100, 0
    v_mov_b32 v101, 0
    v_mov_b32 v102, 0
    v_mov_b32 v103, 0
    v_mov_b32 v104, 0
    v_mov_b32 v105, 0
    v_mov_b32 v106, 0
    v_mov_b32 v107, 0
    v_mov_b32 v108, 0
    v_mov_b32 v109, 0
    v_mov_b32 v110, 0
    v_mov_b32 v111, 0
    v_mov_b32 v112, 0
    v_mov_b32 v113, 0
    v_mov_b32 v114, 0
    v_mov_b32 v115, 0
    v_mov_b32 v116, 0
    v_mov_b32 v117, 0
    v_mov_b32 v118, 0
    v_mov_b32 v119, 0
    v_mov_b32 v120, 0
    v_mov_b32 v121, 0
    v_mov_b32 v122, 0
    v_mov_b32 v123, 0
    v_mov_b32 v124, 0
    v_mov_b32 v125, 0
    v_mov_b32 v126, 0
    v_mov_b32 v127, 0
    v_mov_b32 v128, 0
    v_mov_b32 v129, 0
    v_mov_b32 v130, 0
    v_mov_b32 v131, 0
    v_mov_b32 v132, 0
    v_mov_b32 v133, 0
    v_mov_b32 v134, 0
    v_mov_b32 v135, 0
    s_lshl_b32 s4, s6, 8
    s_add_u32 s4, s4, 147456
    v_lshl_add_u32 v6, v3, 2, s4
    v_lshlrev_b32 v4, 4, v1
    ds_read_b128 v[136:139], v16 offset:0
    ds_read_b128 v[140:143], v16 offset:64
    ds_read_b128 v[144:147], v16 offset:128
    ds_read_b128 v[148:151], v16 offset:192
    ds_read_b128 v[152:155], v16 offset:256
    ds_read_b128 v[156:159], v16 offset:320
    s_waitcnt lgkmcnt(0)
    s_mov_b32 s58, 0
    s_mov_b32 s59, 49152
    s_mov_b32 s9, 0
    v_mov_b32 v12, v8
    v_add_u32 v13, s59, v9
    v_add_u32 v14, s59, v10
    v_add_u32 v15, s59, v11
    s_barrier
    ds_read_b64_tr_b16 v[176:177], v13 offset:0
    ds_read_b64_tr_b16 v[178:179], v13 offset:1024
    ds_read_b128 v[160:163], v12 offset:0
    ds_read_b128 v[164:167], v12 offset:1024
    ds_read_b128 v[168:171], v12 offset:2048
    ds_read_b128 v[172:175], v12 offset:3072
    ds_read_b64_tr_b16 v[180:181], v13 offset:2048
    ds_read_b64_tr_b16 v[182:183], v13 offset:3072
    ds_read_b64_tr_b16 v[184:185], v14 offset:0
    ds_read_b64_tr_b16 v[186:187], v14 offset:1024
    ds_read_b64_tr_b16 v[188:189], v14 offset:2048
    ds_read_b64_tr_b16 v[190:191], v14 offset:3072
    ds_read_b64_tr_b16 v[192:193], v15 offset:0
    ds_read_b64_tr_b16 v[194:195], v15 offset:1024
    ds_read_b64_tr_b16 v[196:197], v15 offset:2048
    ds_read_b64_tr_b16 v[198:199], v15 offset:3072
L_ml_s3l1:
    s_waitcnt lgkmcnt(13)
    v_mfma_f32_16x16x32_bf16 v[40:43], v[176:179], v[160:163], v[40:43]
    ds_read_b64_tr_b16 v[216:217], v13 offset:12288
    s_waitcnt lgkmcnt(13)
    v_mfma_f32_16x16x32_bf16 v[52:55], v[176:179], v[164:167], v[52:55]
    ds_read_b64_tr_b16 v[218:219], v13 offset:13312
    s_waitcnt lgkmcnt(13)
    v_mfma_f32_16x16x32_bf16 v[64:67], v[176:179], v[168:171], v[64:67]
    ds_read_b128 v[200:203], v12 offset:8192
    s_waitcnt lgkmcnt(13)
    v_mfma_f32_16x16x32_bf16 v[76:79], v[176:179], v[172:175], v[76:79]
    ds_read_b128 v[204:207], v12 offset:9216
    s_waitcnt lgkmcnt(12)
    v_mfma_f32_16x16x32_bf16 v[88:91], v[180:183], v[160:163], v[88:91]
    ds_read_b128 v[208:211], v12 offset:10240
    v_mfma_f32_16x16x32_bf16 v[100:103], v[180:183], v[164:167], v[100:103]
    ds_read_b128 v[212:215], v12 offset:11264
    v_mfma_f32_16x16x32_bf16 v[112:115], v[180:183], v[168:171], v[112:115]
    ds_read_b64_tr_b16 v[220:221], v13 offset:14336
    v_mfma_f32_16x16x32_bf16 v[124:127], v[180:183], v[172:175], v[124:127]
    ds_read_b64_tr_b16 v[222:223], v13 offset:15360
    s_waitcnt lgkmcnt(14)
    v_mfma_f32_16x16x32_bf16 v[44:47], v[184:187], v[160:163], v[44:47]
    ds_read_b64_tr_b16 v[224:225], v14 offset:12288
    v_mfma_f32_16x16x32_bf16 v[56:59], v[184:187], v[164:167], v[56:59]
    ds_read_b64_tr_b16 v[226:227], v14 offset:13312
    v_mfma_f32_16x16x32_bf16 v[68:71], v[184:187], v[168:171], v[68:71]
    ds_read_b64_tr_b16 v[228:229], v14 offset:14336
    v_mfma_f32_16x16x32_bf16 v[80:83], v[184:187], v[172:175], v[80:83]
    ds_read_b64_tr_b16 v[230:231], v14 offset:15360
    s_waitcnt lgkmcnt(14)
    v_mfma_f32_16x16x32_bf16 v[92:95], v[188:191], v[160:163], v[92:95]
    ds_read_b64_tr_b16 v[232:233], v15 offset:12288
    v_mfma_f32_16x16x32_bf16 v[104:107], v[188:191], v[164:167], v[104:107]
    ds_read_b64_tr_b16 v[234:235], v15 offset:13312
    v_mfma_f32_16x16x32_bf16 v[116:119], v[188:191], v[168:171], v[116:119]
    ds_read_b64_tr_b16 v[236:237], v15 offset:14336
    v_mfma_f32_16x16x32_bf16 v[128:131], v[188:191], v[172:175], v[128:131]
    ds_read_b64_tr_b16 v[238:239], v15 offset:15360
    v_mfma_f32_16x16x32_bf16 v[48:51], v[192:195], v[160:163], v[48:51]
    s_add_u32 s58, s58, 16384
    s_cmp_eq_u32 s58, 49152
    v_mfma_f32_16x16x32_bf16 v[60:63], v[192:195], v[164:167], v[60:63]
    s_cselect_b32 s58, 0, s58
    s_add_u32 s59, s59, 24576
    v_mfma_f32_16x16x32_bf16 v[72:75], v[192:195], v[168:171], v[72:75]
    s_cmp_eq_u32 s59, 98304
    s_cselect_b32 s59, 0, s59
    v_mfma_f32_16x16x32_bf16 v[84:87], v[192:195], v[172:175], v[84:87]
    v_add_u32 v12, s58, v8
    v_add_u32 v13, s59, v9
    s_waitcnt lgkmcnt(14)
    v_mfma_f32_16x16x32_bf16 v[96:99], v[196:199], v[160:163], v[96:99]
    v_add_u32 v14, s59, v10
    v_add_u32 v15, s59, v11
    v_mfma_f32_16x16x32_bf16 v[108:111], v[196:199], v[164:167], v[108:111]
    s_add_u32 s9, s9, 1
    v_mfma_f32_16x16x32_bf16 v[120:123], v[196:199], v[168:171], v[120:123]
    v_mfma_f32_16x16x32_bf16 v[132:135], v[196:199], v[172:175], v[132:135]
    s_waitcnt lgkmcnt(0)
    s_barrier
    s_cmp_lt_u32 s9, 8
    s_cbranch_scc0 L_mx_s3l1
    v_mfma_f32_16x16x32_bf16 v[40:43], v[216:219], v[200:203], v[40:43]
    ds_read_b64_tr_b16 v[176:177], v13 offset:0
    v_mfma_f32_16x16x32_bf16 v[52:55], v[216:219], v[204:207], v[52:55]
    ds_read_b64_tr_b16 v[178:179], v13 offset:1024
    v_mfma_f32_16x16x32_bf16 v[64:67], v[216:219], v[208:211], v[64:67]
    ds_read_b128 v[160:163], v12 offset:0
    v_mfma_f32_16x16x32_bf16 v[76:79], v[216:219], v[212:215], v[76:79]
    ds_read_b128 v[164:167], v12 offset:1024
    v_mfma_f32_16x16x32_bf16 v[88:91], v[220:223], v[200:203], v[88:91]
    ds_read_b128 v[168:171], v12 offset:2048
    v_mfma_f32_16x16x32_bf16 v[100:103], v[220:223], v[204:207], v[100:103]
    ds_read_b128 v[172:175], v12 offset:3072
    v_mfma_f32_16x16x32_bf16 v[112:115], v[220:223], v[208:211], v[112:115]
    ds_read_b64_tr_b16 v[180:181], v13 offset:2048
    v_mfma_f32_16x16x32_bf16 v[124:127], v[220:223], v[212:215], v[124:127]
    ds_read_b64_tr_b16 v[182:183], v13 offset:3072
    v_mfma_f32_16x16x32_bf16 v[44:47], v[224:227], v[200:203], v[44:47]
    ds_read_b64_tr_b16 v[184:185], v14 offset:0
    v_mfma_f32_16x16x32_bf16 v[56:59], v[224:227], v[204:207], v[56:59]
    ds_read_b64_tr_b16 v[186:187], v14 offset:1024
    v_mfma_f32_16x16x32_bf16 v[68:71], v[224:227], v[208:211], v[68:71]
    ds_read_b64_tr_b16 v[188:189], v14 offset:2048
    v_mfma_f32_16x16x32_bf16 v[80:83], v[224:227], v[212:215], v[80:83]
    ds_read_b64_tr_b16 v[190:191], v14 offset:3072
    v_mfma_f32_16x16x32_bf16 v[92:95], v[228:231], v[200:203], v[92:95]
    ds_read_b64_tr_b16 v[192:193], v15 offset:0
    v_mfma_f32_16x16x32_bf16 v[104:107], v[228:231], v[204:207], v[104:107]
    ds_read_b64_tr_b16 v[194:195], v15 offset:1024
    v_mfma_f32_16x16x32_bf16 v[116:119], v[228:231], v[208:211], v[116:119]
    ds_read_b64_tr_b16 v[196:197], v15 offset:2048
    v_mfma_f32_16x16x32_bf16 v[128:131], v[228:231], v[212:215], v[128:131]
    ds_read_b64_tr_b16 v[198:199], v15 offset:3072
    v_mfma_f32_16x16x32_bf16 v[48:51], v[232:235], v[200:203], v[48:51]
    v_mfma_f32_16x16x32_bf16 v[60:63], v[232:235], v[204:207], v[60:63]
    v_mfma_f32_16x16x32_bf16 v[72:75], v[232:235], v[208:211], v[72:75]
    v_mfma_f32_16x16x32_bf16 v[84:87], v[232:235], v[212:215], v[84:87]
    v_mfma_f32_16x16x32_bf16 v[96:99], v[236:239], v[200:203], v[96:99]
    v_mfma_f32_16x16x32_bf16 v[108:111], v[236:239], v[204:207], v[108:111]
    v_mfma_f32_16x16x32_bf16 v[120:123], v[236:239], v[208:211], v[120:123]
    v_mfma_f32_16x16x32_bf16 v[132:135], v[236:239], v[212:215], v[132:135]
    s_branch L_ml_s3l1
L_mx_s3l1:
    v_mfma_f32_16x16x32_bf16 v[40:43], v[216:219], v[200:203], v[40:43]
    ds_read_b32 v24, v6 offset:0
    ds_read_b32 v28, v6 offset:512
    v_mfma_f32_16x16x32_bf16 v[88:91], v[220:223], v[200:203], v[88:91]
    ds_read_b32 v25, v6 offset:64
    ds_read_b32 v29, v6 offset:576
    v_mfma_f32_16x16x32_bf16 v[44:47], v[224:227], v[200:203], v[44:47]
    ds_read_b32 v26, v6 offset:128
    ds_read_b32 v30, v6 offset:640
    v_mfma_f32_16x16x32_bf16 v[92:95], v[228:231], v[200:203], v[92:95]
    ds_read_b32 v27, v6 offset:192
    ds_read_b32 v31, v6 offset:704
    v_mfma_f32_16x16x32_bf16 v[48:51], v[232:235], v[200:203], v[48:51]
    v_mfma_f32_16x16x32_bf16 v[96:99], v[236:239], v[200:203], v[96:99]
    v_mfma_f32_16x16x32_bf16 v[52:55], v[216:219], v[204:207], v[52:55]
    v_mfma_f32_16x16x32_bf16 v[100:103], v[220:223], v[204:207], v[100:103]
    v_mfma_f32_16x16x32_bf16 v[56:59], v[224:227], v[204:207], v[56:59]
    s_waitcnt lgkmcnt(6)
    v_mul_f32 v32, v28, v28
    s_waitcnt lgkmcnt(4)
    v_mul_f32 v33, v29, v29
    s_waitcnt lgkmcnt(2)
    v_mul_f32 v34, v30, v30
    s_waitcnt lgkmcnt(0)
    v_mul_f32 v35, v31, v31
    v_mfma_f32_16x16x32_bf16 v[104:107], v[228:231], v[204:207], v[104:107]
    v_pk_fma_f32 v[40:41], v[24:25], v[136:137], v[40:41] op_sel:[0,0,0] op_sel_hi:[0,1,1] neg_lo:[1,0,0] neg_hi:[1,0,0]
    v_pk_fma_f32 v[88:89], v[24:25], v[148:149], v[88:89] op_sel:[0,0,0] op_sel_hi:[0,1,1] neg_lo:[1,0,0] neg_hi:[1,0,0]
    v_pk_fma_f32 v[42:43], v[24:25], v[138:139], v[42:43] op_sel:[0,0,0] op_sel_hi:[0,1,1] neg_lo:[1,0,0] neg_hi:[1,0,0]
    v_pk_fma_f32 v[90:91], v[24:25], v[150:151], v[90:91] op_sel:[0,0,0] op_sel_hi:[0,1,1] neg_lo:[1,0,0] neg_hi:[1,0,0]
    v_pk_fma_f32 v[44:45], v[24:25], v[140:141], v[44:45] op_sel:[0,0,0] op_sel_hi:[0,1,1] neg_lo:[1,0,0] neg_hi:[1,0,0]
    v_mfma_f32_16x16x32_bf16 v[60:63], v[232:235], v[204:207], v[60:63]
    v_pk_fma_f32 v[92:93], v[24:25], v[152:153], v[92:93] op_sel:[0,0,0] op_sel_hi:[0,1,1] neg_lo:[1,0,0] neg_hi:[1,0,0]
    v_pk_fma_f32 v[46:47], v[24:25], v[142:143], v[46:47] op_sel:[0,0,0] op_sel_hi:[0,1,1] neg_lo:[1,0,0] neg_hi:[1,0,0]
    v_pk_fma_f32 v[94:95], v[24:25], v[154:155], v[94:95] op_sel:[0,0,0] op_sel_hi:[0,1,1] neg_lo:[1,0,0] neg_hi:[1,0,0]
    v_pk_fma_f32 v[48:49], v[24:25], v[144:145], v[48:49] op_sel:[0,0,0] op_sel_hi:[0,1,1] neg_lo:[1,0,0] neg_hi:[1,0,0]
    v_pk_fma_f32 v[96:97], v[24:25], v[156:157], v[96:97] op_sel:[0,0,0] op_sel_hi:[0,1,1] neg_lo:[1,0,0] neg_hi:[1,0,0]
    v_mfma_f32_16x16x32_bf16 v[108:111], v[236:239], v[204:207], v[108:111]
    v_pk_fma_f32 v[50:51], v[24:25], v[146:147], v[50:51] op_sel:[0,0,0] op_sel_hi:[0,1,1] neg_lo:[1,0,0] neg_hi:[1,0,0]
    v_pk_fma_f32 v[98:99], v[24:25], v[158:159], v[98:99] op_sel:[0,0,0] op_sel_hi:[0,1,1] neg_lo:[1,0,0] neg_hi:[1,0,0]
    v_max_f32 v40, 0, v40
    v_max_f32 v41, 0, v41
    v_pk_mul_f32 v[88:89], v[88:89], v[32:33] op_sel:[0,0] op_sel_hi:[1,0]
    v_mfma_f32_16x16x32_bf16 v[64:67], v[216:219], v[208:211], v[64:67]
    v_max_f32 v42, 0, v42
    v_max_f32 v43, 0, v43
    v_pk_mul_f32 v[90:91], v[90:91], v[32:33] op_sel:[0,0] op_sel_hi:[1,0]
    v_max_f32 v44, 0, v44
    v_max_f32 v45, 0, v45
    v_mfma_f32_16x16x32_bf16 v[112:115], v[220:223], v[208:211], v[112:115]
    v_pk_mul_f32 v[92:93], v[92:93], v[32:33] op_sel:[0,0] op_sel_hi:[1,0]
    v_max_f32 v46, 0, v46
    v_max_f32 v47, 0, v47
    v_pk_mul_f32 v[94:95], v[94:95], v[32:33] op_sel:[0,0] op_sel_hi:[1,0]
    v_max_f32 v48, 0, v48
    v_mfma_f32_16x16x32_bf16 v[68:71], v[224:227], v[208:211], v[68:71]
    v_max_f32 v49, 0, v49
    v_pk_mul_f32 v[96:97], v[96:97], v[32:33] op_sel:[0,0] op_sel_hi:[1,0]
    v_max_f32 v50, 0, v50
    v_max_f32 v51, 0, v51
    v_pk_mul_f32 v[98:99], v[98:99], v[32:33] op_sel:[0,0] op_sel_hi:[1,0]
    v_pk_mul_f32 v[40:41], v[40:41], v[88:89] op_sel:[0,0] op_sel_hi:[1,1]
    v_pk_mul_f32 v[42:43], v[42:43], v[90:91] op_sel:[0,0] op_sel_hi:[1,1]
    v_pk_mul_f32 v[44:45], v[44:45], v[92:93] op_sel:[0,0] op_sel_hi:[1,1]
    v_pk_mul_f32 v[46:47], v[46:47], v[94:95] op_sel:[0,0] op_sel_hi:[1,1]
    v_pk_mul_f32 v[48:49], v[48:49], v[96:97] op_sel:[0,0] op_sel_hi:[1,1]
    v_pk_mul_f32 v[50:51], v[50:51], v[98:99] op_sel:[0,0] op_sel_hi:[1,1]
    v_cvt_pk_bf16_f32 v160, v40, v41
    v_cvt_pk_bf16_f32 v161, v42, v43
    v_cvt_pk_bf16_f32 v162, v44, v45
    v_cvt_pk_bf16_f32 v163, v46, v47
    v_cvt_pk_bf16_f32 v164, v48, v49
    v_cvt_pk_bf16_f32 v165, v50, v51
    buffer_store_dwordx4 v[160:163], v4, s[44:47], s7 offen
    buffer_store_dwordx2 v[164:165], v4, s[44:47], s8 offen
    s_add_u32 s7, s7, 44032
    s_add_u32 s8, s8, 44032
    v_mfma_f32_16x16x32_bf16 v[116:119], v[228:231], v[208:211], v[116:119]
    v_pk_fma_f32 v[52:53], v[24:25], v[136:137], v[52:53] op_sel:[1,0,0] op_sel_hi:[1,1,1] neg_lo:[1,0,0] neg_hi:[1,0,0]
    v_pk_fma_f32 v[100:101], v[24:25], v[148:149], v[100:101] op_sel:[1,0,0] op_sel_hi:[1,1,1] neg_lo:[1,0,0] neg_hi:[1,0,0]
    v_pk_fma_f32 v[54:55], v[24:25], v[138:139], v[54:55] op_sel:[1,0,0] op_sel_hi:[1,1,1] neg_lo:[1,0,0] neg_hi:[1,0,0]
    v_pk_fma_f32 v[102:103], v[24:25], v[150:151], v[102:103] op_sel:[1,0,0] op_sel_hi:[1,1,1] neg_lo:[1,0,0] neg_hi:[1,0,0]
    v_pk_fma_f32 v[56:57], v[24:25], v[140:141], v[56:57] op_sel:[1,0,0] op_sel_hi:[1,1,1] neg_lo:[1,0,0] neg_hi:[1,0,0]
    v_mfma_f32_16x16x32_bf16 v[72:75], v[232:235], v[208:211], v[72:75]
    v_pk_fma_f32 v[104:105], v[24:25], v[152:153], v[104:105] op_sel:[1,0,0] op_sel_hi:[1,1,1] neg_lo:[1,0,0] neg_hi:[1,0,0]
    v_pk_fma_f32 v[58:59], v[24:25], v[142:143], v[58:59] op_sel:[1,0,0] op_sel_hi:[1,1,1] neg_lo:[1,0,0] neg_hi:[1,0,0]
    v_pk_fma_f32 v[106:107], v[24:25], v[154:155], v[106:107] op_sel:[1,0,0] op_sel_hi:[1,1,1] neg_lo:[1,0,0] neg_hi:[1,0,0]
    v_pk_fma_f32 v[60:61], v[24:25], v[144:145], v[60:61] op_sel:[1,0,0] op_sel_hi:[1,1,1] neg_lo:[1,0,0] neg_hi:[1,0,0]
    v_pk_fma_f32 v[108:109], v[24:25], v[156:157], v[108:109] op_sel:[1,0,0] op_sel_hi:[1,1,1] neg_lo:[1,0,0] neg_hi:[1,0,0]
    v_mfma_f32_16x16x32_bf16 v[120:123], v[236:239], v[208:211], v[120:123]
    v_pk_fma_f32 v[62:63], v[24:25], v[146:147], v[62:63] op_sel:[1,0,0] op_sel_hi:[1,1,1] neg_lo:[1,0,0] neg_hi:[1,0,0]
    v_pk_fma_f32 v[110:111], v[24:25], v[158:159], v[110:111] op_sel:[1,0,0] op_sel_hi:[1,1,1] neg_lo:[1,0,0] neg_hi:[1,0,0]
    v_max_f32 v52, 0, v52
    v_max_f32 v53, 0, v53
    v_pk_mul_f32 v[100:101], v[100:101], v[32:33] op_sel:[0,1] op_sel_hi:[1,1]
    v_mfma_f32_16x16x32_bf16 v[76:79], v[216:219], v[212:215], v[76:79]
    v_max_f32 v54, 0, v54
    v_max_f32 v55, 0, v55
    v_pk_mul_f32 v[102:103], v[102:103], v[32:33] op_sel:[0,1] op_sel_hi:[1,1]
    v_max_f32 v56, 0, v56
    v_max_f32 v57, 0, v57
    v_mfma_f32_16x16x32_bf16 v[124:127], v[220:223], v[212:215], v[124:127]
    v_pk_mul_f32 v[104:105], v[104:105], v[32:33] op_sel:[0,1] op_sel_hi:[1,1]
    v_max_f32 v58, 0, v58
    v_max_f32 v59, 0, v59
    v_pk_mul_f32 v[106:107], v[106:107], v[32:33] op_sel:[0,1] op_sel_hi:[1,1]
    v_max_f32 v60, 0, v60
    v_mfma_f32_16x16x32_bf16 v[80:83], v[224:227], v[212:215], v[80:83]
    v_max_f32 v61, 0, v61
    v_pk_mul_f32 v[108:109], v[108:109], v[32:33] op_sel:[0,1] op_sel_hi:[1,1]
    v_max_f32 v62, 0, v62
    v_max_f32 v63, 0, v63
    v_pk_mul_f32 v[110:111], v[110:111], v[32:33] op_sel:[0,1] op_sel_hi:[1,1]
    v_mfma_f32_16x16x32_bf16 v[128:131], v[228:231], v[212:215], v[128:131]
    v_pk_mul_f32 v[52:53], v[52:53], v[100:101] op_sel:[0,0] op_sel_hi:[1,1]
    v_pk_mul_f32 v[54:55], v[54:55], v[102:103] op_sel:[0,0] op_sel_hi:[1,1]
    v_pk_mul_f32 v[56:57], v[56:57], v[104:105] op_sel:[0,0] op_sel_hi:[1,1]
    v_pk_mul_f32 v[58:59], v[58:59], v[106:107] op_sel:[0,0] op_sel_hi:[1,1]
    v_pk_mul_f32 v[60:61], v[60:61], v[108:109] op_sel:[0,0] op_sel_hi:[1,1]
    v_mfma_f32_16x16x32_bf16 v[84:87], v[232:235], v[212:215], v[84:87]
    v_pk_mul_f32 v[62:63], v[62:63], v[110:111] op_sel:[0,0] op_sel_hi:[1,1]
    v_cvt_pk_bf16_f32 v168, v52, v53
    v_cvt_pk_bf16_f32 v169, v54, v55
    v_cvt_pk_bf16_f32 v170, v56, v57
    v_cvt_pk_bf16_f32 v171, v58, v59
    v_mfma_f32_16x16x32_bf16 v[132:135], v[236:239], v[212:215], v[132:135]
    v_cvt_pk_bf16_f32 v172, v60, v61
    v_cvt_pk_bf16_f32 v173, v62, v63
    buffer_store_dwordx4 v[168:171], v4, s[44:47], s7 offen
    buffer_store_dwordx2 v[172:173], v4, s[44:47], s8 offen
    s_add_u32 s7, s7, 44032
    s_add_u32 s8, s8, 44032
    v_pk_fma_f32 v[64:65], v[26:27], v[136:137], v[64:65] op_sel:[0,0,0] op_sel_hi:[0,1,1] neg_lo:[1,0,0] neg_hi:[1,0,0]
    v_pk_fma_f32 v[112:113], v[26:27], v[148:149], v[112:113] op_sel:[0,0,0] op_sel_hi:[0,1,1] neg_lo:[1,0,0] neg_hi:[1,0,0]
    v_pk_fma_f32 v[66:67], v[26:27], v[138:139], v[66:67] op_sel:[0,0,0] op_sel_hi:[0,1,1] neg_lo:[1,0,0] neg_hi:[1,0,0]
    v_pk_fma_f32 v[114:115], v[26:27], v[150:151], v[114:115] op_sel:[0,0,0] op_sel_hi:[0,1,1] neg_lo:[1,0,0] neg_hi:[1,0,0]
    v_pk_fma_f32 v[68:69], v[26:27], v[140:141], v[68:69] op_sel:[0,0,0] op_sel_hi:[0,1,1] neg_lo:[1,0,0] neg_hi:[1,0,0]
    v_pk_fma_f32 v[116:117], v[26:27], v[152:153], v[116:117] op_sel:[0,0,0] op_sel_hi:[0,1,1] neg_lo:[1,0,0] neg_hi:[1,0,0]
    v_pk_fma_f32 v[70:71], v[26:27], v[142:143], v[70:71] op_sel:[0,0,0] op_sel_hi:[0,1,1] neg_lo:[1,0,0] neg_hi:[1,0,0]
    v_pk_fma_f32 v[118:119], v[26:27], v[154:155], v[118:119] op_sel:[0,0,0] op_sel_hi:[0,1,1] neg_lo:[1,0,0] neg_hi:[1,0,0]
    v_pk_fma_f32 v[72:73], v[26:27], v[144:145], v[72:73] op_sel:[0,0,0] op_sel_hi:[0,1,1] neg_lo:[1,0,0] neg_hi:[1,0,0]
    v_pk_fma_f32 v[120:121], v[26:27], v[156:157], v[120:121] op_sel:[0,0,0] op_sel_hi:[0,1,1] neg_lo:[1,0,0] neg_hi:[1,0,0]
    v_pk_fma_f32 v[74:75], v[26:27], v[146:147], v[74:75] op_sel:[0,0,0] op_sel_hi:[0,1,1] neg_lo:[1,0,0] neg_hi:[1,0,0]
    v_pk_fma_f32 v[122:123], v[26:27], v[158:159], v[122:123] op_sel:[0,0,0] op_sel_hi:[0,1,1] neg_lo:[1,0,0] neg_hi:[1,0,0]
    v_max_f32 v64, 0, v64
    v_max_f32 v65, 0, v65
    v_pk_mul_f32 v[112:113], v[112:113], v[34:35] op_sel:[0,0] op_sel_hi:[1,0]
    v_max_f32 v66, 0, v66
    v_max_f32 v67, 0, v67
    v_pk_mul_f32 v[114:115], v[114:115], v[34:35] op_sel:[0,0] op_sel_hi:[1,0]
    v_max_f32 v68, 0, v68
    v_max_f32 v69, 0, v69
    v_pk_mul_f32 v[116:117], v[116:117], v[34:35] op_sel:[0,0] op_sel_hi:[1,0]
    v_max_f32 v70, 0, v70
    v_max_f32 v71, 0, v71
    v_pk_mul_f32 v[118:119], v[118:119], v[34:35] op_sel:[0,0] op_sel_hi:[1,0]
    v_max_f32 v72, 0, v72
    v_max_f32 v73, 0, v73
    v_pk_mul_f32 v[120:121], v[120:121], v[34:35] op_sel:[0,0] op_sel_hi:[1,0]
    v_max_f32 v74, 0, v74
    v_max_f32 v75, 0, v75
    v_pk_mul_f32 v[122:123], v[122:123], v[34:35] op_sel:[0,0] op_sel_hi:[1,0]
    v_pk_mul_f32 v[64:65], v[64:65], v[112:113] op_sel:[0,0] op_sel_hi:[1,1]
    v_pk_mul_f32 v[66:67], v[66:67], v[114:115] op_sel:[0,0] op_sel_hi:[1,1]
    v_pk_mul_f32 v[68:69], v[68:69], v[116:117] op_sel:[0,0] op_sel_hi:[1,1]
    v_pk_mul_f32 v[70:71], v[70:71], v[118:119] op_sel:[0,0] op_sel_hi:[1,1]
    v_pk_mul_f32 v[72:73], v[72:73], v[120:121] op_sel:[0,0] op_sel_hi:[1,1]
    v_pk_mul_f32 v[74:75], v[74:75], v[122:123] op_sel:[0,0] op_sel_hi:[1,1]
    v_cvt_pk_bf16_f32 v176, v64, v65
    v_cvt_pk_bf16_f32 v177, v66, v67
    v_cvt_pk_bf16_f32 v178, v68, v69
    v_cvt_pk_bf16_f32 v179, v70, v71
    v_cvt_pk_bf16_f32 v180, v72, v73
    v_cvt_pk_bf16_f32 v181, v74, v75
    buffer_store_dwordx4 v[176:179], v4, s[44:47], s7 offen
    buffer_store_dwordx2 v[180:181], v4, s[44:47], s8 offen
    s_add_u32 s7, s7, 44032
    s_add_u32 s8, s8, 44032
    v_pk_fma_f32 v[76:77], v[26:27], v[136:137], v[76:77] op_sel:[1,0,0] op_sel_hi:[1,1,1] neg_lo:[1,0,0] neg_hi:[1,0,0]
    v_pk_fma_f32 v[124:125], v[26:27], v[148:149], v[124:125] op_sel:[1,0,0] op_sel_hi:[1,1,1] neg_lo:[1,0,0] neg_hi:[1,0,0]
    v_pk_fma_f32 v[78:79], v[26:27], v[138:139], v[78:79] op_sel:[1,0,0] op_sel_hi:[1,1,1] neg_lo:[1,0,0] neg_hi:[1,0,0]
    v_pk_fma_f32 v[126:127], v[26:27], v[150:151], v[126:127] op_sel:[1,0,0] op_sel_hi:[1,1,1] neg_lo:[1,0,0] neg_hi:[1,0,0]
    v_pk_fma_f32 v[80:81], v[26:27], v[140:141], v[80:81] op_sel:[1,0,0] op_sel_hi:[1,1,1] neg_lo:[1,0,0] neg_hi:[1,0,0]
    v_pk_fma_f32 v[128:129], v[26:27], v[152:153], v[128:129] op_sel:[1,0,0] op_sel_hi:[1,1,1] neg_lo:[1,0,0] neg_hi:[1,0,0]
    v_pk_fma_f32 v[82:83], v[26:27], v[142:143], v[82:83] op_sel:[1,0,0] op_sel_hi:[1,1,1] neg_lo:[1,0,0] neg_hi:[1,0,0]
    v_pk_fma_f32 v[130:131], v[26:27], v[154:155], v[130:131] op_sel:[1,0,0] op_sel_hi:[1,1,1] neg_lo:[1,0,0] neg_hi:[1,0,0]
    v_pk_fma_f32 v[84:85], v[26:27], v[144:145], v[84:85] op_sel:[1,0,0] op_sel_hi:[1,1,1] neg_lo:[1,0,0] neg_hi:[1,0,0]
    v_pk_fma_f32 v[132:133], v[26:27], v[156:157], v[132:133] op_sel:[1,0,0] op_sel_hi:[1,1,1] neg_lo:[1,0,0] neg_hi:[1,0,0]
    v_pk_fma_f32 v[86:87], v[26:27], v[146:147], v[86:87] op_sel:[1,0,0] op_sel_hi:[1,1,1] neg_lo:[1,0,0] neg_hi:[1,0,0]
    v_pk_fma_f32 v[134:135], v[26:27], v[158:159], v[134:135] op_sel:[1,0,0] op_sel_hi:[1,1,1] neg_lo:[1,0,0] neg_hi:[1,0,0]
    v_max_f32 v76, 0, v76
    v_max_f32 v77, 0, v77
    v_pk_mul_f32 v[124:125], v[124:125], v[34:35] op_sel:[0,1] op_sel_hi:[1,1]
    v_max_f32 v78, 0, v78
    v_max_f32 v79, 0, v79
    v_pk_mul_f32 v[126:127], v[126:127], v[34:35] op_sel:[0,1] op_sel_hi:[1,1]
    v_max_f32 v80, 0, v80
    v_max_f32 v81, 0, v81
    v_pk_mul_f32 v[128:129], v[128:129], v[34:35] op_sel:[0,1] op_sel_hi:[1,1]
    v_max_f32 v82, 0, v82
    v_max_f32 v83, 0, v83
    v_pk_mul_f32 v[130:131], v[130:131], v[34:35] op_sel:[0,1] op_sel_hi:[1,1]
    v_max_f32 v84, 0, v84
    v_max_f32 v85, 0, v85
    v_pk_mul_f32 v[132:133], v[132:133], v[34:35] op_sel:[0,1] op_sel_hi:[1,1]
    v_max_f32 v86, 0, v86
    v_max_f32 v87, 0, v87
    v_pk_mul_f32 v[134:135], v[134:135], v[34:35] op_sel:[0,1] op_sel_hi:[1,1]
    v_pk_mul_f32 v[76:77], v[76:77], v[124:125] op_sel:[0,0] op_sel_hi:[1,1]
    v_pk_mul_f32 v[78:79], v[78:79], v[126:127] op_sel:[0,0] op_sel_hi:[1,1]
    v_pk_mul_f32 v[80:81], v[80:81], v[128:129] op_sel:[0,0] op_sel_hi:[1,1]
    v_pk_mul_f32 v[82:83], v[82:83], v[130:131] op_sel:[0,0] op_sel_hi:[1,1]
    v_pk_mul_f32 v[84:85], v[84:85], v[132:133] op_sel:[0,0] op_sel_hi:[1,1]
    v_pk_mul_f32 v[86:87], v[86:87], v[134:135] op_sel:[0,0] op_sel_hi:[1,1]
    v_cvt_pk_bf16_f32 v184, v76, v77
    v_cvt_pk_bf16_f32 v185, v78, v79
    v_cvt_pk_bf16_f32 v186, v80, v81
    v_cvt_pk_bf16_f32 v187, v82, v83
    v_cvt_pk_bf16_f32 v188, v84, v85
    v_cvt_pk_bf16_f32 v189, v86, v87
    buffer_store_dwordx4 v[184:187], v4, s[44:47], s7 offen
    buffer_store_dwordx2 v[188:189], v4, s[44:47], s8 offen
    s_waitcnt vmcnt(0)
    s_barrier
    s_lshr_b32 s13, s61, 3
    s_lshl_b32 s12, s60, 1
    s_add_u32 s12, s12, s13
    s_and_b32 s13, s61, 7
    s_mul_i32 s14, s13, 5
    s_lshr_b32 s10, s3, 1
    s_and_b32 s11, s3, 1
    s_lshl_b32 s15, s12, 2
    s_lshl_b32 s5, s10, 1
    s_add_u32 s15, s15, s5
    v_lshlrev_b32 v16, 4, v1
    s_lshl_b32 s6, s15, 4
    s_lshl_b32 s5, s13, 1
    s_add_u32 s6, s6, s5
    s_add_u32 s6, s6, s11
    s_lshl_b32 s6, s6, 10
    s_add_u32 s7, s6, 4194304
    s_add_u32 s6, s6, 4194304
    s_lshl_b32 s8, s15, 14
    s_lshl_b32 s5, s13, 7
    s_add_u32 s8, s8, s5
    s_lshl_b32 s5, s11, 6
    s_add_u32 s8, s8, s5
    s_mov_b32 s48, s30
    s_mov_b32 s49, s31
    s_mov_b32 s50, 2097152
    s_mov_b32 s51, 0x00020000
    s_add_u32 s5, s7, 16384
    buffer_load_dwordx4 v[24:27], v16, s[44:47], s7 offen
    buffer_load_dwordx4 v[28:31], v16, s[44:47], s5 offen
    s_lshl_b32 s4, s10, 11
    s_add_u32 s4, s4, 98304
    v_lshl_add_u32 v8, v1, 4, s4
    v_and_b32 v4, 1, v2
    v_lshlrev_b32 v4, 5, v4
    v_lshl_add_u32 v4, v2, 8, v4
    v_bfe_u32 v5, v1, 2, 2
    v_lshl_add_u32 v4, v5, 6, v4
    v_and_b32 v5, 3, v1
    v_lshl_add_u32 v9, v5, 3, v4
    v_xor_b32 v10, 32, v9
    s_lshl_b32 s4, s11, 11
    v_add_u32 v9, s4, v9
    v_add_u32 v10, s4, v10
    s_waitcnt vmcnt(1)
    v_lshlrev_b32 v32, 16, v24
    v_and_b32 v33, 0xffff0000, v24
    v_lshlrev_b32 v34, 16, v25
    v_and_b32 v35, 0xffff0000, v25
    v_lshlrev_b32 v36, 16, v26
    v_and_b32 v37, 0xffff0000, v26
    v_lshlrev_b32 v38, 16, v27
    v_and_b32 v39, 0xffff0000, v27
    s_waitcnt vmcnt(0)
    v_lshlrev_b32 v40, 16, v28
    v_and_b32 v41, 0xffff0000, v28
    v_lshlrev_b32 v42, 16, v29
    v_and_b32 v43, 0xffff0000, v29
    v_lshlrev_b32 v44, 16, v30
    v_and_b32 v45, 0xffff0000, v30
    v_lshlrev_b32 v46, 16, v31
    v_and_b32 v47, 0xffff0000, v31
    s_mov_b32 s58, 0
    s_mov_b32 s59, 49152
    s_mov_b32 s9, 0
    v_mov_b32 v11, v8
    v_add_u32 v12, s59, v9
    v_add_u32 v13, s59, v10
    s_barrier
    ds_read_b128 v[48:51], v11 offset:0
    ds_read_b64_tr_b16 v[64:65], v12 offset:0
    ds_read_b64_tr_b16 v[66:67], v12 offset:1024
    ds_read_b128 v[52:55], v11 offset:1024
    ds_read_b64_tr_b16 v[68:69], v13 offset:0
    ds_read_b64_tr_b16 v[70:71], v13 offset:1024
    ds_read_b128 v[56:59], v11 offset:4096
    ds_read_b64_tr_b16 v[72:73], v12 offset:4096
    ds_read_b64_tr_b16 v[74:75], v12 offset:5120
    ds_read_b128 v[60:63], v11 offset:5120
    ds_read_b64_tr_b16 v[76:77], v13 offset:4096
    ds_read_b64_tr_b16 v[78:79], v13 offset:5120
L_ml_s4l1:
    s_barrier
    s_waitcnt lgkmcnt(9)
    v_mfma_f32_16x16x32_bf16 v[32:35], v[64:67], v[48:51], v[32:35]
    ds_read_b128 v[80:83], v11 offset:8192
    ds_read_b64_tr_b16 v[96:97], v12 offset:8192
    s_waitcnt lgkmcnt(10)
    v_mfma_f32_16x16x32_bf16 v[40:43], v[64:67], v[52:55], v[40:43]
    ds_read_b64_tr_b16 v[98:99], v12 offset:9216
    ds_read_b128 v[84:87], v11 offset:9216
    s_waitcnt lgkmcnt(10)
    v_mfma_f32_16x16x32_bf16 v[36:39], v[68:71], v[48:51], v[36:39]
    ds_read_b64_tr_b16 v[100:101], v13 offset:8192
    ds_read_b64_tr_b16 v[102:103], v13 offset:9216
    v_mfma_f32_16x16x32_bf16 v[44:47], v[68:71], v[52:55], v[44:47]
    ds_read_b128 v[88:91], v11 offset:12288
    ds_read_b64_tr_b16 v[104:105], v12 offset:12288
    s_waitcnt lgkmcnt(11)
    v_mfma_f32_16x16x32_bf16 v[32:35], v[72:75], v[56:59], v[32:35]
    ds_read_b64_tr_b16 v[106:107], v12 offset:13312
    ds_read_b128 v[92:95], v11 offset:13312
    s_waitcnt lgkmcnt(12)
    v_mfma_f32_16x16x32_bf16 v[40:43], v[72:75], v[60:63], v[40:43]
    ds_read_b64_tr_b16 v[108:109], v13 offset:12288
    ds_read_b64_tr_b16 v[110:111], v13 offset:13312
    s_waitcnt lgkmcnt(12)
    v_mfma_f32_16x16x32_bf16 v[36:39], v[76:79], v[56:59], v[36:39]
    s_add_u32 s58, s58, 16384
    s_cmp_eq_u32 s58, 49152
    s_cselect_b32 s58, 0, s58
    s_add_u32 s59, s59, 16384
    s_cmp_eq_u32 s59, 98304
    v_mfma_f32_16x16x32_bf16 v[44:47], v[76:79], v[60:63], v[44:47]
    s_cselect_b32 s59, 0, s59
    v_add_u32 v11, s58, v8
    v_add_u32 v12, s59, v9
    v_add_u32 v13, s59, v10
    s_barrier
    s_waitcnt lgkmcnt(9)
    v_mfma_f32_16x16x32_bf16 v[32:35], v[96:99], v[80:83], v[32:35]
    ds_read_b128 v[48:51], v11 offset:0
    ds_read_b64_tr_b16 v[64:65], v12 offset:0
    s_waitcnt lgkmcnt(10)
    v_mfma_f32_16x16x32_bf16 v[40:43], v[96:99], v[84:87], v[40:43]
    ds_read_b64_tr_b16 v[66:67], v12 offset:1024
    ds_read_b128 v[52:55], v11 offset:1024
    s_waitcnt lgkmcnt(10)
    v_mfma_f32_16x16x32_bf16 v[36:39], v[100:103], v[80:83], v[36:39]
    ds_read_b64_tr_b16 v[68:69], v13 offset:0
    ds_read_b64_tr_b16 v[70:71], v13 offset:1024
    v_mfma_f32_16x16x32_bf16 v[44:47], v[100:103], v[84:87], v[44:47]
    ds_read_b128 v[56:59], v11 offset:4096
    ds_read_b64_tr_b16 v[72:73], v12 offset:4096
    s_waitcnt lgkmcnt(11)
    v_mfma_f32_16x16x32_bf16 v[32:35], v[104:107], v[88:91], v[32:35]
    ds_read_b64_tr_b16 v[74:75], v12 offset:5120
    ds_read_b128 v[60:63], v11 offset:5120
    s_waitcnt lgkmcnt(12)
    v_mfma_f32_16x16x32_bf16 v[40:43], v[104:107], v[92:95], v[40:43]
    ds_read_b64_tr_b16 v[76:77], v13 offset:4096
    ds_read_b64_tr_b16 v[78:79], v13 offset:5120
    s_waitcnt lgkmcnt(12)
    v_mfma_f32_16x16x32_bf16 v[36:39], v[108:111], v[88:91], v[36:39]
    s_add_u32 s9, s9, 1
    v_mfma_f32_16x16x32_bf16 v[44:47], v[108:111], v[92:95], v[44:47]
    s_cmp_lt_u32 s9, 11
    s_cbranch_scc1 L_ml_s4l1
    s_waitcnt lgkmcnt(0)
    v_cvt_pk_bf16_f32 v24, v32, v33
    v_cvt_pk_bf16_f32 v25, v34, v35
    s_nop 0
    v_cvt_pk_bf16_f32 v26, v36, v37
    v_cvt_pk_bf16_f32 v27, v38, v39
    v_cvt_pk_bf16_f32 v28, v40, v41
    v_cvt_pk_bf16_f32 v29, v42, v43
    v_cvt_pk_bf16_f32 v30, v44, v45
    v_cvt_pk_bf16_f32 v31, v46, v47
    s_mul_i32 s4, s3, 2560
    s_add_u32 s4, s4, 147456
    v_mul_u32_u24 v4, 80, v3
    v_lshl_add_u32 v4, v2, 3, v4
    v_add_u32 v4, s4, v4
    ds_write_b64 v4, v[24:25] offset:0
    ds_write_b64 v4, v[26:27] offset:32
    ds_write_b64 v4, v[28:29] offset:1280
    ds_write_b64 v4, v[30:31] offset:1312
    v_lshrrev_b32 v5, 2, v1
    v_and_b32 v6, 3, v1
    v_mul_u32_u24 v7, 80, v5
    v_lshl_add_u32 v7, v6, 4, v7
    v_add_u32 v7, s4, v7
    s_waitcnt lgkmcnt(0)
    ds_read_b128 v[32:35], v7 offset:0
    ds_read_b128 v[36:39], v7 offset:1280
    v_lshlrev_b32 v5, 10, v5
    v_lshl_add_u32 v5, v6, 4, v5
    s_add_u32 s9, s8, 16384
    s_waitcnt lgkmcnt(1)
    buffer_store_dwordx4 v[32:35], v5, s[48:51], s8 offen
    s_waitcnt lgkmcnt(0)
    buffer_store_dwordx4 v[36:39], v5, s[48:51], s9 offen
L_end:
    s_endpgm

.section .rodata,"a"
.p2align 6
.amdhsa_kernel interleave_layers__linear_attn_block__glu_gated_reglu__prompt_kernel
  .amdhsa_next_free_vgpr 256
  .amdhsa_next_free_sgpr 102
  .amdhsa_accum_offset 256
  .amdhsa_group_segment_fixed_size 0
  .amdhsa_kernarg_size 80
  .amdhsa_user_sgpr_count 2
  .amdhsa_user_sgpr_kernarg_segment_ptr 1
  .amdhsa_system_sgpr_workgroup_id_x 1
.end_amdhsa_kernel
```
